```python
import torch

def _softmax(x, axis=-1):
    return torch.softmax(x, dim=axis)
def _gelu(x):
    return torch.nn.functional.gelu(x, approximate="tanh")
def _silu(x):
    return torch.nn.functional.silu(x)
def _sigmoid(x):
    return torch.sigmoid(x)
def _layernorm(x, axis=-1, eps=1e-5):
    m = x.mean(dim=axis, keepdim=True)
    v = x.var(dim=axis, keepdim=True, unbiased=False)
    return (x - m) / torch.sqrt(v + eps)
def _scatter_add(tgt, idx, src, axis=0):
    return tgt.clone().index_add_(axis, idx, src)
def _segment_sum(src, seg, n):
    out = torch.zeros((n,) + src.shape[1:], dtype=src.dtype)
    return out.index_add_(0, seg, src)
def _pad(x, pw):
    flat = tuple(v for pair in reversed(pw) for v in pair)
    return torch.nn.functional.pad(x, flat)

kernel_name = 'standalone__gqa_softmax__near_ridge'

def setup_inputs():

    _w = (lambda a: (lambda t: t.to(torch.bfloat16) if t.is_floating_point() else t)(torch.as_tensor(a)))
    B, Hq, Hkv, Sq, Sk, D = 32, 32, 16, 384, 512, 128
    return {
        "q": _w((lambda *s: torch.randn(*s, dtype=torch.bfloat16) * 0.8)(B, Hq, Sq, D)),
        "k": _w((lambda *s: torch.randn(*s, dtype=torch.bfloat16) * 0.8)(B, Hkv, Sk, D)),
        "v": _w((lambda *s: torch.randn(*s, dtype=torch.bfloat16) * 0.05)(B, Hkv, Sk, D)),
    }

def reference(q, k, v):
    B, Hq, Sq, D = q.shape
    Hkv = k.shape[1]
    rep = Hq // Hkv
    k = (lambda x, n, axis: torch.repeat_interleave(x, n, dim=axis))(k, rep, axis=1)
    v = (lambda x, n, axis: torch.repeat_interleave(x, n, dim=axis))(v, rep, axis=1)
    scale = D ** -0.5
    scores = torch.einsum("bhqd,bhkd->bhqk", q, k) * scale
    p = _softmax(scores, axis=-1)
    return torch.einsum("bhqk,bhkd->bhqd", p, v)
```

```asm
; @launch grid=(256,1,1) block=(256,1,1) lds=163840
.amdgcn_target "amdgcn-amd-amdhsa--gfx950"
.text
.globl standalone__gqa_softmax__near_ridge_kernel
.p2align 8
.type standalone__gqa_softmax__near_ridge_kernel,@function
standalone__gqa_softmax__near_ridge_kernel:
  s_cmp_ge_u32 s2, 256
  s_cbranch_scc1 L_end
  s_load_dwordx4 s[40:43], s[0:1], 0
  s_load_dwordx4 s[44:47], s[0:1], 16
  s_getpc_b64 s[54:55]
L_pc:
  s_lshr_b32 s53, s2, 3
  s_lshl_b32 s53, s53, 7
  v_lshl_add_u32 v58, v0, 12, s53
  v_cmp_ge_u32 vcc, L_end-L_pc, v58
  s_and_saveexec_b64 s[56:57], vcc
  s_cbranch_execz L_pfd
  global_load_dword v59, v58, s[54:55]
L_pfd:
  s_mov_b64 exec, s[56:57]
  v_lshrrev_b32 v60, 6, v0
  v_and_b32 v0, 63, v0
  v_readfirstlane_b32 s34, v60
  v_and_b32 v54, 15, v0
  v_lshrrev_b32 v55, 4, v0
  v_and_b32 v56, 3, v0
  v_bfe_u32 v57, v0, 2, 2
  v_lshlrev_b32 v4, 8, v57
  v_lshl_add_u32 v4, v55, 6, v4
  v_lshl_add_u32 v4, v56, 4, v4
  v_and_b32 v58, 1, v60
  v_lshlrev_b32 v58, 5, v58
  v_xor_b32 v5, v4, v58
  s_and_b32 s48, s2, 7
  s_lshr_b32 s49, s2, 3
  s_and_b32 s50, s49, 1
  s_lshr_b32 s49, s49, 1
  s_lshl_b32 s49, s49, 3
  s_add_u32 s49, s49, s48
  s_lshl_b32 s36, s49, 17
  s_lshl_b32 s49, s49, 1
  s_add_u32 s49, s49, s50
  s_mul_i32 s37, s49, 98304
  s_mul_i32 s51, s34, 24576
  s_add_u32 s37, s37, s51
  s_add_u32 s33, s51, 65536
  s_lshl_b32 s32, s34, 12
  s_lshl_b32 s52, s34, 11
  s_add_u32 s20, s36, s52
  s_mov_b32 s21, s37
  s_mov_b32 s23, s37
  s_mov_b32 s22, 0x7000000
  s_mov_b32 s6, 100663296
  s_mov_b32 s7, 0x20000
  s_mov_b32 s10, 67110912
  s_mov_b32 s11, 0x20000
  s_mov_b32 s14, 67108864
  s_mov_b32 s15, 0x20000
  s_mov_b32 s18, 100663296
  s_mov_b32 s19, 0x20000
  s_waitcnt lgkmcnt(0)
  s_sub_u32 s8, s42, 2048
  s_subb_u32 s9, s43, 0
  s_mov_b32 s4, s40
  s_mov_b32 s5, s41
  s_mov_b32 s12, s44
  s_mov_b32 s13, s45
  s_mov_b32 s16, s46
  s_mov_b32 s17, s47
  s_mov_b32 m0, s32
  s_nop 0
  buffer_load_dwordx4 v5, s[8:11], s20 offen offset:2048 lds
  buffer_load_dwordx4 v5, s[8:11], s20 offen offset:3072 lds
  s_mov_b32 m0, s33
  s_nop 0
  buffer_load_dwordx4 v4, s[4:7], s21 offen nt lds
  buffer_load_dwordx4 v4, s[4:7], s21 offen offset:1024 nt lds
  buffer_load_dwordx4 v4, s[4:7], s21 offen offset:2048 nt lds
  buffer_load_dwordx4 v4, s[4:7], s21 offen offset:3072 nt lds
  s_add_u32 s21, s21, 4096
  s_mov_b32 m0, s32
  s_nop 0
  buffer_load_dwordx4 v4, s[12:15], s20 offen lds
  buffer_load_dwordx4 v4, s[12:15], s20 offen offset:1024 lds
  s_add_u32 s20, s20, 8192
  s_add_u32 m0, s32, 16384
  s_nop 0
  buffer_load_dwordx4 v5, s[8:11], s20 offen offset:2048 lds
  buffer_load_dwordx4 v5, s[8:11], s20 offen offset:3072 lds
  buffer_load_dwordx4 v4, s[12:15], s20 offen lds
  buffer_load_dwordx4 v4, s[12:15], s20 offen offset:1024 lds
  s_add_u32 s20, s20, 8192
  s_add_u32 m0, s33, 4096
  s_nop 0
  buffer_load_dwordx4 v4, s[4:7], s21 offen nt lds
  buffer_load_dwordx4 v4, s[4:7], s21 offen offset:1024 nt lds
  buffer_load_dwordx4 v4, s[4:7], s21 offen offset:2048 nt lds
  buffer_load_dwordx4 v4, s[4:7], s21 offen offset:3072 nt lds
  s_add_u32 s21, s21, 4096
  v_bfe_u32 v58, v0, 3, 1
  v_lshlrev_b32 v1, 12, v58
  v_lshlrev_b32 v58, 1, v58
  v_xor_b32 v58, v58, v55
  v_lshl_add_u32 v1, v58, 4, v1
  v_bfe_u32 v58, v0, 2, 1
  v_lshl_add_u32 v1, v58, 10, v1
  v_lshl_add_u32 v1, v56, 6, v1
  v_lshrrev_b32 v58, 5, v0
  v_lshlrev_b32 v2, 12, v58
  v_bfe_u32 v58, v0, 4, 1
  v_lshl_add_u32 v2, v58, 10, v2
  v_lshl_add_u32 v2, v54, 4, v2
  v_lshlrev_b32 v3, 10, v57
  v_lshl_add_u32 v3, v56, 6, v3
  v_lshl_add_u32 v3, v55, 4, v3
  v_add_u32 v3, s33, v3
  v_bfe_u32 v58, v0, 1, 2
  v_xor_b32 v58, v58, v55
  v_lshlrev_b32 v62, 4, v58
  v_lshl_add_u32 v62, v54, 6, v62
  v_add_u32 v62, s33, v62
  v_xor_b32 v58, v56, v55
  v_lshlrev_b32 v63, 4, v58
  v_bfe_u32 v58, v0, 2, 1
  v_lshl_add_u32 v63, v58, 10, v63
  v_lshrrev_b32 v58, 3, v0
  v_lshl_add_u32 v63, v58, 6, v63
  v_add_u32 v63, s33, v63
  v_lshlrev_b32 v6, 8, v58
  v_and_b32 v58, 7, v0
  v_lshl_add_u32 v6, v58, 4, v6
  v_bfe_u32 v58, v0, 1, 1
  v_lshrrev_b32 v61, 5, v0
  v_cmp_eq_u32 vcc, v58, v61
  v_mov_b32 v58, 0x3f803f80
  s_nop 1
  v_cndmask_b32 v58, 0, v58, vcc
  v_accvgpr_write_b32 a224, v58
  v_accvgpr_write_b32 a225, v58
  v_accvgpr_write_b32 a226, v58
  v_accvgpr_write_b32 a227, v58
  v_and_b32 v58, 1, v0
  v_mul_u32_u24 v58, 0xaaaa, v58
  v_add_u32 v7, 0x4444, v58
  v_mov_b32 v40, 0
  v_mov_b32 v41, 0
  v_mov_b32 v42, 0
  v_mov_b32 v43, 0
  v_mov_b32 v44, 0
  v_mov_b32 v45, 0
  v_mov_b32 v46, 0
  v_mov_b32 v47, 0
  v_mov_b32 v48, 0
  v_mov_b32 v49, 0
  v_mov_b32 v50, 0
  v_mov_b32 v51, 0
  s_mov_b32 s24, 0x3e0293ee
  s_mov_b32 s25, 0xbe0293ee
  s_mov_b32 s26, 0x53800000
  s_mov_b32 s27, 0
  s_mov_b32 s28, 0
  s_mov_b64 s[30:31], 0
  s_add_u32 m0, s33, 8192
  s_nop 0
  buffer_load_dwordx4 v4, s[4:7], s21 offen nt lds
  buffer_load_dwordx4 v4, s[4:7], s21 offen offset:1024 nt lds
  buffer_load_dwordx4 v4, s[4:7], s21 offen offset:2048 nt lds
  buffer_load_dwordx4 v4, s[4:7], s21 offen offset:3072 nt lds
  s_add_u32 s21, s21, 4096
  s_waitcnt vmcnt(12)
  s_barrier
  ds_read_b128 a[0:3], v3 offset:0
  ds_read_b128 a[4:7], v3 offset:256
  ds_read_b128 a[8:11], v3 offset:512
  ds_read_b128 a[12:15], v3 offset:768
  ds_read_b128 a[96:99], v1 offset:2048
  ds_read_b128 a[100:103], v1 offset:2304
  ds_read_b128 a[104:107], v1 offset:2560
  ds_read_b128 a[108:111], v1 offset:2816
  ds_read_b128 a[112:115], v1 offset:10240
  ds_read_b128 a[116:119], v1 offset:10496
  ds_read_b128 a[120:123], v1 offset:10752
  ds_read_b128 a[124:127], v1 offset:11008
  ds_read_b64_tr_b16 a[160:161], v2 offset:0
  ds_read_b64_tr_b16 a[162:163], v2 offset:8192
  ds_read_b64_tr_b16 a[164:165], v2 offset:8
  ds_read_b64_tr_b16 a[166:167], v2 offset:8200
  ds_read_b64_tr_b16 a[168:169], v2 offset:256
  ds_read_b64_tr_b16 a[170:171], v2 offset:8448
  ds_read_b64_tr_b16 a[172:173], v2 offset:264
  ds_read_b64_tr_b16 a[174:175], v2 offset:8456
  ds_read_b64_tr_b16 a[176:177], v2 offset:512
  ds_read_b64_tr_b16 a[178:179], v2 offset:8704
  ds_read_b64_tr_b16 a[180:181], v2 offset:520
  ds_read_b64_tr_b16 a[182:183], v2 offset:8712
  s_waitcnt lgkmcnt(12)
  v_mfma_f32_16x16x32_bf16 v[16:19], a[96:99], a[0:3], 0
  ds_read_b64_tr_b16 a[184:185], v2 offset:768
  v_mfma_f32_16x16x32_bf16 v[16:19], a[100:103], a[4:7], v[16:19]
  v_mfma_f32_16x16x32_bf16 v[16:19], a[104:107], a[8:11], v[16:19]
  ds_read_b64_tr_b16 a[186:187], v2 offset:8960
  v_mfma_f32_16x16x32_bf16 v[16:19], a[108:111], a[12:15], v[16:19]
  v_mfma_f32_16x16x32_bf16 v[20:23], a[124:127], a[12:15], 0
  ds_read_b64_tr_b16 a[188:189], v2 offset:776
  v_mfma_f32_16x16x32_bf16 v[20:23], a[120:123], a[8:11], v[20:23]
  v_mfma_f32_16x16x32_bf16 v[20:23], a[116:119], a[4:7], v[20:23]
  ds_read_b64_tr_b16 a[190:191], v2 offset:8968
  v_mfma_f32_16x16x32_bf16 v[20:23], a[112:115], a[0:3], v[20:23]
  s_nop 1
  v_max3_f32 v14, v16, v17, v18
  s_nop 4
  v_max3_f32 v14, v14, v19, v20
  v_max3_f32 v14, v14, v21, v22
  v_max_f32 v14, v14, v23
  v_mov_b32 v15, v14
  s_nop 1
  v_permlane16_swap_b32 v14, v15
  v_max_f32 v14, v14, v15
  v_mov_b32 v15, v14
  s_nop 1
  v_permlane32_swap_b32 v14, v15
  v_max_f32 v14, v14, v15
  s_waitcnt vmcnt(8) lgkmcnt(0)
  v_mul_f32 v8, s25, v14
  s_add_u32 m0, s33, 12288
  s_nop 0
  buffer_load_dwordx4 v4, s[4:7], s21 offen nt lds
  buffer_load_dwordx4 v4, s[4:7], s21 offen offset:1024 nt lds
  buffer_load_dwordx4 v4, s[4:7], s21 offen offset:2048 nt lds
  buffer_load_dwordx4 v4, s[4:7], s21 offen offset:3072 nt lds
  s_add_u32 s21, s21, 4096
  s_waitcnt vmcnt(8)
  ds_read_b128 a[16:19], v3 offset:4096
  ds_read_b128 a[20:23], v3 offset:4352
  ds_read_b128 a[24:27], v3 offset:4608
  ds_read_b128 a[28:31], v3 offset:4864
  s_waitcnt lgkmcnt(0)
  v_mfma_f32_16x16x32_bf16 v[24:27], a[96:99], a[16:19], 0
  s_barrier
  ds_read_b128 a[128:131], v1 offset:18432
  v_fma_f32 v16, v16, s24, v8
  v_mfma_f32_16x16x32_bf16 v[24:27], a[100:103], a[20:23], v[24:27]
  v_exp_f32 v16, v16
  v_mfma_f32_16x16x32_bf16 v[24:27], a[104:107], a[24:27], v[24:27]
  ds_read_b128 a[132:135], v1 offset:18688
  v_fma_f32 v17, v17, s24, v8
  v_mfma_f32_16x16x32_bf16 v[24:27], a[108:111], a[28:31], v[24:27]
  v_exp_f32 v17, v17
  v_mfma_f32_16x16x32_bf16 v[28:31], a[124:127], a[28:31], 0
  ds_read_b128 a[136:139], v1 offset:18944
  v_fma_f32 v18, v18, s24, v8
  v_mfma_f32_16x16x32_bf16 v[28:31], a[120:123], a[24:27], v[28:31]
  v_exp_f32 v18, v18
  v_mfma_f32_16x16x32_bf16 v[28:31], a[116:119], a[20:23], v[28:31]
  ds_read_b128 a[140:143], v1 offset:19200
  v_fma_f32 v19, v19, s24, v8
  v_mfma_f32_16x16x32_bf16 v[28:31], a[112:115], a[16:19], v[28:31]
  v_exp_f32 v19, v19
  v_fma_f32 v20, v20, s24, v8
  v_cvt_pk_bf16_f32 v32, v16, v17
  v_exp_f32 v20, v20
  v_fma_f32 v21, v21, s24, v8
  v_cvt_pk_bf16_f32 v33, v18, v19
  v_exp_f32 v21, v21
  v_max3_f32 v14, v24, v25, v26
  v_max3_f32 v14, v14, v27, v28
  v_fma_f32 v22, v22, s24, v8
  v_fma_f32 v23, v23, s24, v8
  v_max3_f32 v14, v14, v29, v30
  v_max_f32 v14, v14, v31
  v_mov_b32 v15, v14
  v_exp_f32 v22, v22
  s_nop 0
  v_permlane16_swap_b32 v14, v15
  v_max_f32 v14, v14, v15
  v_mov_b32 v15, v14
  v_exp_f32 v23, v23
  s_nop 0
  v_permlane32_swap_b32 v14, v15
  v_max_f32 v14, v14, v15
  v_cvt_pk_bf16_f32 v34, v20, v21
  v_cvt_pk_bf16_f32 v35, v22, v23
  v_mul_f32 v9, s25, v14
  s_add_u32 m0, s33, 16384
  s_nop 0
  buffer_load_dwordx4 v4, s[4:7], s21 offen nt lds
  buffer_load_dwordx4 v4, s[4:7], s21 offen offset:1024 nt lds
  buffer_load_dwordx4 v4, s[4:7], s21 offen offset:2048 nt lds
  buffer_load_dwordx4 v4, s[4:7], s21 offen offset:3072 nt lds
  s_add_u32 s21, s21, 4096
  s_waitcnt vmcnt(8)
  ds_read_b128 a[32:35], v3 offset:8192
  ds_read_b128 a[36:39], v3 offset:8448
  ds_read_b128 a[40:43], v3 offset:8704
  ds_read_b128 a[44:47], v3 offset:8960
  s_waitcnt lgkmcnt(0)
  v_mfma_f32_16x16x32_bf16 v[16:19], a[96:99], a[32:35], 0
  ds_read_b128 a[144:147], v1 offset:26624
  v_fma_f32 v24, v24, s24, v9
  v_mfma_f32_16x16x32_bf16 v[16:19], a[100:103], a[36:39], v[16:19]
  v_exp_f32 v24, v24
  v_mfma_f32_16x16x32_bf16 v[16:19], a[104:107], a[40:43], v[16:19]
  ds_read_b128 a[148:151], v1 offset:26880
  v_fma_f32 v25, v25, s24, v9
  v_mfma_f32_16x16x32_bf16 v[16:19], a[108:111], a[44:47], v[16:19]
  v_exp_f32 v25, v25
  v_mfma_f32_16x16x32_bf16 v[20:23], a[124:127], a[44:47], 0
  ds_read_b128 a[152:155], v1 offset:27136
  v_fma_f32 v26, v26, s24, v9
  v_mfma_f32_16x16x32_bf16 v[20:23], a[120:123], a[40:43], v[20:23]
  v_exp_f32 v26, v26
  v_mfma_f32_16x16x32_bf16 v[20:23], a[116:119], a[36:39], v[20:23]
  ds_read_b128 a[156:159], v1 offset:27392
  v_fma_f32 v27, v27, s24, v9
  v_mfma_f32_16x16x32_bf16 v[20:23], a[112:115], a[32:35], v[20:23]
  v_exp_f32 v27, v27
  v_mfma_f32_16x16x32_bf16 v[64:67], a[160:163], v[32:35], 0
  v_fma_f32 v28, v28, s24, v9
  v_cvt_pk_bf16_f32 v36, v24, v25
  v_mfma_f32_16x16x32_bf16 v[68:71], a[164:167], v[32:35], 0
  v_exp_f32 v28, v28
  v_mfma_f32_16x16x32_bf16 v[72:75], a[168:171], v[32:35], 0
  v_fma_f32 v29, v29, s24, v9
  v_cvt_pk_bf16_f32 v37, v26, v27
  v_mfma_f32_16x16x32_bf16 v[76:79], a[172:175], v[32:35], 0
  v_exp_f32 v29, v29
  v_max3_f32 v14, v16, v17, v18
  v_max3_f32 v14, v14, v19, v20
  v_mfma_f32_16x16x32_bf16 v[80:83], a[176:179], v[32:35], 0
  v_fma_f32 v30, v30, s24, v9
  v_fma_f32 v31, v31, s24, v9
  v_max3_f32 v14, v14, v21, v22
  v_max_f32 v14, v14, v23
  v_mov_b32 v15, v14
  v_mfma_f32_16x16x32_bf16 v[84:87], a[180:183], v[32:35], 0
  v_exp_f32 v30, v30
  v_permlane16_swap_b32 v14, v15
  v_max_f32 v14, v14, v15
  v_mov_b32 v15, v14
  v_mfma_f32_16x16x32_bf16 v[88:91], a[184:187], v[32:35], 0
  v_exp_f32 v31, v31
  v_permlane32_swap_b32 v14, v15
  v_max_f32 v14, v14, v15
  v_mfma_f32_16x16x32_bf16 v[92:95], a[188:191], v[32:35], 0
  v_cvt_pk_bf16_f32 v38, v28, v29
  v_cvt_pk_bf16_f32 v39, v30, v31
  v_mul_f32 v10, s25, v14
  s_add_u32 m0, s33, 20480
  s_nop 0
  buffer_load_dwordx4 v4, s[4:7], s21 offen nt lds
  buffer_load_dwordx4 v4, s[4:7], s21 offen offset:1024 nt lds
  buffer_load_dwordx4 v4, s[4:7], s21 offen offset:2048 nt lds
  buffer_load_dwordx4 v4, s[4:7], s21 offen offset:3072 nt lds
  s_add_u32 s21, s21, 25145344
  s_mov_b64 exec, 0
  s_cmp_eq_u32 s34, 0
  s_cbranch_scc1 L_pad0
  s_cmp_eq_u32 s34, 1
  s_cbranch_scc1 L_pad3
  s_cmp_eq_u32 s34, 2
  s_cbranch_scc1 L_pad6
  s_branch L_pad9
L_padret:
  s_mov_b64 exec, -1
  s_nop 3
  s_waitcnt vmcnt(8)
  ds_read_b128 a[48:51], v3 offset:12288
  ds_read_b128 a[52:55], v3 offset:12544
  ds_read_b128 a[56:59], v3 offset:12800
  ds_read_b128 a[60:63], v3 offset:13056
  s_waitcnt lgkmcnt(0)
  v_mfma_f32_16x16x32_bf16 v[24:27], a[96:99], a[48:51], 0
  ds_read_b64_tr_b16 a[192:193], v2 offset:16384
  v_fma_f32 v16, v16, s24, v10
  v_smfmac_f32_16x16x64_bf16 v[40:43], a[224:227], v[32:39], v7
  v_mfma_f32_16x16x32_bf16 v[24:27], a[100:103], a[52:55], v[24:27]
  v_exp_f32 v16, v16
  v_mfma_f32_16x16x32_bf16 v[24:27], a[104:107], a[56:59], v[24:27]
  ds_read_b64_tr_b16 a[194:195], v2 offset:24576
  v_fma_f32 v17, v17, s24, v10
  v_mfma_f32_16x16x32_bf16 v[24:27], a[108:111], a[60:63], v[24:27]
  v_exp_f32 v17, v17
  v_mfma_f32_16x16x32_bf16 v[28:31], a[124:127], a[60:63], 0
  ds_read_b64_tr_b16 a[196:197], v2 offset:16392
  v_fma_f32 v18, v18, s24, v10
  v_mfma_f32_16x16x32_bf16 v[28:31], a[120:123], a[56:59], v[28:31]
  v_exp_f32 v18, v18
  v_mfma_f32_16x16x32_bf16 v[28:31], a[116:119], a[52:55], v[28:31]
  ds_read_b64_tr_b16 a[198:199], v2 offset:24584
  v_fma_f32 v19, v19, s24, v10
  v_mfma_f32_16x16x32_bf16 v[28:31], a[112:115], a[48:51], v[28:31]
  v_exp_f32 v19, v19
  v_mfma_f32_16x16x32_bf16 v[96:99], a[160:163], v[36:39], 0
  v_fma_f32 v20, v20, s24, v10
  v_cvt_pk_bf16_f32 v32, v16, v17
  v_mfma_f32_16x16x32_bf16 v[100:103], a[164:167], v[36:39], 0
  v_exp_f32 v20, v20
  v_mfma_f32_16x16x32_bf16 v[104:107], a[168:171], v[36:39], 0
  v_fma_f32 v21, v21, s24, v10
  v_cvt_pk_bf16_f32 v33, v18, v19
  v_mfma_f32_16x16x32_bf16 v[108:111], a[172:175], v[36:39], 0
  v_exp_f32 v21, v21
  v_max3_f32 v14, v24, v25, v26
  v_max3_f32 v14, v14, v27, v28
  v_mfma_f32_16x16x32_bf16 v[112:115], a[176:179], v[36:39], 0
  v_fma_f32 v22, v22, s24, v10
  v_fma_f32 v23, v23, s24, v10
  v_max3_f32 v14, v14, v29, v30
  v_max_f32 v14, v14, v31
  v_mov_b32 v15, v14
  v_mfma_f32_16x16x32_bf16 v[116:119], a[180:183], v[36:39], 0
  v_exp_f32 v22, v22
  v_permlane16_swap_b32 v14, v15
  v_max_f32 v14, v14, v15
  v_mov_b32 v15, v14
  v_mfma_f32_16x16x32_bf16 v[120:123], a[184:187], v[36:39], 0
  v_exp_f32 v23, v23
  v_permlane32_swap_b32 v14, v15
  v_max_f32 v14, v14, v15
  v_mfma_f32_16x16x32_bf16 v[124:127], a[188:191], v[36:39], 0
  v_cvt_pk_bf16_f32 v34, v20, v21
  v_cvt_pk_bf16_f32 v35, v22, v23
  v_mul_f32 v11, s25, v14
  s_add_u32 m0, s32, 32768
  s_nop 0
  buffer_load_dwordx4 v5, s[8:11], s20 offen offset:2048 lds
  buffer_load_dwordx4 v5, s[8:11], s20 offen offset:3072 lds
  buffer_load_dwordx4 v4, s[12:15], s20 offen lds
  buffer_load_dwordx4 v4, s[12:15], s20 offen offset:1024 lds
  s_add_u32 s20, s20, 8192
  s_waitcnt vmcnt(8)
  ds_read_b128 a[64:67], v3 offset:16384
  ds_read_b128 a[68:71], v3 offset:16640
  ds_read_b128 a[72:75], v3 offset:16896
  ds_read_b128 a[76:79], v3 offset:17152
  s_waitcnt lgkmcnt(0)
  v_mfma_f32_16x16x32_bf16 v[16:19], a[96:99], a[64:67], 0
  ds_read_b64_tr_b16 a[200:201], v2 offset:16640
  v_fma_f32 v24, v24, s24, v11
  v_mfma_f32_16x16x32_bf16 v[16:19], a[100:103], a[68:71], v[16:19]
  v_exp_f32 v24, v24
  v_mfma_f32_16x16x32_bf16 v[16:19], a[104:107], a[72:75], v[16:19]
  ds_read_b64_tr_b16 a[202:203], v2 offset:24832
  v_fma_f32 v25, v25, s24, v11
  v_mfma_f32_16x16x32_bf16 v[16:19], a[108:111], a[76:79], v[16:19]
  v_exp_f32 v25, v25
  v_mfma_f32_16x16x32_bf16 v[20:23], a[124:127], a[76:79], 0
  ds_read_b64_tr_b16 a[204:205], v2 offset:16648
  v_fma_f32 v26, v26, s24, v11
  v_mfma_f32_16x16x32_bf16 v[20:23], a[120:123], a[72:75], v[20:23]
  v_exp_f32 v26, v26
  v_mfma_f32_16x16x32_bf16 v[20:23], a[116:119], a[68:71], v[20:23]
  ds_read_b64_tr_b16 a[206:207], v2 offset:24840
  v_fma_f32 v27, v27, s24, v11
  v_mfma_f32_16x16x32_bf16 v[20:23], a[112:115], a[64:67], v[20:23]
  v_exp_f32 v27, v27
  v_mfma_f32_16x16x32_bf16 v[128:131], a[160:163], v[32:35], 0
  v_fma_f32 v28, v28, s24, v11
  v_cvt_pk_bf16_f32 v36, v24, v25
  v_mfma_f32_16x16x32_bf16 v[132:135], a[164:167], v[32:35], 0
  v_exp_f32 v28, v28
  v_mfma_f32_16x16x32_bf16 v[136:139], a[168:171], v[32:35], 0
  v_fma_f32 v29, v29, s24, v11
  v_cvt_pk_bf16_f32 v37, v26, v27
  v_mfma_f32_16x16x32_bf16 v[140:143], a[172:175], v[32:35], 0
  v_exp_f32 v29, v29
  v_max3_f32 v14, v16, v17, v18
  v_max3_f32 v14, v14, v19, v20
  v_mfma_f32_16x16x32_bf16 v[144:147], a[176:179], v[32:35], 0
  v_fma_f32 v30, v30, s24, v11
  v_fma_f32 v31, v31, s24, v11
  v_max3_f32 v14, v14, v21, v22
  v_max_f32 v14, v14, v23
  v_mov_b32 v15, v14
  v_mfma_f32_16x16x32_bf16 v[148:151], a[180:183], v[32:35], 0
  v_exp_f32 v30, v30
  v_permlane16_swap_b32 v14, v15
  v_max_f32 v14, v14, v15
  v_mov_b32 v15, v14
  v_mfma_f32_16x16x32_bf16 v[152:155], a[184:187], v[32:35], 0
  v_exp_f32 v31, v31
  v_permlane32_swap_b32 v14, v15
  v_max_f32 v14, v14, v15
  v_mfma_f32_16x16x32_bf16 v[156:159], a[188:191], v[32:35], 0
  v_cvt_pk_bf16_f32 v38, v28, v29
  v_cvt_pk_bf16_f32 v39, v30, v31
  v_mul_f32 v12, s25, v14
  s_add_u32 m0, s32, 49152
  s_nop 0
  buffer_load_dwordx4 v5, s[8:11], s20 offen offset:2048 lds
  buffer_load_dwordx4 v5, s[8:11], s20 offen offset:3072 lds
  buffer_load_dwordx4 v4, s[12:15], s20 offen lds
  buffer_load_dwordx4 v4, s[12:15], s20 offen offset:1024 lds
  s_add_u32 s20, s20, 8192
  s_waitcnt vmcnt(8)
  ds_read_b128 a[80:83], v3 offset:20480
  ds_read_b128 a[84:87], v3 offset:20736
  ds_read_b128 a[88:91], v3 offset:20992
  ds_read_b128 a[92:95], v3 offset:21248
  s_waitcnt lgkmcnt(0)
  v_mfma_f32_16x16x32_bf16 v[24:27], a[96:99], a[80:83], 0
  ds_read_b64_tr_b16 a[208:209], v2 offset:16896
  v_fma_f32 v16, v16, s24, v12
  v_smfmac_f32_16x16x64_bf16 v[44:47], a[224:227], v[32:39], v7
  v_mfma_f32_16x16x32_bf16 v[24:27], a[100:103], a[84:87], v[24:27]
  v_exp_f32 v16, v16
  v_mfma_f32_16x16x32_bf16 v[24:27], a[104:107], a[88:91], v[24:27]
  ds_read_b64_tr_b16 a[210:211], v2 offset:25088
  v_fma_f32 v17, v17, s24, v12
  v_mfma_f32_16x16x32_bf16 v[24:27], a[108:111], a[92:95], v[24:27]
  v_exp_f32 v17, v17
  v_mfma_f32_16x16x32_bf16 v[28:31], a[124:127], a[92:95], 0
  ds_read_b64_tr_b16 a[212:213], v2 offset:16904
  v_fma_f32 v18, v18, s24, v12
  v_mfma_f32_16x16x32_bf16 v[28:31], a[120:123], a[88:91], v[28:31]
  v_exp_f32 v18, v18
  v_mfma_f32_16x16x32_bf16 v[28:31], a[116:119], a[84:87], v[28:31]
  ds_read_b64_tr_b16 a[214:215], v2 offset:25096
  v_fma_f32 v19, v19, s24, v12
  v_mfma_f32_16x16x32_bf16 v[28:31], a[112:115], a[80:83], v[28:31]
  v_exp_f32 v19, v19
  v_mfma_f32_16x16x32_bf16 v[160:163], a[160:163], v[36:39], 0
  v_fma_f32 v20, v20, s24, v12
  v_cvt_pk_bf16_f32 v32, v16, v17
  v_mfma_f32_16x16x32_bf16 v[164:167], a[164:167], v[36:39], 0
  v_exp_f32 v20, v20
  v_mfma_f32_16x16x32_bf16 v[168:171], a[168:171], v[36:39], 0
  v_fma_f32 v21, v21, s24, v12
  v_cvt_pk_bf16_f32 v33, v18, v19
  v_mfma_f32_16x16x32_bf16 v[172:175], a[172:175], v[36:39], 0
  v_exp_f32 v21, v21
  v_max3_f32 v14, v24, v25, v26
  v_max3_f32 v14, v14, v27, v28
  v_mfma_f32_16x16x32_bf16 v[176:179], a[176:179], v[36:39], 0
  v_fma_f32 v22, v22, s24, v12
  v_fma_f32 v23, v23, s24, v12
  v_max3_f32 v14, v14, v29, v30
  v_max_f32 v14, v14, v31
  v_mov_b32 v15, v14
  v_mfma_f32_16x16x32_bf16 v[180:183], a[180:183], v[36:39], 0
  v_exp_f32 v22, v22
  v_permlane16_swap_b32 v14, v15
  v_max_f32 v14, v14, v15
  v_mov_b32 v15, v14
  v_mfma_f32_16x16x32_bf16 v[184:187], a[184:187], v[36:39], 0
  v_exp_f32 v23, v23
  v_permlane32_swap_b32 v14, v15
  v_max_f32 v14, v14, v15
  v_mfma_f32_16x16x32_bf16 v[188:191], a[188:191], v[36:39], 0
  s_waitcnt lgkmcnt(15)
  v_cvt_pk_bf16_f32 v34, v20, v21
  v_cvt_pk_bf16_f32 v35, v22, v23
  v_mul_f32 v13, s25, v14
  s_mov_b32 m0, s32
  s_nop 0
  buffer_load_dwordx4 v5, s[8:11], s20 offen offset:2048 lds
  buffer_load_dwordx4 v5, s[8:11], s20 offen offset:3072 lds
  buffer_load_dwordx4 v4, s[12:15], s20 offen lds
  buffer_load_dwordx4 v4, s[12:15], s20 offen offset:1024 lds
  buffer_load_dword v59, v6, s[16:19], s22 offen
  buffer_load_dword v59, v6, s[16:19], s22 offen
  buffer_load_dword v59, v6, s[16:19], s22 offen
  buffer_load_dword v59, v6, s[16:19], s22 offen
  buffer_load_dword v59, v6, s[16:19], s22 offen
  buffer_load_dword v59, v6, s[16:19], s22 offen
  s_branch L_entry
.p2align 12
L_loop:
  v_mfma_f32_16x16x32_bf16 v[24:27], a[96:99], a[16:19], 0
  s_barrier
  ds_read_b128 a[128:131], v1 offset:18432
  v_fma_f32 v16, v16, s24, v8
  v_smfmac_f32_16x16x64_bf16 v[48:51], a[224:227], v[32:39], v7
  buffer_load_dwordx4 v5, s[8:11], s20 offen offset:2048 lds
  v_mfma_f32_16x16x32_bf16 v[24:27], a[100:103], a[20:23], v[24:27]
L_pad0:
  s_cbranch_execz L_pad1
  v_exp_f32 v16, v16
  v_mfma_f32_16x16x32_bf16 v[24:27], a[104:107], a[24:27], v[24:27]
  ds_read_b128 a[132:135], v1 offset:18688
  v_fma_f32 v17, v17, s24, v8
  v_mfma_f32_16x16x32_bf16 v[24:27], a[108:111], a[28:31], v[24:27]
  v_exp_f32 v17, v17
  v_add_f32 v53, v48, v49
  v_rcp_f32 v52, v53
  v_cmp_ngt_f32 vcc, s26, v53
  v_pk_mul_f32 v[192:193], v[192:193], v[52:53] op_sel_hi:[1,0]
  v_pk_mul_f32 v[194:195], v[194:195], v[52:53] op_sel_hi:[1,0]
  v_pk_mul_f32 v[196:197], v[196:197], v[52:53] op_sel_hi:[1,0]
  v_pk_mul_f32 v[198:199], v[198:199], v[52:53] op_sel_hi:[1,0]
  v_mfma_f32_16x16x32_bf16 v[28:31], a[124:127], a[28:31], 0
  ds_read_b128 a[136:139], v1 offset:18944
  v_fma_f32 v18, v18, s24, v8
  v_mfma_f32_16x16x32_bf16 v[28:31], a[120:123], a[24:27], v[28:31]
  s_or_b64 s[30:31], s[30:31], vcc
  v_exp_f32 v18, v18
  v_cvt_pk_bf16_f32 v192, v192, v193
  v_cvt_pk_bf16_f32 v193, v194, v195
  v_cvt_pk_bf16_f32 v194, v196, v197
  v_cvt_pk_bf16_f32 v195, v198, v199
  v_pk_mul_f32 v[200:201], v[200:201], v[52:53] op_sel_hi:[1,0]
  v_pk_mul_f32 v[202:203], v[202:203], v[52:53] op_sel_hi:[1,0]
  v_pk_mul_f32 v[204:205], v[204:205], v[52:53] op_sel_hi:[1,0]
  v_pk_mul_f32 v[206:207], v[206:207], v[52:53] op_sel_hi:[1,0]
  v_mfma_f32_16x16x32_bf16 v[28:31], a[116:119], a[20:23], v[28:31]
  ds_read_b128 a[140:143], v1 offset:19200
  ds_write_b128 v62, v[192:195] offset:16384
  v_fma_f32 v19, v19, s24, v8
  v_mfma_f32_16x16x32_bf16 v[28:31], a[112:115], a[16:19], v[28:31]
  v_exp_f32 v19, v19
  v_cvt_pk_bf16_f32 v200, v200, v201
  v_cvt_pk_bf16_f32 v201, v202, v203
  v_cvt_pk_bf16_f32 v202, v204, v205
  v_cvt_pk_bf16_f32 v203, v206, v207
  v_pk_mul_f32 v[208:209], v[208:209], v[52:53] op_sel_hi:[1,0]
  v_pk_mul_f32 v[210:211], v[210:211], v[52:53] op_sel_hi:[1,0]
  v_pk_mul_f32 v[212:213], v[212:213], v[52:53] op_sel_hi:[1,0]
  v_pk_mul_f32 v[214:215], v[214:215], v[52:53] op_sel_hi:[1,0]
  v_mfma_f32_16x16x32_bf16 v[224:227], a[192:195], v[36:39], v[224:227]
  s_waitcnt lgkmcnt(8)
  ds_write_b128 v62, v[200:203] offset:17408
  v_fma_f32 v20, v20, s24, v8
  v_cvt_pk_bf16_f32 v32, v16, v17
  v_mfma_f32_16x16x32_bf16 v[228:231], a[196:199], v[36:39], v[228:231]
  buffer_store_dwordx4 a[228:231], v6, s[16:19], s22 offen offset:128 sc1
  ds_read_b128 a[232:235], v63 offset:2560
  v_exp_f32 v20, v20
  v_cvt_pk_bf16_f32 v208, v208, v209
  v_cvt_pk_bf16_f32 v209, v210, v211
  v_cvt_pk_bf16_f32 v210, v212, v213
  v_cvt_pk_bf16_f32 v211, v214, v215
  v_pk_mul_f32 v[216:217], v[216:217], v[52:53] op_sel_hi:[1,0]
  v_pk_mul_f32 v[218:219], v[218:219], v[52:53] op_sel_hi:[1,0]
  v_pk_mul_f32 v[220:221], v[220:221], v[52:53] op_sel_hi:[1,0]
  v_pk_mul_f32 v[222:223], v[222:223], v[52:53] op_sel_hi:[1,0]
  v_mfma_f32_16x16x32_bf16 v[232:235], a[200:203], v[36:39], v[232:235]
  ds_write_b128 v62, v[208:211] offset:18432
  v_fma_f32 v21, v21, s24, v8
  v_cvt_pk_bf16_f32 v33, v18, v19
  v_mfma_f32_16x16x32_bf16 v[236:239], a[204:207], v[36:39], v[236:239]
  v_exp_f32 v21, v21
  v_max3_f32 v14, v24, v25, v26
  v_max3_f32 v14, v14, v27, v28
  v_cvt_pk_bf16_f32 v216, v216, v217
  v_cvt_pk_bf16_f32 v217, v218, v219
  v_cvt_pk_bf16_f32 v218, v220, v221
  v_cvt_pk_bf16_f32 v219, v222, v223
  v_mfma_f32_16x16x32_bf16 v[240:243], a[208:211], v[36:39], v[240:243]
  ds_write_b128 v62, v[216:219] offset:19456
  v_fma_f32 v22, v22, s24, v8
  v_fma_f32 v23, v23, s24, v8
  v_max3_f32 v14, v14, v29, v30
  v_max_f32 v14, v14, v31
  v_mov_b32 v15, v14
  v_mfma_f32_16x16x32_bf16 v[244:247], a[212:215], v[36:39], v[244:247]
  v_exp_f32 v22, v22
  v_permlane16_swap_b32 v14, v15
  v_max_f32 v14, v14, v15
  v_mov_b32 v15, v14
  v_mfma_f32_16x16x32_bf16 v[248:251], a[216:219], v[36:39], v[248:251]
  s_waitcnt lgkmcnt(15)
  v_exp_f32 v23, v23
  v_permlane32_swap_b32 v14, v15
  v_max_f32 v14, v14, v15
  v_mfma_f32_16x16x32_bf16 v[252:255], a[220:223], v[36:39], v[252:255]
  v_cvt_pk_bf16_f32 v34, v20, v21
  v_cvt_pk_bf16_f32 v35, v22, v23
  v_mul_f32 v9, s25, v14
  v_mfma_f32_16x16x32_bf16 v[16:19], a[96:99], a[32:35], 0
  ds_read_b128 a[144:147], v1 offset:26624
  v_fma_f32 v24, v24, s24, v9
  v_mfma_f32_16x16x32_bf16 v[16:19], a[100:103], a[36:39], v[16:19]
  v_exp_f32 v24, v24
  v_mfma_f32_16x16x32_bf16 v[16:19], a[104:107], a[40:43], v[16:19]
  ds_read_b128 a[148:151], v1 offset:26880
  v_fma_f32 v25, v25, s24, v9
  v_mfma_f32_16x16x32_bf16 v[16:19], a[108:111], a[44:47], v[16:19]
  buffer_load_dwordx4 v5, s[8:11], s20 offen offset:3072 lds
  v_exp_f32 v25, v25
  v_add_f32 v53, v50, v51
  v_rcp_f32 v52, v53
  v_cmp_ngt_f32 vcc, s26, v53
  v_pk_mul_f32 v[224:225], v[224:225], v[52:53] op_sel_hi:[1,0]
  v_pk_mul_f32 v[226:227], v[226:227], v[52:53] op_sel_hi:[1,0]
  v_pk_mul_f32 v[228:229], v[228:229], v[52:53] op_sel_hi:[1,0]
  v_pk_mul_f32 v[230:231], v[230:231], v[52:53] op_sel_hi:[1,0]
  v_mfma_f32_16x16x32_bf16 v[20:23], a[124:127], a[44:47], 0
  ds_read_b128 a[152:155], v1 offset:27136
  v_fma_f32 v26, v26, s24, v9
  v_mov_b32 v48, 0
  v_mov_b32 v49, 0
  v_mov_b32 v50, 0
  v_mov_b32 v51, 0
  v_mfma_f32_16x16x32_bf16 v[20:23], a[120:123], a[40:43], v[20:23]
  s_or_b64 s[30:31], s[30:31], vcc
  v_exp_f32 v26, v26
  v_cvt_pk_bf16_f32 v224, v224, v225
  v_cvt_pk_bf16_f32 v225, v226, v227
  v_cvt_pk_bf16_f32 v226, v228, v229
  v_cvt_pk_bf16_f32 v227, v230, v231
  v_pk_mul_f32 v[232:233], v[232:233], v[52:53] op_sel_hi:[1,0]
  v_pk_mul_f32 v[234:235], v[234:235], v[52:53] op_sel_hi:[1,0]
  v_pk_mul_f32 v[236:237], v[236:237], v[52:53] op_sel_hi:[1,0]
  v_pk_mul_f32 v[238:239], v[238:239], v[52:53] op_sel_hi:[1,0]
  v_mfma_f32_16x16x32_bf16 v[20:23], a[116:119], a[36:39], v[20:23]
  ds_read_b128 a[156:159], v1 offset:27392
  ds_write_b128 v62, v[224:227] offset:20480
  v_fma_f32 v27, v27, s24, v9
  v_mfma_f32_16x16x32_bf16 v[20:23], a[112:115], a[32:35], v[20:23]
  v_exp_f32 v27, v27
  v_cvt_pk_bf16_f32 v232, v232, v233
  v_cvt_pk_bf16_f32 v233, v234, v235
  v_cvt_pk_bf16_f32 v234, v236, v237
  v_cvt_pk_bf16_f32 v235, v238, v239
  v_pk_mul_f32 v[240:241], v[240:241], v[52:53] op_sel_hi:[1,0]
  v_pk_mul_f32 v[242:243], v[242:243], v[52:53] op_sel_hi:[1,0]
  v_pk_mul_f32 v[244:245], v[244:245], v[52:53] op_sel_hi:[1,0]
  v_pk_mul_f32 v[246:247], v[246:247], v[52:53] op_sel_hi:[1,0]
  v_mfma_f32_16x16x32_bf16 v[64:67], a[160:163], v[32:35], 0
  s_waitcnt lgkmcnt(7)
  ds_write_b128 v62, v[232:235] offset:21504
  v_fma_f32 v28, v28, s24, v9
  v_cvt_pk_bf16_f32 v36, v24, v25
  v_mfma_f32_16x16x32_bf16 v[68:71], a[164:167], v[32:35], 0
  buffer_store_dwordx4 a[232:235], v6, s[16:19], s22 offen offset:2176 sc1
  ds_read_b128 a[228:231], v63 offset:4096
  v_exp_f32 v28, v28
  v_cvt_pk_bf16_f32 v240, v240, v241
  v_cvt_pk_bf16_f32 v241, v242, v243
  v_cvt_pk_bf16_f32 v242, v244, v245
  v_cvt_pk_bf16_f32 v243, v246, v247
  v_pk_mul_f32 v[248:249], v[248:249], v[52:53] op_sel_hi:[1,0]
  v_pk_mul_f32 v[250:251], v[250:251], v[52:53] op_sel_hi:[1,0]
  v_pk_mul_f32 v[252:253], v[252:253], v[52:53] op_sel_hi:[1,0]
  v_pk_mul_f32 v[254:255], v[254:255], v[52:53] op_sel_hi:[1,0]
  v_mfma_f32_16x16x32_bf16 v[72:75], a[168:171], v[32:35], 0
  s_add_u32 s22, s22, 4096
  ds_write_b128 v62, v[240:243] offset:22528
  v_fma_f32 v29, v29, s24, v9
  v_cvt_pk_bf16_f32 v37, v26, v27
  v_mfma_f32_16x16x32_bf16 v[76:79], a[172:175], v[32:35], 0
  v_exp_f32 v29, v29
  v_max3_f32 v14, v16, v17, v18
  v_max3_f32 v14, v14, v19, v20
  v_cvt_pk_bf16_f32 v248, v248, v249
  v_cvt_pk_bf16_f32 v249, v250, v251
  v_cvt_pk_bf16_f32 v250, v252, v253
  v_cvt_pk_bf16_f32 v251, v254, v255
  v_mfma_f32_16x16x32_bf16 v[80:83], a[176:179], v[32:35], 0
  ds_write_b128 v62, v[248:251] offset:23552
  v_fma_f32 v30, v30, s24, v9
  v_fma_f32 v31, v31, s24, v9
  v_max3_f32 v14, v14, v21, v22
  v_max_f32 v14, v14, v23
  v_mov_b32 v15, v14
  v_mfma_f32_16x16x32_bf16 v[84:87], a[180:183], v[32:35], 0
  v_exp_f32 v30, v30
  v_permlane16_swap_b32 v14, v15
  v_max_f32 v14, v14, v15
  v_mov_b32 v15, v14
  v_mfma_f32_16x16x32_bf16 v[88:91], a[184:187], v[32:35], 0
  s_waitcnt lgkmcnt(15)
  v_exp_f32 v31, v31
  v_permlane32_swap_b32 v14, v15
  v_max_f32 v14, v14, v15
  v_mfma_f32_16x16x32_bf16 v[92:95], a[188:191], v[32:35], 0
  v_cvt_pk_bf16_f32 v38, v28, v29
  v_cvt_pk_bf16_f32 v39, v30, v31
  v_mul_f32 v10, s25, v14
  v_mfma_f32_16x16x32_bf16 v[24:27], a[96:99], a[48:51], 0
  ds_read_b64_tr_b16 a[192:193], v2 offset:16384
  v_fma_f32 v16, v16, s24, v10
  v_smfmac_f32_16x16x64_bf16 v[40:43], a[224:227], v[32:39], v7
  buffer_load_dwordx4 v4, s[12:15], s20 offen lds
  v_mfma_f32_16x16x32_bf16 v[24:27], a[100:103], a[52:55], v[24:27]
  s_cmp_lg_u64 s[30:31], 0
  s_cselect_b32 s35, 1, 0
  v_exp_f32 v16, v16
  v_mfma_f32_16x16x32_bf16 v[24:27], a[104:107], a[56:59], v[24:27]
  ds_read_b64_tr_b16 a[194:195], v2 offset:24576
  v_fma_f32 v17, v17, s24, v10
  v_mfma_f32_16x16x32_bf16 v[24:27], a[108:111], a[60:63], v[24:27]
  s_lshl_b32 s35, s35, s27
  v_exp_f32 v17, v17
  v_mfma_f32_16x16x32_bf16 v[28:31], a[124:127], a[60:63], 0
  ds_read_b64_tr_b16 a[196:197], v2 offset:16392
  v_fma_f32 v18, v18, s24, v10
  v_mfma_f32_16x16x32_bf16 v[28:31], a[120:123], a[56:59], v[28:31]
  s_or_b32 s28, s28, s35
  v_exp_f32 v18, v18
  v_mfma_f32_16x16x32_bf16 v[28:31], a[116:119], a[52:55], v[28:31]
  ds_read_b64_tr_b16 a[198:199], v2 offset:24584
  v_fma_f32 v19, v19, s24, v10
  v_mfma_f32_16x16x32_bf16 v[28:31], a[112:115], a[48:51], v[28:31]
  s_mov_b64 s[30:31], 0
  v_exp_f32 v19, v19
  v_mfma_f32_16x16x32_bf16 v[96:99], a[160:163], v[36:39], 0
  s_waitcnt lgkmcnt(6)
  v_fma_f32 v20, v20, s24, v10
  v_cvt_pk_bf16_f32 v32, v16, v17
  v_mfma_f32_16x16x32_bf16 v[100:103], a[164:167], v[36:39], 0
  s_add_u32 s27, s27, 1
  buffer_store_dwordx4 a[228:231], v6, s[16:19], s22 offen sc1
  ds_read_b128 a[232:235], v63 offset:4608
  v_exp_f32 v20, v20
  v_mfma_f32_16x16x32_bf16 v[104:107], a[168:171], v[36:39], 0
  v_fma_f32 v21, v21, s24, v10
  v_cvt_pk_bf16_f32 v33, v18, v19
  v_mfma_f32_16x16x32_bf16 v[108:111], a[172:175], v[36:39], 0
  v_exp_f32 v21, v21
  v_max3_f32 v14, v24, v25, v26
  v_max3_f32 v14, v14, v27, v28
  v_mfma_f32_16x16x32_bf16 v[112:115], a[176:179], v[36:39], 0
  v_fma_f32 v22, v22, s24, v10
  v_fma_f32 v23, v23, s24, v10
  v_max3_f32 v14, v14, v29, v30
  v_max_f32 v14, v14, v31
  v_mov_b32 v15, v14
  v_mfma_f32_16x16x32_bf16 v[116:119], a[180:183], v[36:39], 0
  v_exp_f32 v22, v22
  v_permlane16_swap_b32 v14, v15
  v_max_f32 v14, v14, v15
  v_mov_b32 v15, v14
  v_mfma_f32_16x16x32_bf16 v[120:123], a[184:187], v[36:39], 0
  s_waitcnt lgkmcnt(15)
  v_exp_f32 v23, v23
  v_permlane32_swap_b32 v14, v15
  v_max_f32 v14, v14, v15
  v_mfma_f32_16x16x32_bf16 v[124:127], a[188:191], v[36:39], 0
  v_cvt_pk_bf16_f32 v34, v20, v21
  v_cvt_pk_bf16_f32 v35, v22, v23
  v_mul_f32 v11, s25, v14
  v_mfma_f32_16x16x32_bf16 v[16:19], a[96:99], a[64:67], 0
  ds_read_b64_tr_b16 a[200:201], v2 offset:16640
  v_fma_f32 v24, v24, s24, v11
  v_mfma_f32_16x16x32_bf16 v[16:19], a[100:103], a[68:71], v[16:19]
  v_exp_f32 v24, v24
  v_mfma_f32_16x16x32_bf16 v[16:19], a[104:107], a[72:75], v[16:19]
  ds_read_b64_tr_b16 a[202:203], v2 offset:24832
  v_fma_f32 v25, v25, s24, v11
  v_mfma_f32_16x16x32_bf16 v[16:19], a[108:111], a[76:79], v[16:19]
  v_exp_f32 v25, v25
  v_mfma_f32_16x16x32_bf16 v[20:23], a[124:127], a[76:79], 0
  ds_read_b64_tr_b16 a[204:205], v2 offset:16648
  v_fma_f32 v26, v26, s24, v11
  v_mfma_f32_16x16x32_bf16 v[20:23], a[120:123], a[72:75], v[20:23]
  v_exp_f32 v26, v26
  v_mfma_f32_16x16x32_bf16 v[20:23], a[116:119], a[68:71], v[20:23]
  ds_read_b64_tr_b16 a[206:207], v2 offset:24840
  v_fma_f32 v27, v27, s24, v11
  v_mfma_f32_16x16x32_bf16 v[20:23], a[112:115], a[64:67], v[20:23]
  v_exp_f32 v27, v27
  v_mfma_f32_16x16x32_bf16 v[128:131], a[160:163], v[32:35], 0
  v_fma_f32 v28, v28, s24, v11
  v_cvt_pk_bf16_f32 v36, v24, v25
  v_mfma_f32_16x16x32_bf16 v[132:135], a[164:167], v[32:35], 0
  v_exp_f32 v28, v28
  v_mfma_f32_16x16x32_bf16 v[136:139], a[168:171], v[32:35], 0
  v_fma_f32 v29, v29, s24, v11
  v_cvt_pk_bf16_f32 v37, v26, v27
  v_mfma_f32_16x16x32_bf16 v[140:143], a[172:175], v[32:35], 0
  v_exp_f32 v29, v29
  v_max3_f32 v14, v16, v17, v18
  v_max3_f32 v14, v14, v19, v20
  v_mfma_f32_16x16x32_bf16 v[144:147], a[176:179], v[32:35], 0
  v_fma_f32 v30, v30, s24, v11
  v_fma_f32 v31, v31, s24, v11
  v_max3_f32 v14, v14, v21, v22
  v_max_f32 v14, v14, v23
  v_mov_b32 v15, v14
  v_mfma_f32_16x16x32_bf16 v[148:151], a[180:183], v[32:35], 0
  v_exp_f32 v30, v30
  v_permlane16_swap_b32 v14, v15
  v_max_f32 v14, v14, v15
  v_mov_b32 v15, v14
  v_mfma_f32_16x16x32_bf16 v[152:155], a[184:187], v[32:35], 0
  s_waitcnt lgkmcnt(15)
  v_exp_f32 v31, v31
  v_permlane32_swap_b32 v14, v15
  v_max_f32 v14, v14, v15
  v_mfma_f32_16x16x32_bf16 v[156:159], a[188:191], v[32:35], 0
  v_cvt_pk_bf16_f32 v38, v28, v29
  v_cvt_pk_bf16_f32 v39, v30, v31
  v_mul_f32 v12, s25, v14
  v_mfma_f32_16x16x32_bf16 v[24:27], a[96:99], a[80:83], 0
  ds_read_b64_tr_b16 a[208:209], v2 offset:16896
  v_fma_f32 v16, v16, s24, v12
  v_smfmac_f32_16x16x64_bf16 v[44:47], a[224:227], v[32:39], v7
  buffer_load_dwordx4 v4, s[12:15], s20 offen offset:1024 lds
  v_mfma_f32_16x16x32_bf16 v[24:27], a[100:103], a[84:87], v[24:27]
  v_exp_f32 v16, v16
  v_mfma_f32_16x16x32_bf16 v[24:27], a[104:107], a[88:91], v[24:27]
  ds_read_b64_tr_b16 a[210:211], v2 offset:25088
  v_fma_f32 v17, v17, s24, v12
  v_mfma_f32_16x16x32_bf16 v[24:27], a[108:111], a[92:95], v[24:27]
  v_exp_f32 v17, v17
  v_mfma_f32_16x16x32_bf16 v[28:31], a[124:127], a[92:95], 0
  ds_read_b64_tr_b16 a[212:213], v2 offset:16904
  v_fma_f32 v18, v18, s24, v12
  v_mfma_f32_16x16x32_bf16 v[28:31], a[120:123], a[88:91], v[28:31]
  v_exp_f32 v18, v18
  v_mfma_f32_16x16x32_bf16 v[28:31], a[116:119], a[84:87], v[28:31]
  ds_read_b64_tr_b16 a[214:215], v2 offset:25096
  v_fma_f32 v19, v19, s24, v12
  v_mfma_f32_16x16x32_bf16 v[28:31], a[112:115], a[80:83], v[28:31]
  v_exp_f32 v19, v19
  v_mfma_f32_16x16x32_bf16 v[160:163], a[160:163], v[36:39], 0
  s_waitcnt lgkmcnt(8)
  v_fma_f32 v20, v20, s24, v12
  v_cvt_pk_bf16_f32 v32, v16, v17
  v_mfma_f32_16x16x32_bf16 v[164:167], a[164:167], v[36:39], 0
  buffer_store_dwordx4 a[232:235], v6, s[16:19], s22 offen offset:2048 sc1
  ds_read_b128 a[228:231], v63 offset:6144
  v_exp_f32 v20, v20
  v_mfma_f32_16x16x32_bf16 v[168:171], a[168:171], v[36:39], 0
  v_fma_f32 v21, v21, s24, v12
  v_cvt_pk_bf16_f32 v33, v18, v19
  v_mfma_f32_16x16x32_bf16 v[172:175], a[172:175], v[36:39], 0
  v_exp_f32 v21, v21
  v_max3_f32 v14, v24, v25, v26
  v_max3_f32 v14, v14, v27, v28
  v_mfma_f32_16x16x32_bf16 v[176:179], a[176:179], v[36:39], 0
  v_fma_f32 v22, v22, s24, v12
  v_fma_f32 v23, v23, s24, v12
  v_max3_f32 v14, v14, v29, v30
  v_max_f32 v14, v14, v31
  v_mov_b32 v15, v14
  v_mfma_f32_16x16x32_bf16 v[180:183], a[180:183], v[36:39], 0
  v_exp_f32 v22, v22
  v_permlane16_swap_b32 v14, v15
  v_max_f32 v14, v14, v15
  v_mov_b32 v15, v14
  v_mfma_f32_16x16x32_bf16 v[184:187], a[184:187], v[36:39], 0
  v_exp_f32 v23, v23
  v_permlane32_swap_b32 v14, v15
  v_max_f32 v14, v14, v15
  v_mfma_f32_16x16x32_bf16 v[188:191], a[188:191], v[36:39], 0
  s_waitcnt lgkmcnt(15)
  v_cvt_pk_bf16_f32 v34, v20, v21
  v_cvt_pk_bf16_f32 v35, v22, v23
  v_mul_f32 v13, s25, v14
L_entry:
  v_mfma_f32_16x16x32_bf16 v[16:19], a[128:131], a[0:3], 0
L_pad1:
  s_cbranch_execz L_pad2
  ds_read_b64_tr_b16 a[216:217], v2 offset:17152
  v_fma_f32 v24, v24, s24, v13
  v_mfma_f32_16x16x32_bf16 v[16:19], a[132:135], a[4:7], v[16:19]
  v_exp_f32 v24, v24
  v_mfma_f32_16x16x32_bf16 v[16:19], a[136:139], a[8:11], v[16:19]
  ds_read_b64_tr_b16 a[218:219], v2 offset:25344
  v_fma_f32 v25, v25, s24, v13
  v_mfma_f32_16x16x32_bf16 v[16:19], a[140:143], a[12:15], v[16:19]
  v_exp_f32 v25, v25
  v_mfma_f32_16x16x32_bf16 v[20:23], a[156:159], a[12:15], 0
  ds_read_b64_tr_b16 a[220:221], v2 offset:17160
  v_fma_f32 v26, v26, s24, v13
  v_mfma_f32_16x16x32_bf16 v[20:23], a[152:155], a[8:11], v[20:23]
  v_exp_f32 v26, v26
  v_mfma_f32_16x16x32_bf16 v[20:23], a[148:151], a[4:7], v[20:23]
  ds_read_b64_tr_b16 a[222:223], v2 offset:25352
  v_fma_f32 v27, v27, s24, v13
  v_mfma_f32_16x16x32_bf16 v[20:23], a[144:147], a[0:3], v[20:23]
  v_exp_f32 v27, v27
  v_mfma_f32_16x16x32_bf16 v[192:195], a[160:163], v[32:35], 0
  s_waitcnt lgkmcnt(4)
  v_fma_f32 v28, v28, s24, v13
  v_cvt_pk_bf16_f32 v36, v24, v25
  v_mfma_f32_16x16x32_bf16 v[196:199], a[164:167], v[32:35], 0
  buffer_store_dwordx4 a[228:231], v6, s[16:19], s22 offen offset:128 sc1
  ds_read_b128 a[232:235], v63 offset:6656
  v_exp_f32 v28, v28
  v_mfma_f32_16x16x32_bf16 v[200:203], a[168:171], v[32:35], 0
  v_fma_f32 v29, v29, s24, v13
  v_cvt_pk_bf16_f32 v37, v26, v27
  v_mfma_f32_16x16x32_bf16 v[204:207], a[172:175], v[32:35], 0
  v_exp_f32 v29, v29
  v_mfma_f32_16x16x32_bf16 v[208:211], a[176:179], v[32:35], 0
  s_add_u32 s20, s20, 8192
  v_fma_f32 v30, v30, s24, v13
  v_fma_f32 v31, v31, s24, v13
  v_mfma_f32_16x16x32_bf16 v[212:215], a[180:183], v[32:35], 0
  v_exp_f32 v30, v30
  v_mfma_f32_16x16x32_bf16 v[216:219], a[184:187], v[32:35], 0
  s_add_u32 m0, s32, 16384
  v_exp_f32 v31, v31
  v_mfma_f32_16x16x32_bf16 v[220:223], a[188:191], v[32:35], 0
  s_waitcnt vmcnt(15) lgkmcnt(0)
  v_cvt_pk_bf16_f32 v38, v28, v29
  v_cvt_pk_bf16_f32 v39, v30, v31
  v_mfma_f32_16x16x32_bf16 v[24:27], a[128:131], a[16:19], 0
  s_barrier
  ds_read_b128 a[96:99], v1 offset:34816
  v_fma_f32 v16, v16, s24, v8
  v_smfmac_f32_16x16x64_bf16 v[48:51], a[224:227], v[32:39], v7
  buffer_load_dwordx4 v5, s[8:11], s20 offen offset:2048 lds
  v_mfma_f32_16x16x32_bf16 v[24:27], a[132:135], a[20:23], v[24:27]
  v_exp_f32 v16, v16
  v_mfma_f32_16x16x32_bf16 v[24:27], a[136:139], a[24:27], v[24:27]
  ds_read_b128 a[100:103], v1 offset:35072
  v_fma_f32 v17, v17, s24, v8
  v_mfma_f32_16x16x32_bf16 v[24:27], a[140:143], a[28:31], v[24:27]
  v_exp_f32 v17, v17
  v_mfma_f32_16x16x32_bf16 v[28:31], a[156:159], a[28:31], 0
  ds_read_b128 a[104:107], v1 offset:35328
  v_fma_f32 v18, v18, s24, v8
  v_mfma_f32_16x16x32_bf16 v[28:31], a[152:155], a[24:27], v[28:31]
  v_exp_f32 v18, v18
  v_mfma_f32_16x16x32_bf16 v[28:31], a[148:151], a[20:23], v[28:31]
  ds_read_b128 a[108:111], v1 offset:35584
  v_fma_f32 v19, v19, s24, v8
  v_mfma_f32_16x16x32_bf16 v[28:31], a[144:147], a[16:19], v[28:31]
  v_exp_f32 v19, v19
  v_mfma_f32_16x16x32_bf16 v[224:227], a[160:163], v[36:39], 0
  v_fma_f32 v20, v20, s24, v8
  v_cvt_pk_bf16_f32 v32, v16, v17
  v_mfma_f32_16x16x32_bf16 v[228:231], a[164:167], v[36:39], 0
  v_exp_f32 v20, v20
  v_mfma_f32_16x16x32_bf16 v[232:235], a[168:171], v[36:39], 0
  v_fma_f32 v21, v21, s24, v8
  v_cvt_pk_bf16_f32 v33, v18, v19
  v_mfma_f32_16x16x32_bf16 v[236:239], a[172:175], v[36:39], 0
  v_exp_f32 v21, v21
  v_mfma_f32_16x16x32_bf16 v[240:243], a[176:179], v[36:39], 0
  v_fma_f32 v22, v22, s24, v8
  v_fma_f32 v23, v23, s24, v8
  v_mfma_f32_16x16x32_bf16 v[244:247], a[180:183], v[36:39], 0
  v_exp_f32 v22, v22
  v_mfma_f32_16x16x32_bf16 v[248:251], a[184:187], v[36:39], 0
  v_exp_f32 v23, v23
  v_mfma_f32_16x16x32_bf16 v[252:255], a[188:191], v[36:39], 0
  v_cvt_pk_bf16_f32 v34, v20, v21
  v_cvt_pk_bf16_f32 v35, v22, v23
  v_mfma_f32_16x16x32_bf16 v[16:19], a[128:131], a[32:35], 0
  ds_read_b128 a[112:115], v1 offset:43008
  v_fma_f32 v24, v24, s24, v9
  v_mfma_f32_16x16x32_bf16 v[16:19], a[132:135], a[36:39], v[16:19]
  v_exp_f32 v24, v24
  v_mfma_f32_16x16x32_bf16 v[16:19], a[136:139], a[40:43], v[16:19]
  ds_read_b128 a[116:119], v1 offset:43264
  v_fma_f32 v25, v25, s24, v9
  v_mfma_f32_16x16x32_bf16 v[16:19], a[140:143], a[44:47], v[16:19]
  buffer_load_dwordx4 v5, s[8:11], s20 offen offset:3072 lds
  v_exp_f32 v25, v25
  v_mfma_f32_16x16x32_bf16 v[20:23], a[156:159], a[44:47], 0
  ds_read_b128 a[120:123], v1 offset:43520
  v_fma_f32 v26, v26, s24, v9
  v_mfma_f32_16x16x32_bf16 v[20:23], a[152:155], a[40:43], v[20:23]
  v_exp_f32 v26, v26
  v_mfma_f32_16x16x32_bf16 v[20:23], a[148:151], a[36:39], v[20:23]
  ds_read_b128 a[124:127], v1 offset:43776
  v_fma_f32 v27, v27, s24, v9
  v_mfma_f32_16x16x32_bf16 v[20:23], a[144:147], a[32:35], v[20:23]
  v_exp_f32 v27, v27
  v_mfma_f32_16x16x32_bf16 v[64:67], a[192:195], v[32:35], v[64:67]
  s_waitcnt lgkmcnt(8)
  v_fma_f32 v28, v28, s24, v9
  v_cvt_pk_bf16_f32 v36, v24, v25
  v_mfma_f32_16x16x32_bf16 v[68:71], a[196:199], v[32:35], v[68:71]
  buffer_store_dwordx4 a[232:235], v6, s[16:19], s22 offen offset:2176 sc1
  ds_read_b128 a[228:231], v63 offset:8192
  v_exp_f32 v28, v28
  v_mfma_f32_16x16x32_bf16 v[72:75], a[200:203], v[32:35], v[72:75]
  s_add_u32 s22, s22, 4096
  v_fma_f32 v29, v29, s24, v9
  v_cvt_pk_bf16_f32 v37, v26, v27
  v_mfma_f32_16x16x32_bf16 v[76:79], a[204:207], v[32:35], v[76:79]
  v_exp_f32 v29, v29
  v_mfma_f32_16x16x32_bf16 v[80:83], a[208:211], v[32:35], v[80:83]
  v_fma_f32 v30, v30, s24, v9
  v_fma_f32 v31, v31, s24, v9
  v_mfma_f32_16x16x32_bf16 v[84:87], a[212:215], v[32:35], v[84:87]
  v_exp_f32 v30, v30
  v_mfma_f32_16x16x32_bf16 v[88:91], a[216:219], v[32:35], v[88:91]
  v_exp_f32 v31, v31
  v_mfma_f32_16x16x32_bf16 v[92:95], a[220:223], v[32:35], v[92:95]
  v_cvt_pk_bf16_f32 v38, v28, v29
  v_cvt_pk_bf16_f32 v39, v30, v31
  v_mfma_f32_16x16x32_bf16 v[24:27], a[128:131], a[48:51], 0
  ds_read_b64_tr_b16 a[160:161], v2 offset:32768
  v_fma_f32 v16, v16, s24, v10
  v_smfmac_f32_16x16x64_bf16 v[40:43], a[224:227], v[32:39], v7
  buffer_load_dwordx4 v4, s[12:15], s20 offen lds
  v_mfma_f32_16x16x32_bf16 v[24:27], a[132:135], a[52:55], v[24:27]
  v_exp_f32 v16, v16
  v_mfma_f32_16x16x32_bf16 v[24:27], a[136:139], a[56:59], v[24:27]
  ds_read_b64_tr_b16 a[162:163], v2 offset:40960
  v_fma_f32 v17, v17, s24, v10
  v_mfma_f32_16x16x32_bf16 v[24:27], a[140:143], a[60:63], v[24:27]
  v_exp_f32 v17, v17
  v_mfma_f32_16x16x32_bf16 v[28:31], a[156:159], a[60:63], 0
  ds_read_b64_tr_b16 a[164:165], v2 offset:32776
  v_fma_f32 v18, v18, s24, v10
  v_mfma_f32_16x16x32_bf16 v[28:31], a[152:155], a[56:59], v[28:31]
  v_exp_f32 v18, v18
  v_mfma_f32_16x16x32_bf16 v[28:31], a[148:151], a[52:55], v[28:31]
  ds_read_b64_tr_b16 a[166:167], v2 offset:40968
  v_fma_f32 v19, v19, s24, v10
  v_mfma_f32_16x16x32_bf16 v[28:31], a[144:147], a[48:51], v[28:31]
  v_exp_f32 v19, v19
  v_mfma_f32_16x16x32_bf16 v[96:99], a[192:195], v[36:39], v[96:99]
  v_fma_f32 v20, v20, s24, v10
  v_cvt_pk_bf16_f32 v32, v16, v17
  v_mfma_f32_16x16x32_bf16 v[100:103], a[196:199], v[36:39], v[100:103]
  v_exp_f32 v20, v20
  v_mfma_f32_16x16x32_bf16 v[104:107], a[200:203], v[36:39], v[104:107]
  v_fma_f32 v21, v21, s24, v10
  v_cvt_pk_bf16_f32 v33, v18, v19
  v_mfma_f32_16x16x32_bf16 v[108:111], a[204:207], v[36:39], v[108:111]
  v_exp_f32 v21, v21
  v_mfma_f32_16x16x32_bf16 v[112:115], a[208:211], v[36:39], v[112:115]
  v_fma_f32 v22, v22, s24, v10
  v_fma_f32 v23, v23, s24, v10
  v_mfma_f32_16x16x32_bf16 v[116:119], a[212:215], v[36:39], v[116:119]
  v_exp_f32 v22, v22
  v_mfma_f32_16x16x32_bf16 v[120:123], a[216:219], v[36:39], v[120:123]
  v_exp_f32 v23, v23
  v_mfma_f32_16x16x32_bf16 v[124:127], a[220:223], v[36:39], v[124:127]
  v_cvt_pk_bf16_f32 v34, v20, v21
  v_cvt_pk_bf16_f32 v35, v22, v23
  v_mfma_f32_16x16x32_bf16 v[16:19], a[128:131], a[64:67], 0
  ds_read_b64_tr_b16 a[168:169], v2 offset:33024
  v_fma_f32 v24, v24, s24, v11
  v_mfma_f32_16x16x32_bf16 v[16:19], a[132:135], a[68:71], v[16:19]
  v_exp_f32 v24, v24
  v_mfma_f32_16x16x32_bf16 v[16:19], a[136:139], a[72:75], v[16:19]
  ds_read_b64_tr_b16 a[170:171], v2 offset:41216
  v_fma_f32 v25, v25, s24, v11
  v_mfma_f32_16x16x32_bf16 v[16:19], a[140:143], a[76:79], v[16:19]
  v_exp_f32 v25, v25
  v_mfma_f32_16x16x32_bf16 v[20:23], a[156:159], a[76:79], 0
  ds_read_b64_tr_b16 a[172:173], v2 offset:33032
  v_fma_f32 v26, v26, s24, v11
  v_mfma_f32_16x16x32_bf16 v[20:23], a[152:155], a[72:75], v[20:23]
  v_exp_f32 v26, v26
  v_mfma_f32_16x16x32_bf16 v[20:23], a[148:151], a[68:71], v[20:23]
  ds_read_b64_tr_b16 a[174:175], v2 offset:41224
  v_fma_f32 v27, v27, s24, v11
  v_mfma_f32_16x16x32_bf16 v[20:23], a[144:147], a[64:67], v[20:23]
  v_exp_f32 v27, v27
  v_mfma_f32_16x16x32_bf16 v[128:131], a[192:195], v[32:35], v[128:131]
  s_waitcnt lgkmcnt(8)
  v_fma_f32 v28, v28, s24, v11
  v_cvt_pk_bf16_f32 v36, v24, v25
  v_mfma_f32_16x16x32_bf16 v[132:135], a[196:199], v[32:35], v[132:135]
  buffer_store_dwordx4 a[228:231], v6, s[16:19], s22 offen sc1
  ds_read_b128 a[232:235], v63 offset:8704
  v_exp_f32 v28, v28
  v_mfma_f32_16x16x32_bf16 v[136:139], a[200:203], v[32:35], v[136:139]
  v_fma_f32 v29, v29, s24, v11
  v_cvt_pk_bf16_f32 v37, v26, v27
  v_mfma_f32_16x16x32_bf16 v[140:143], a[204:207], v[32:35], v[140:143]
  v_exp_f32 v29, v29
  v_mfma_f32_16x16x32_bf16 v[144:147], a[208:211], v[32:35], v[144:147]
  v_fma_f32 v30, v30, s24, v11
  v_fma_f32 v31, v31, s24, v11
  v_mfma_f32_16x16x32_bf16 v[148:151], a[212:215], v[32:35], v[148:151]
  v_exp_f32 v30, v30
  v_mfma_f32_16x16x32_bf16 v[152:155], a[216:219], v[32:35], v[152:155]
  v_exp_f32 v31, v31
  v_mfma_f32_16x16x32_bf16 v[156:159], a[220:223], v[32:35], v[156:159]
L_pad2:
  s_cbranch_execz L_padret
  v_cvt_pk_bf16_f32 v38, v28, v29
  v_cvt_pk_bf16_f32 v39, v30, v31
  v_mfma_f32_16x16x32_bf16 v[24:27], a[128:131], a[80:83], 0
  ds_read_b64_tr_b16 a[176:177], v2 offset:33280
  v_fma_f32 v16, v16, s24, v12
  v_smfmac_f32_16x16x64_bf16 v[44:47], a[224:227], v[32:39], v7
  buffer_load_dwordx4 v4, s[12:15], s20 offen offset:1024 lds
  v_mfma_f32_16x16x32_bf16 v[24:27], a[132:135], a[84:87], v[24:27]
  v_exp_f32 v16, v16
  v_mfma_f32_16x16x32_bf16 v[24:27], a[136:139], a[88:91], v[24:27]
  ds_read_b64_tr_b16 a[178:179], v2 offset:41472
  v_fma_f32 v17, v17, s24, v12
  v_mfma_f32_16x16x32_bf16 v[24:27], a[140:143], a[92:95], v[24:27]
  v_exp_f32 v17, v17
  v_mfma_f32_16x16x32_bf16 v[28:31], a[156:159], a[92:95], 0
  ds_read_b64_tr_b16 a[180:181], v2 offset:33288
  v_fma_f32 v18, v18, s24, v12
  v_mfma_f32_16x16x32_bf16 v[28:31], a[152:155], a[88:91], v[28:31]
  v_exp_f32 v18, v18
  v_mfma_f32_16x16x32_bf16 v[28:31], a[148:151], a[84:87], v[28:31]
  ds_read_b64_tr_b16 a[182:183], v2 offset:41480
  v_fma_f32 v19, v19, s24, v12
  v_mfma_f32_16x16x32_bf16 v[28:31], a[144:147], a[80:83], v[28:31]
  v_exp_f32 v19, v19
  v_mfma_f32_16x16x32_bf16 v[160:163], a[192:195], v[36:39], v[160:163]
  v_fma_f32 v20, v20, s24, v12
  v_cvt_pk_bf16_f32 v32, v16, v17
  v_mfma_f32_16x16x32_bf16 v[164:167], a[196:199], v[36:39], v[164:167]
  v_exp_f32 v20, v20
  v_mfma_f32_16x16x32_bf16 v[168:171], a[200:203], v[36:39], v[168:171]
  v_fma_f32 v21, v21, s24, v12
  v_cvt_pk_bf16_f32 v33, v18, v19
  v_mfma_f32_16x16x32_bf16 v[172:175], a[204:207], v[36:39], v[172:175]
  v_exp_f32 v21, v21
  v_mfma_f32_16x16x32_bf16 v[176:179], a[208:211], v[36:39], v[176:179]
  v_fma_f32 v22, v22, s24, v12
  v_fma_f32 v23, v23, s24, v12
  v_mfma_f32_16x16x32_bf16 v[180:183], a[212:215], v[36:39], v[180:183]
  v_exp_f32 v22, v22
  v_mfma_f32_16x16x32_bf16 v[184:187], a[216:219], v[36:39], v[184:187]
  v_exp_f32 v23, v23
  v_mfma_f32_16x16x32_bf16 v[188:191], a[220:223], v[36:39], v[188:191]
  s_waitcnt lgkmcnt(14)
  v_cvt_pk_bf16_f32 v34, v20, v21
  v_cvt_pk_bf16_f32 v35, v22, v23
  v_mfma_f32_16x16x32_bf16 v[16:19], a[96:99], a[0:3], 0
  ds_read_b64_tr_b16 a[184:185], v2 offset:33536
  v_fma_f32 v24, v24, s24, v13
  v_mfma_f32_16x16x32_bf16 v[16:19], a[100:103], a[4:7], v[16:19]
  v_exp_f32 v24, v24
  v_mfma_f32_16x16x32_bf16 v[16:19], a[104:107], a[8:11], v[16:19]
  ds_read_b64_tr_b16 a[186:187], v2 offset:41728
  v_fma_f32 v25, v25, s24, v13
  v_mfma_f32_16x16x32_bf16 v[16:19], a[108:111], a[12:15], v[16:19]
  v_exp_f32 v25, v25
  v_mfma_f32_16x16x32_bf16 v[20:23], a[124:127], a[12:15], 0
  ds_read_b64_tr_b16 a[188:189], v2 offset:33544
  v_fma_f32 v26, v26, s24, v13
  v_mfma_f32_16x16x32_bf16 v[20:23], a[120:123], a[8:11], v[20:23]
  v_exp_f32 v26, v26
  v_mfma_f32_16x16x32_bf16 v[20:23], a[116:119], a[4:7], v[20:23]
  ds_read_b64_tr_b16 a[190:191], v2 offset:41736
  v_fma_f32 v27, v27, s24, v13
  v_mfma_f32_16x16x32_bf16 v[20:23], a[112:115], a[0:3], v[20:23]
  v_exp_f32 v27, v27
  v_mfma_f32_16x16x32_bf16 v[192:195], a[192:195], v[32:35], v[192:195]
  s_waitcnt lgkmcnt(8)
  v_fma_f32 v28, v28, s24, v13
  v_cvt_pk_bf16_f32 v36, v24, v25
  v_mfma_f32_16x16x32_bf16 v[196:199], a[196:199], v[32:35], v[196:199]
  buffer_store_dwordx4 a[232:235], v6, s[16:19], s22 offen offset:2048 sc1
  ds_read_b128 a[228:231], v63 offset:10240
  v_exp_f32 v28, v28
  v_mfma_f32_16x16x32_bf16 v[200:203], a[200:203], v[32:35], v[200:203]
  v_fma_f32 v29, v29, s24, v13
  v_cvt_pk_bf16_f32 v37, v26, v27
  v_mfma_f32_16x16x32_bf16 v[204:207], a[204:207], v[32:35], v[204:207]
  v_exp_f32 v29, v29
  v_mfma_f32_16x16x32_bf16 v[208:211], a[208:211], v[32:35], v[208:211]
  s_add_u32 s20, s20, 8192
  v_fma_f32 v30, v30, s24, v13
  v_fma_f32 v31, v31, s24, v13
  v_mfma_f32_16x16x32_bf16 v[212:215], a[212:215], v[32:35], v[212:215]
  v_exp_f32 v30, v30
  v_mfma_f32_16x16x32_bf16 v[216:219], a[216:219], v[32:35], v[216:219]
  s_add_u32 m0, s32, 32768
  v_exp_f32 v31, v31
  v_mfma_f32_16x16x32_bf16 v[220:223], a[220:223], v[32:35], v[220:223]
  s_waitcnt vmcnt(18) lgkmcnt(0)
  v_cvt_pk_bf16_f32 v38, v28, v29
  v_cvt_pk_bf16_f32 v39, v30, v31
  v_mfma_f32_16x16x32_bf16 v[24:27], a[96:99], a[16:19], 0
  s_barrier
  ds_read_b128 a[128:131], v1 offset:51200
  v_fma_f32 v16, v16, s24, v8
  v_smfmac_f32_16x16x64_bf16 v[48:51], a[224:227], v[32:39], v7
  buffer_load_dwordx4 v5, s[8:11], s20 offen offset:2048 lds
  v_mfma_f32_16x16x32_bf16 v[24:27], a[100:103], a[20:23], v[24:27]
  v_exp_f32 v16, v16
  v_mfma_f32_16x16x32_bf16 v[24:27], a[104:107], a[24:27], v[24:27]
  ds_read_b128 a[132:135], v1 offset:51456
  v_fma_f32 v17, v17, s24, v8
  v_mfma_f32_16x16x32_bf16 v[24:27], a[108:111], a[28:31], v[24:27]
  v_exp_f32 v17, v17
  v_mfma_f32_16x16x32_bf16 v[28:31], a[124:127], a[28:31], 0
  ds_read_b128 a[136:139], v1 offset:51712
  v_fma_f32 v18, v18, s24, v8
  v_mfma_f32_16x16x32_bf16 v[28:31], a[120:123], a[24:27], v[28:31]
  v_exp_f32 v18, v18
  v_mfma_f32_16x16x32_bf16 v[28:31], a[116:119], a[20:23], v[28:31]
  ds_read_b128 a[140:143], v1 offset:51968
  v_fma_f32 v19, v19, s24, v8
  v_mfma_f32_16x16x32_bf16 v[28:31], a[112:115], a[16:19], v[28:31]
  v_exp_f32 v19, v19
  v_mfma_f32_16x16x32_bf16 v[224:227], a[192:195], v[36:39], v[224:227]
  v_fma_f32 v20, v20, s24, v8
  v_cvt_pk_bf16_f32 v32, v16, v17
  v_mfma_f32_16x16x32_bf16 v[228:231], a[196:199], v[36:39], v[228:231]
  v_exp_f32 v20, v20
  v_mfma_f32_16x16x32_bf16 v[232:235], a[200:203], v[36:39], v[232:235]
  v_fma_f32 v21, v21, s24, v8
  v_cvt_pk_bf16_f32 v33, v18, v19
  v_mfma_f32_16x16x32_bf16 v[236:239], a[204:207], v[36:39], v[236:239]
  v_exp_f32 v21, v21
  v_mfma_f32_16x16x32_bf16 v[240:243], a[208:211], v[36:39], v[240:243]
  v_fma_f32 v22, v22, s24, v8
  v_fma_f32 v23, v23, s24, v8
  v_mfma_f32_16x16x32_bf16 v[244:247], a[212:215], v[36:39], v[244:247]
  v_exp_f32 v22, v22
  v_mfma_f32_16x16x32_bf16 v[248:251], a[216:219], v[36:39], v[248:251]
  v_exp_f32 v23, v23
  v_mfma_f32_16x16x32_bf16 v[252:255], a[220:223], v[36:39], v[252:255]
  v_cvt_pk_bf16_f32 v34, v20, v21
  v_cvt_pk_bf16_f32 v35, v22, v23
  v_mfma_f32_16x16x32_bf16 v[16:19], a[96:99], a[32:35], 0
  ds_read_b128 a[144:147], v1 offset:59392
  v_fma_f32 v24, v24, s24, v9
  v_mfma_f32_16x16x32_bf16 v[16:19], a[100:103], a[36:39], v[16:19]
  v_exp_f32 v24, v24
  v_mfma_f32_16x16x32_bf16 v[16:19], a[104:107], a[40:43], v[16:19]
  ds_read_b128 a[148:151], v1 offset:59648
  v_fma_f32 v25, v25, s24, v9
  v_mfma_f32_16x16x32_bf16 v[16:19], a[108:111], a[44:47], v[16:19]
  buffer_load_dwordx4 v5, s[8:11], s20 offen offset:3072 lds
  v_exp_f32 v25, v25
  v_mfma_f32_16x16x32_bf16 v[20:23], a[124:127], a[44:47], 0
  ds_read_b128 a[152:155], v1 offset:59904
  v_fma_f32 v26, v26, s24, v9
  v_mfma_f32_16x16x32_bf16 v[20:23], a[120:123], a[40:43], v[20:23]
  v_exp_f32 v26, v26
  v_mfma_f32_16x16x32_bf16 v[20:23], a[116:119], a[36:39], v[20:23]
  ds_read_b128 a[156:159], v1 offset:60160
  v_fma_f32 v27, v27, s24, v9
  v_mfma_f32_16x16x32_bf16 v[20:23], a[112:115], a[32:35], v[20:23]
  v_exp_f32 v27, v27
  v_mfma_f32_16x16x32_bf16 v[64:67], a[160:163], v[32:35], v[64:67]
  s_waitcnt lgkmcnt(8)
  v_fma_f32 v28, v28, s24, v9
  v_cvt_pk_bf16_f32 v36, v24, v25
  v_mfma_f32_16x16x32_bf16 v[68:71], a[164:167], v[32:35], v[68:71]
  buffer_store_dwordx4 a[228:231], v6, s[16:19], s22 offen offset:128 sc1
  ds_read_b128 a[232:235], v63 offset:10752
  v_exp_f32 v28, v28
  v_mfma_f32_16x16x32_bf16 v[72:75], a[168:171], v[32:35], v[72:75]
  v_fma_f32 v29, v29, s24, v9
  v_cvt_pk_bf16_f32 v37, v26, v27
  v_mfma_f32_16x16x32_bf16 v[76:79], a[172:175], v[32:35], v[76:79]
  v_exp_f32 v29, v29
  v_mfma_f32_16x16x32_bf16 v[80:83], a[176:179], v[32:35], v[80:83]
  v_fma_f32 v30, v30, s24, v9
  v_fma_f32 v31, v31, s24, v9
  v_mfma_f32_16x16x32_bf16 v[84:87], a[180:183], v[32:35], v[84:87]
  v_exp_f32 v30, v30
  v_mfma_f32_16x16x32_bf16 v[88:91], a[184:187], v[32:35], v[88:91]
  v_exp_f32 v31, v31
  v_mfma_f32_16x16x32_bf16 v[92:95], a[188:191], v[32:35], v[92:95]
  v_cvt_pk_bf16_f32 v38, v28, v29
  v_cvt_pk_bf16_f32 v39, v30, v31
  v_mfma_f32_16x16x32_bf16 v[24:27], a[96:99], a[48:51], 0
  ds_read_b64_tr_b16 a[192:193], v2 offset:49152
  v_fma_f32 v16, v16, s24, v10
  v_smfmac_f32_16x16x64_bf16 v[40:43], a[224:227], v[32:39], v7
  buffer_load_dwordx4 v4, s[12:15], s20 offen lds
  v_mfma_f32_16x16x32_bf16 v[24:27], a[100:103], a[52:55], v[24:27]
  v_exp_f32 v16, v16
  v_mfma_f32_16x16x32_bf16 v[24:27], a[104:107], a[56:59], v[24:27]
  ds_read_b64_tr_b16 a[194:195], v2 offset:57344
  v_fma_f32 v17, v17, s24, v10
  v_mfma_f32_16x16x32_bf16 v[24:27], a[108:111], a[60:63], v[24:27]
  v_exp_f32 v17, v17
  v_mfma_f32_16x16x32_bf16 v[28:31], a[124:127], a[60:63], 0
  ds_read_b64_tr_b16 a[196:197], v2 offset:49160
  v_fma_f32 v18, v18, s24, v10
  v_mfma_f32_16x16x32_bf16 v[28:31], a[120:123], a[56:59], v[28:31]
  v_exp_f32 v18, v18
  v_mfma_f32_16x16x32_bf16 v[28:31], a[116:119], a[52:55], v[28:31]
  ds_read_b64_tr_b16 a[198:199], v2 offset:57352
  v_fma_f32 v19, v19, s24, v10
  v_mfma_f32_16x16x32_bf16 v[28:31], a[112:115], a[48:51], v[28:31]
  v_exp_f32 v19, v19
  v_mfma_f32_16x16x32_bf16 v[96:99], a[160:163], v[36:39], v[96:99]
  s_waitcnt lgkmcnt(4)
  v_fma_f32 v20, v20, s24, v10
  v_cvt_pk_bf16_f32 v32, v16, v17
  v_mfma_f32_16x16x32_bf16 v[100:103], a[164:167], v[36:39], v[100:103]
  buffer_store_dwordx4 a[232:235], v6, s[16:19], s22 offen offset:2176 sc1
  ds_read_b128 a[228:231], v63 offset:12288
  v_exp_f32 v20, v20
  v_mfma_f32_16x16x32_bf16 v[104:107], a[168:171], v[36:39], v[104:107]
  s_add_u32 s22, s22, 4096
  v_fma_f32 v21, v21, s24, v10
  v_cvt_pk_bf16_f32 v33, v18, v19
  v_mfma_f32_16x16x32_bf16 v[108:111], a[172:175], v[36:39], v[108:111]
  v_exp_f32 v21, v21
  v_mfma_f32_16x16x32_bf16 v[112:115], a[176:179], v[36:39], v[112:115]
  v_fma_f32 v22, v22, s24, v10
  v_fma_f32 v23, v23, s24, v10
  v_mfma_f32_16x16x32_bf16 v[116:119], a[180:183], v[36:39], v[116:119]
  v_exp_f32 v22, v22
  v_mfma_f32_16x16x32_bf16 v[120:123], a[184:187], v[36:39], v[120:123]
  v_exp_f32 v23, v23
  v_mfma_f32_16x16x32_bf16 v[124:127], a[188:191], v[36:39], v[124:127]
  v_cvt_pk_bf16_f32 v34, v20, v21
  v_cvt_pk_bf16_f32 v35, v22, v23
  v_mfma_f32_16x16x32_bf16 v[16:19], a[96:99], a[64:67], 0
  ds_read_b64_tr_b16 a[200:201], v2 offset:49408
  v_fma_f32 v24, v24, s24, v11
  v_mfma_f32_16x16x32_bf16 v[16:19], a[100:103], a[68:71], v[16:19]
  v_exp_f32 v24, v24
  v_mfma_f32_16x16x32_bf16 v[16:19], a[104:107], a[72:75], v[16:19]
  ds_read_b64_tr_b16 a[202:203], v2 offset:57600
  v_fma_f32 v25, v25, s24, v11
  v_mfma_f32_16x16x32_bf16 v[16:19], a[108:111], a[76:79], v[16:19]
  v_exp_f32 v25, v25
  v_mfma_f32_16x16x32_bf16 v[20:23], a[124:127], a[76:79], 0
  ds_read_b64_tr_b16 a[204:205], v2 offset:49416
  v_fma_f32 v26, v26, s24, v11
  v_mfma_f32_16x16x32_bf16 v[20:23], a[120:123], a[72:75], v[20:23]
  v_exp_f32 v26, v26
  v_mfma_f32_16x16x32_bf16 v[20:23], a[116:119], a[68:71], v[20:23]
  ds_read_b64_tr_b16 a[206:207], v2 offset:57608
  v_fma_f32 v27, v27, s24, v11
  v_mfma_f32_16x16x32_bf16 v[20:23], a[112:115], a[64:67], v[20:23]
  v_exp_f32 v27, v27
  v_mfma_f32_16x16x32_bf16 v[128:131], a[160:163], v[32:35], v[128:131]
  v_fma_f32 v28, v28, s24, v11
  v_cvt_pk_bf16_f32 v36, v24, v25
  v_mfma_f32_16x16x32_bf16 v[132:135], a[164:167], v[32:35], v[132:135]
  v_exp_f32 v28, v28
  v_mfma_f32_16x16x32_bf16 v[136:139], a[168:171], v[32:35], v[136:139]
  v_fma_f32 v29, v29, s24, v11
  v_cvt_pk_bf16_f32 v37, v26, v27
  v_mfma_f32_16x16x32_bf16 v[140:143], a[172:175], v[32:35], v[140:143]
  v_exp_f32 v29, v29
  v_mfma_f32_16x16x32_bf16 v[144:147], a[176:179], v[32:35], v[144:147]
  v_fma_f32 v30, v30, s24, v11
  v_fma_f32 v31, v31, s24, v11
  v_mfma_f32_16x16x32_bf16 v[148:151], a[180:183], v[32:35], v[148:151]
  v_exp_f32 v30, v30
  v_mfma_f32_16x16x32_bf16 v[152:155], a[184:187], v[32:35], v[152:155]
  v_exp_f32 v31, v31
  v_mfma_f32_16x16x32_bf16 v[156:159], a[188:191], v[32:35], v[156:159]
  v_cvt_pk_bf16_f32 v38, v28, v29
  v_cvt_pk_bf16_f32 v39, v30, v31
  v_mfma_f32_16x16x32_bf16 v[24:27], a[96:99], a[80:83], 0
  ds_read_b64_tr_b16 a[208:209], v2 offset:49664
  v_fma_f32 v16, v16, s24, v12
  v_smfmac_f32_16x16x64_bf16 v[44:47], a[224:227], v[32:39], v7
  buffer_load_dwordx4 v4, s[12:15], s20 offen offset:1024 lds
  v_mfma_f32_16x16x32_bf16 v[24:27], a[100:103], a[84:87], v[24:27]
  v_exp_f32 v16, v16
  v_mfma_f32_16x16x32_bf16 v[24:27], a[104:107], a[88:91], v[24:27]
  ds_read_b64_tr_b16 a[210:211], v2 offset:57856
  v_fma_f32 v17, v17, s24, v12
  v_mfma_f32_16x16x32_bf16 v[24:27], a[108:111], a[92:95], v[24:27]
  v_exp_f32 v17, v17
  v_mfma_f32_16x16x32_bf16 v[28:31], a[124:127], a[92:95], 0
  ds_read_b64_tr_b16 a[212:213], v2 offset:49672
  v_fma_f32 v18, v18, s24, v12
  v_mfma_f32_16x16x32_bf16 v[28:31], a[120:123], a[88:91], v[28:31]
  v_exp_f32 v18, v18
  v_mfma_f32_16x16x32_bf16 v[28:31], a[116:119], a[84:87], v[28:31]
  ds_read_b64_tr_b16 a[214:215], v2 offset:57864
  v_fma_f32 v19, v19, s24, v12
  v_mfma_f32_16x16x32_bf16 v[28:31], a[112:115], a[80:83], v[28:31]
  v_exp_f32 v19, v19
  v_mfma_f32_16x16x32_bf16 v[160:163], a[160:163], v[36:39], v[160:163]
  s_waitcnt lgkmcnt(8)
  v_fma_f32 v20, v20, s24, v12
  v_cvt_pk_bf16_f32 v32, v16, v17
  v_mfma_f32_16x16x32_bf16 v[164:167], a[164:167], v[36:39], v[164:167]
  buffer_store_dwordx4 a[228:231], v6, s[16:19], s22 offen sc1
  ds_read_b128 a[232:235], v63 offset:12800
  v_exp_f32 v20, v20
  v_mfma_f32_16x16x32_bf16 v[168:171], a[168:171], v[36:39], v[168:171]
  v_fma_f32 v21, v21, s24, v12
  v_cvt_pk_bf16_f32 v33, v18, v19
  v_mfma_f32_16x16x32_bf16 v[172:175], a[172:175], v[36:39], v[172:175]
  v_exp_f32 v21, v21
  v_mfma_f32_16x16x32_bf16 v[176:179], a[176:179], v[36:39], v[176:179]
  v_fma_f32 v22, v22, s24, v12
  v_fma_f32 v23, v23, s24, v12
  v_mfma_f32_16x16x32_bf16 v[180:183], a[180:183], v[36:39], v[180:183]
  v_exp_f32 v22, v22
  v_mfma_f32_16x16x32_bf16 v[184:187], a[184:187], v[36:39], v[184:187]
  v_exp_f32 v23, v23
  v_mfma_f32_16x16x32_bf16 v[188:191], a[188:191], v[36:39], v[188:191]
  s_waitcnt lgkmcnt(15)
  v_cvt_pk_bf16_f32 v34, v20, v21
  v_cvt_pk_bf16_f32 v35, v22, v23
  v_mfma_f32_16x16x32_bf16 v[16:19], a[128:131], a[0:3], 0
  ds_read_b64_tr_b16 a[216:217], v2 offset:49920
  v_fma_f32 v24, v24, s24, v13
  v_mfma_f32_16x16x32_bf16 v[16:19], a[132:135], a[4:7], v[16:19]
  v_exp_f32 v24, v24
  v_mfma_f32_16x16x32_bf16 v[16:19], a[136:139], a[8:11], v[16:19]
  ds_read_b64_tr_b16 a[218:219], v2 offset:58112
  v_fma_f32 v25, v25, s24, v13
  v_mfma_f32_16x16x32_bf16 v[16:19], a[140:143], a[12:15], v[16:19]
  v_exp_f32 v25, v25
  v_mfma_f32_16x16x32_bf16 v[20:23], a[156:159], a[12:15], 0
  ds_read_b64_tr_b16 a[220:221], v2 offset:49928
  v_fma_f32 v26, v26, s24, v13
  v_mfma_f32_16x16x32_bf16 v[20:23], a[152:155], a[8:11], v[20:23]
  v_exp_f32 v26, v26
  v_mfma_f32_16x16x32_bf16 v[20:23], a[148:151], a[4:7], v[20:23]
  ds_read_b64_tr_b16 a[222:223], v2 offset:58120
  v_fma_f32 v27, v27, s24, v13
  v_mfma_f32_16x16x32_bf16 v[20:23], a[144:147], a[0:3], v[20:23]
  v_exp_f32 v27, v27
  v_mfma_f32_16x16x32_bf16 v[192:195], a[160:163], v[32:35], v[192:195]
  v_fma_f32 v28, v28, s24, v13
  v_cvt_pk_bf16_f32 v36, v24, v25
  v_mfma_f32_16x16x32_bf16 v[196:199], a[164:167], v[32:35], v[196:199]
  v_exp_f32 v28, v28
  v_mfma_f32_16x16x32_bf16 v[200:203], a[168:171], v[32:35], v[200:203]
  v_fma_f32 v29, v29, s24, v13
  v_cvt_pk_bf16_f32 v37, v26, v27
  v_mfma_f32_16x16x32_bf16 v[204:207], a[172:175], v[32:35], v[204:207]
  v_exp_f32 v29, v29
  v_mfma_f32_16x16x32_bf16 v[208:211], a[176:179], v[32:35], v[208:211]
  s_add_u32 s20, s20, 8192
  v_fma_f32 v30, v30, s24, v13
  v_fma_f32 v31, v31, s24, v13
  v_mfma_f32_16x16x32_bf16 v[212:215], a[180:183], v[32:35], v[212:215]
  v_exp_f32 v30, v30
  v_mfma_f32_16x16x32_bf16 v[216:219], a[184:187], v[32:35], v[216:219]
  s_add_u32 m0, s32, 49152
  v_exp_f32 v31, v31
  v_mfma_f32_16x16x32_bf16 v[220:223], a[188:191], v[32:35], v[220:223]
  s_waitcnt vmcnt(16) lgkmcnt(0)
  v_cvt_pk_bf16_f32 v38, v28, v29
  v_cvt_pk_bf16_f32 v39, v30, v31
  v_mfma_f32_16x16x32_bf16 v[24:27], a[128:131], a[16:19], 0
  s_barrier
  ds_read_b128 a[96:99], v1 offset:2048
  v_fma_f32 v16, v16, s24, v8
  v_smfmac_f32_16x16x64_bf16 v[48:51], a[224:227], v[32:39], v7
  buffer_load_dwordx4 v5, s[8:11], s20 offen offset:2048 lds
  v_mfma_f32_16x16x32_bf16 v[24:27], a[132:135], a[20:23], v[24:27]
  v_exp_f32 v16, v16
  v_mfma_f32_16x16x32_bf16 v[24:27], a[136:139], a[24:27], v[24:27]
  ds_read_b128 a[100:103], v1 offset:2304
  v_fma_f32 v17, v17, s24, v8
  v_mfma_f32_16x16x32_bf16 v[24:27], a[140:143], a[28:31], v[24:27]
  v_exp_f32 v17, v17
  v_mfma_f32_16x16x32_bf16 v[28:31], a[156:159], a[28:31], 0
  ds_read_b128 a[104:107], v1 offset:2560
  v_fma_f32 v18, v18, s24, v8
  v_mfma_f32_16x16x32_bf16 v[28:31], a[152:155], a[24:27], v[28:31]
  v_exp_f32 v18, v18
  v_mfma_f32_16x16x32_bf16 v[28:31], a[148:151], a[20:23], v[28:31]
  ds_read_b128 a[108:111], v1 offset:2816
  v_fma_f32 v19, v19, s24, v8
  v_mfma_f32_16x16x32_bf16 v[28:31], a[144:147], a[16:19], v[28:31]
  v_exp_f32 v19, v19
  v_mfma_f32_16x16x32_bf16 v[224:227], a[160:163], v[36:39], v[224:227]
  s_waitcnt lgkmcnt(8)
  v_fma_f32 v20, v20, s24, v8
  v_cvt_pk_bf16_f32 v32, v16, v17
  v_mfma_f32_16x16x32_bf16 v[228:231], a[164:167], v[36:39], v[228:231]
  buffer_store_dwordx4 a[232:235], v6, s[16:19], s22 offen offset:2048 sc1
  ds_read_b128 a[228:231], v63 offset:14336
  v_exp_f32 v20, v20
  v_mfma_f32_16x16x32_bf16 v[232:235], a[168:171], v[36:39], v[232:235]
  v_fma_f32 v21, v21, s24, v8
  v_cvt_pk_bf16_f32 v33, v18, v19
  v_mfma_f32_16x16x32_bf16 v[236:239], a[172:175], v[36:39], v[236:239]
  v_exp_f32 v21, v21
  v_mfma_f32_16x16x32_bf16 v[240:243], a[176:179], v[36:39], v[240:243]
  v_fma_f32 v22, v22, s24, v8
  v_fma_f32 v23, v23, s24, v8
  v_mfma_f32_16x16x32_bf16 v[244:247], a[180:183], v[36:39], v[244:247]
  v_exp_f32 v22, v22
  v_mfma_f32_16x16x32_bf16 v[248:251], a[184:187], v[36:39], v[248:251]
  v_exp_f32 v23, v23
  v_mfma_f32_16x16x32_bf16 v[252:255], a[188:191], v[36:39], v[252:255]
  v_cvt_pk_bf16_f32 v34, v20, v21
  v_cvt_pk_bf16_f32 v35, v22, v23
  v_mfma_f32_16x16x32_bf16 v[16:19], a[128:131], a[32:35], 0
  ds_read_b128 a[112:115], v1 offset:10240
  v_fma_f32 v24, v24, s24, v9
  v_mfma_f32_16x16x32_bf16 v[16:19], a[132:135], a[36:39], v[16:19]
  v_exp_f32 v24, v24
  v_mfma_f32_16x16x32_bf16 v[16:19], a[136:139], a[40:43], v[16:19]
  ds_read_b128 a[116:119], v1 offset:10496
  v_fma_f32 v25, v25, s24, v9
  v_mfma_f32_16x16x32_bf16 v[16:19], a[140:143], a[44:47], v[16:19]
  buffer_load_dwordx4 v5, s[8:11], s20 offen offset:3072 lds
  v_exp_f32 v25, v25
  v_mfma_f32_16x16x32_bf16 v[20:23], a[156:159], a[44:47], 0
  ds_read_b128 a[120:123], v1 offset:10752
  v_fma_f32 v26, v26, s24, v9
  v_mfma_f32_16x16x32_bf16 v[20:23], a[152:155], a[40:43], v[20:23]
  v_exp_f32 v26, v26
  v_mfma_f32_16x16x32_bf16 v[20:23], a[148:151], a[36:39], v[20:23]
  ds_read_b128 a[124:127], v1 offset:11008
  v_fma_f32 v27, v27, s24, v9
  v_mfma_f32_16x16x32_bf16 v[20:23], a[144:147], a[32:35], v[20:23]
  v_exp_f32 v27, v27
  v_mfma_f32_16x16x32_bf16 v[64:67], a[192:195], v[32:35], v[64:67]
  v_fma_f32 v28, v28, s24, v9
  v_cvt_pk_bf16_f32 v36, v24, v25
  v_mfma_f32_16x16x32_bf16 v[68:71], a[196:199], v[32:35], v[68:71]
  v_exp_f32 v28, v28
  v_mfma_f32_16x16x32_bf16 v[72:75], a[200:203], v[32:35], v[72:75]
  v_fma_f32 v29, v29, s24, v9
  v_cvt_pk_bf16_f32 v37, v26, v27
  v_mfma_f32_16x16x32_bf16 v[76:79], a[204:207], v[32:35], v[76:79]
  v_exp_f32 v29, v29
  v_mfma_f32_16x16x32_bf16 v[80:83], a[208:211], v[32:35], v[80:83]
  v_fma_f32 v30, v30, s24, v9
  v_fma_f32 v31, v31, s24, v9
  v_mfma_f32_16x16x32_bf16 v[84:87], a[212:215], v[32:35], v[84:87]
  v_exp_f32 v30, v30
  v_mfma_f32_16x16x32_bf16 v[88:91], a[216:219], v[32:35], v[88:91]
  v_exp_f32 v31, v31
  v_mfma_f32_16x16x32_bf16 v[92:95], a[220:223], v[32:35], v[92:95]
  v_cvt_pk_bf16_f32 v38, v28, v29
  v_cvt_pk_bf16_f32 v39, v30, v31
  v_mfma_f32_16x16x32_bf16 v[24:27], a[128:131], a[48:51], 0
  ds_read_b64_tr_b16 a[160:161], v2 offset:0
  v_fma_f32 v16, v16, s24, v10
  v_smfmac_f32_16x16x64_bf16 v[40:43], a[224:227], v[32:39], v7
  buffer_load_dwordx4 v4, s[12:15], s20 offen lds
  v_mfma_f32_16x16x32_bf16 v[24:27], a[132:135], a[52:55], v[24:27]
  v_exp_f32 v16, v16
  v_mfma_f32_16x16x32_bf16 v[24:27], a[136:139], a[56:59], v[24:27]
  ds_read_b64_tr_b16 a[162:163], v2 offset:8192
  v_fma_f32 v17, v17, s24, v10
  v_mfma_f32_16x16x32_bf16 v[24:27], a[140:143], a[60:63], v[24:27]
  v_exp_f32 v17, v17
  v_mfma_f32_16x16x32_bf16 v[28:31], a[156:159], a[60:63], 0
  ds_read_b64_tr_b16 a[164:165], v2 offset:8
  v_fma_f32 v18, v18, s24, v10
  v_mfma_f32_16x16x32_bf16 v[28:31], a[152:155], a[56:59], v[28:31]
  v_exp_f32 v18, v18
  v_mfma_f32_16x16x32_bf16 v[28:31], a[148:151], a[52:55], v[28:31]
  ds_read_b64_tr_b16 a[166:167], v2 offset:8200
  v_fma_f32 v19, v19, s24, v10
  v_mfma_f32_16x16x32_bf16 v[28:31], a[144:147], a[48:51], v[28:31]
  v_exp_f32 v19, v19
  v_mfma_f32_16x16x32_bf16 v[96:99], a[192:195], v[36:39], v[96:99]
  s_waitcnt lgkmcnt(8)
  v_fma_f32 v20, v20, s24, v10
  v_cvt_pk_bf16_f32 v32, v16, v17
  v_mfma_f32_16x16x32_bf16 v[100:103], a[196:199], v[36:39], v[100:103]
  buffer_store_dwordx4 a[228:231], v6, s[16:19], s22 offen offset:128 sc1
  ds_read_b128 a[232:235], v63 offset:14848
  v_exp_f32 v20, v20
  v_mfma_f32_16x16x32_bf16 v[104:107], a[200:203], v[36:39], v[104:107]
  v_fma_f32 v21, v21, s24, v10
  v_cvt_pk_bf16_f32 v33, v18, v19
  v_mfma_f32_16x16x32_bf16 v[108:111], a[204:207], v[36:39], v[108:111]
  v_exp_f32 v21, v21
  v_mfma_f32_16x16x32_bf16 v[112:115], a[208:211], v[36:39], v[112:115]
  v_fma_f32 v22, v22, s24, v10
  v_fma_f32 v23, v23, s24, v10
  v_mfma_f32_16x16x32_bf16 v[116:119], a[212:215], v[36:39], v[116:119]
  v_exp_f32 v22, v22
  v_mfma_f32_16x16x32_bf16 v[120:123], a[216:219], v[36:39], v[120:123]
  v_exp_f32 v23, v23
  v_mfma_f32_16x16x32_bf16 v[124:127], a[220:223], v[36:39], v[124:127]
  v_cvt_pk_bf16_f32 v34, v20, v21
  v_cvt_pk_bf16_f32 v35, v22, v23
  v_mfma_f32_16x16x32_bf16 v[16:19], a[128:131], a[64:67], 0
  ds_read_b64_tr_b16 a[168:169], v2 offset:256
  v_fma_f32 v24, v24, s24, v11
  v_mfma_f32_16x16x32_bf16 v[16:19], a[132:135], a[68:71], v[16:19]
  v_exp_f32 v24, v24
  v_mfma_f32_16x16x32_bf16 v[16:19], a[136:139], a[72:75], v[16:19]
  ds_read_b64_tr_b16 a[170:171], v2 offset:8448
  v_fma_f32 v25, v25, s24, v11
  v_mfma_f32_16x16x32_bf16 v[16:19], a[140:143], a[76:79], v[16:19]
  v_exp_f32 v25, v25
  v_mfma_f32_16x16x32_bf16 v[20:23], a[156:159], a[76:79], 0
  ds_read_b64_tr_b16 a[172:173], v2 offset:264
  v_fma_f32 v26, v26, s24, v11
  v_mfma_f32_16x16x32_bf16 v[20:23], a[152:155], a[72:75], v[20:23]
  v_exp_f32 v26, v26
  v_mfma_f32_16x16x32_bf16 v[20:23], a[148:151], a[68:71], v[20:23]
  ds_read_b64_tr_b16 a[174:175], v2 offset:8456
  v_fma_f32 v27, v27, s24, v11
  v_mfma_f32_16x16x32_bf16 v[20:23], a[144:147], a[64:67], v[20:23]
  v_exp_f32 v27, v27
  v_mfma_f32_16x16x32_bf16 v[128:131], a[192:195], v[32:35], v[128:131]
  v_fma_f32 v28, v28, s24, v11
  v_cvt_pk_bf16_f32 v36, v24, v25
  v_mfma_f32_16x16x32_bf16 v[132:135], a[196:199], v[32:35], v[132:135]
  v_exp_f32 v28, v28
  v_mfma_f32_16x16x32_bf16 v[136:139], a[200:203], v[32:35], v[136:139]
  v_fma_f32 v29, v29, s24, v11
  v_cvt_pk_bf16_f32 v37, v26, v27
  v_mfma_f32_16x16x32_bf16 v[140:143], a[204:207], v[32:35], v[140:143]
  v_exp_f32 v29, v29
  v_mfma_f32_16x16x32_bf16 v[144:147], a[208:211], v[32:35], v[144:147]
  v_fma_f32 v30, v30, s24, v11
  v_fma_f32 v31, v31, s24, v11
  v_mfma_f32_16x16x32_bf16 v[148:151], a[212:215], v[32:35], v[148:151]
  v_exp_f32 v30, v30
  v_mfma_f32_16x16x32_bf16 v[152:155], a[216:219], v[32:35], v[152:155]
  v_exp_f32 v31, v31
  v_mfma_f32_16x16x32_bf16 v[156:159], a[220:223], v[32:35], v[156:159]
  v_cvt_pk_bf16_f32 v38, v28, v29
  v_cvt_pk_bf16_f32 v39, v30, v31
  v_mfma_f32_16x16x32_bf16 v[24:27], a[128:131], a[80:83], 0
  ds_read_b64_tr_b16 a[176:177], v2 offset:512
  v_fma_f32 v16, v16, s24, v12
  v_smfmac_f32_16x16x64_bf16 v[44:47], a[224:227], v[32:39], v7
  buffer_load_dwordx4 v4, s[12:15], s20 offen offset:1024 lds
  v_mfma_f32_16x16x32_bf16 v[24:27], a[132:135], a[84:87], v[24:27]
  v_exp_f32 v16, v16
  v_mfma_f32_16x16x32_bf16 v[24:27], a[136:139], a[88:91], v[24:27]
  ds_read_b64_tr_b16 a[178:179], v2 offset:8704
  v_fma_f32 v17, v17, s24, v12
  v_mfma_f32_16x16x32_bf16 v[24:27], a[140:143], a[92:95], v[24:27]
  v_exp_f32 v17, v17
  v_mfma_f32_16x16x32_bf16 v[28:31], a[156:159], a[92:95], 0
  ds_read_b64_tr_b16 a[180:181], v2 offset:520
  v_fma_f32 v18, v18, s24, v12
  v_mfma_f32_16x16x32_bf16 v[28:31], a[152:155], a[88:91], v[28:31]
  v_exp_f32 v18, v18
  v_mfma_f32_16x16x32_bf16 v[28:31], a[148:151], a[84:87], v[28:31]
  ds_read_b64_tr_b16 a[182:183], v2 offset:8712
  v_fma_f32 v19, v19, s24, v12
  v_mfma_f32_16x16x32_bf16 v[28:31], a[144:147], a[80:83], v[28:31]
  v_exp_f32 v19, v19
  v_mfma_f32_16x16x32_bf16 v[160:163], a[192:195], v[36:39], v[160:163]
  s_waitcnt lgkmcnt(8)
  v_fma_f32 v20, v20, s24, v12
  v_cvt_pk_bf16_f32 v32, v16, v17
  v_mfma_f32_16x16x32_bf16 v[164:167], a[196:199], v[36:39], v[164:167]
  buffer_store_dwordx4 a[232:235], v6, s[16:19], s22 offen offset:2176 sc1
  ds_read_b128 a[228:231], v63 offset:16384
  v_exp_f32 v20, v20
  v_mfma_f32_16x16x32_bf16 v[168:171], a[200:203], v[36:39], v[168:171]
  s_add_u32 s22, s22, 4096
  v_fma_f32 v21, v21, s24, v12
  v_cvt_pk_bf16_f32 v33, v18, v19
  v_mfma_f32_16x16x32_bf16 v[172:175], a[204:207], v[36:39], v[172:175]
  v_exp_f32 v21, v21
  v_mfma_f32_16x16x32_bf16 v[176:179], a[208:211], v[36:39], v[176:179]
  v_fma_f32 v22, v22, s24, v12
  v_fma_f32 v23, v23, s24, v12
  v_mfma_f32_16x16x32_bf16 v[180:183], a[212:215], v[36:39], v[180:183]
  v_exp_f32 v22, v22
  v_mfma_f32_16x16x32_bf16 v[184:187], a[216:219], v[36:39], v[184:187]
  v_exp_f32 v23, v23
  v_mfma_f32_16x16x32_bf16 v[188:191], a[220:223], v[36:39], v[188:191]
  s_waitcnt lgkmcnt(14)
  v_cvt_pk_bf16_f32 v34, v20, v21
  v_cvt_pk_bf16_f32 v35, v22, v23
  v_mfma_f32_16x16x32_bf16 v[16:19], a[96:99], a[0:3], 0
L_pad3:
  s_cbranch_execz L_pad4
  ds_read_b64_tr_b16 a[184:185], v2 offset:768
  v_fma_f32 v24, v24, s24, v13
  v_mfma_f32_16x16x32_bf16 v[16:19], a[100:103], a[4:7], v[16:19]
  v_exp_f32 v24, v24
  v_mfma_f32_16x16x32_bf16 v[16:19], a[104:107], a[8:11], v[16:19]
  ds_read_b64_tr_b16 a[186:187], v2 offset:8960
  v_fma_f32 v25, v25, s24, v13
  v_mfma_f32_16x16x32_bf16 v[16:19], a[108:111], a[12:15], v[16:19]
  v_exp_f32 v25, v25
  v_mfma_f32_16x16x32_bf16 v[20:23], a[124:127], a[12:15], 0
  ds_read_b64_tr_b16 a[188:189], v2 offset:776
  v_fma_f32 v26, v26, s24, v13
  v_mfma_f32_16x16x32_bf16 v[20:23], a[120:123], a[8:11], v[20:23]
  v_exp_f32 v26, v26
  v_mfma_f32_16x16x32_bf16 v[20:23], a[116:119], a[4:7], v[20:23]
  ds_read_b64_tr_b16 a[190:191], v2 offset:8968
  v_fma_f32 v27, v27, s24, v13
  v_mfma_f32_16x16x32_bf16 v[20:23], a[112:115], a[0:3], v[20:23]
  v_exp_f32 v27, v27
  v_mfma_f32_16x16x32_bf16 v[192:195], a[192:195], v[32:35], v[192:195]
  s_waitcnt lgkmcnt(4)
  v_fma_f32 v28, v28, s24, v13
  v_cvt_pk_bf16_f32 v36, v24, v25
  v_mfma_f32_16x16x32_bf16 v[196:199], a[196:199], v[32:35], v[196:199]
  buffer_store_dwordx4 a[228:231], v6, s[16:19], s22 offen sc1
  ds_read_b128 a[232:235], v63 offset:16896
  v_exp_f32 v28, v28
  v_mfma_f32_16x16x32_bf16 v[200:203], a[200:203], v[32:35], v[200:203]
  v_fma_f32 v29, v29, s24, v13
  v_cvt_pk_bf16_f32 v37, v26, v27
  v_mfma_f32_16x16x32_bf16 v[204:207], a[204:207], v[32:35], v[204:207]
  v_exp_f32 v29, v29
  v_mfma_f32_16x16x32_bf16 v[208:211], a[208:211], v[32:35], v[208:211]
  s_add_u32 s20, s20, 8192
  v_fma_f32 v30, v30, s24, v13
  v_fma_f32 v31, v31, s24, v13
  v_mfma_f32_16x16x32_bf16 v[212:215], a[212:215], v[32:35], v[212:215]
  v_exp_f32 v30, v30
  v_mfma_f32_16x16x32_bf16 v[216:219], a[216:219], v[32:35], v[216:219]
  s_mov_b32 m0, s32
  v_exp_f32 v31, v31
  v_mfma_f32_16x16x32_bf16 v[220:223], a[220:223], v[32:35], v[220:223]
  s_waitcnt vmcnt(16) lgkmcnt(0)
  v_cvt_pk_bf16_f32 v38, v28, v29
  v_cvt_pk_bf16_f32 v39, v30, v31
  v_mfma_f32_16x16x32_bf16 v[24:27], a[96:99], a[16:19], 0
  s_barrier
  ds_read_b128 a[128:131], v1 offset:18432
  v_fma_f32 v16, v16, s24, v8
  v_smfmac_f32_16x16x64_bf16 v[48:51], a[224:227], v[32:39], v7
  buffer_load_dwordx4 v5, s[8:11], s20 offen offset:2048 lds
  v_mfma_f32_16x16x32_bf16 v[24:27], a[100:103], a[20:23], v[24:27]
  v_exp_f32 v16, v16
  v_mfma_f32_16x16x32_bf16 v[24:27], a[104:107], a[24:27], v[24:27]
  ds_read_b128 a[132:135], v1 offset:18688
  v_fma_f32 v17, v17, s24, v8
  v_mfma_f32_16x16x32_bf16 v[24:27], a[108:111], a[28:31], v[24:27]
  v_exp_f32 v17, v17
  v_mfma_f32_16x16x32_bf16 v[28:31], a[124:127], a[28:31], 0
  ds_read_b128 a[136:139], v1 offset:18944
  v_fma_f32 v18, v18, s24, v8
  v_mfma_f32_16x16x32_bf16 v[28:31], a[120:123], a[24:27], v[28:31]
  v_exp_f32 v18, v18
  v_mfma_f32_16x16x32_bf16 v[28:31], a[116:119], a[20:23], v[28:31]
  ds_read_b128 a[140:143], v1 offset:19200
  v_fma_f32 v19, v19, s24, v8
  v_mfma_f32_16x16x32_bf16 v[28:31], a[112:115], a[16:19], v[28:31]
  v_exp_f32 v19, v19
  v_mfma_f32_16x16x32_bf16 v[224:227], a[192:195], v[36:39], v[224:227]
  v_fma_f32 v20, v20, s24, v8
  v_cvt_pk_bf16_f32 v32, v16, v17
  v_mfma_f32_16x16x32_bf16 v[228:231], a[196:199], v[36:39], v[228:231]
  v_exp_f32 v20, v20
  v_mfma_f32_16x16x32_bf16 v[232:235], a[200:203], v[36:39], v[232:235]
  v_fma_f32 v21, v21, s24, v8
  v_cvt_pk_bf16_f32 v33, v18, v19
  v_mfma_f32_16x16x32_bf16 v[236:239], a[204:207], v[36:39], v[236:239]
  v_exp_f32 v21, v21
  v_mfma_f32_16x16x32_bf16 v[240:243], a[208:211], v[36:39], v[240:243]
  v_fma_f32 v22, v22, s24, v8
  v_fma_f32 v23, v23, s24, v8
  v_mfma_f32_16x16x32_bf16 v[244:247], a[212:215], v[36:39], v[244:247]
  v_exp_f32 v22, v22
  v_mfma_f32_16x16x32_bf16 v[248:251], a[216:219], v[36:39], v[248:251]
  v_exp_f32 v23, v23
  v_mfma_f32_16x16x32_bf16 v[252:255], a[220:223], v[36:39], v[252:255]
  v_cvt_pk_bf16_f32 v34, v20, v21
  v_cvt_pk_bf16_f32 v35, v22, v23
  v_mfma_f32_16x16x32_bf16 v[16:19], a[96:99], a[32:35], 0
  ds_read_b128 a[144:147], v1 offset:26624
  v_fma_f32 v24, v24, s24, v9
  v_mfma_f32_16x16x32_bf16 v[16:19], a[100:103], a[36:39], v[16:19]
  v_exp_f32 v24, v24
  v_mfma_f32_16x16x32_bf16 v[16:19], a[104:107], a[40:43], v[16:19]
  ds_read_b128 a[148:151], v1 offset:26880
  v_fma_f32 v25, v25, s24, v9
  v_mfma_f32_16x16x32_bf16 v[16:19], a[108:111], a[44:47], v[16:19]
  buffer_load_dwordx4 v5, s[8:11], s20 offen offset:3072 lds
  v_exp_f32 v25, v25
  v_mfma_f32_16x16x32_bf16 v[20:23], a[124:127], a[44:47], 0
  ds_read_b128 a[152:155], v1 offset:27136
  v_fma_f32 v26, v26, s24, v9
  v_mfma_f32_16x16x32_bf16 v[20:23], a[120:123], a[40:43], v[20:23]
  v_exp_f32 v26, v26
  v_mfma_f32_16x16x32_bf16 v[20:23], a[116:119], a[36:39], v[20:23]
  ds_read_b128 a[156:159], v1 offset:27392
  v_fma_f32 v27, v27, s24, v9
  v_mfma_f32_16x16x32_bf16 v[20:23], a[112:115], a[32:35], v[20:23]
  v_exp_f32 v27, v27
  v_mfma_f32_16x16x32_bf16 v[64:67], a[160:163], v[32:35], v[64:67]
  s_waitcnt lgkmcnt(8)
  v_fma_f32 v28, v28, s24, v9
  v_cvt_pk_bf16_f32 v36, v24, v25
  v_mfma_f32_16x16x32_bf16 v[68:71], a[164:167], v[32:35], v[68:71]
  buffer_store_dwordx4 a[232:235], v6, s[16:19], s22 offen offset:2048 sc1
  ds_read_b128 a[228:231], v63 offset:18432
  v_exp_f32 v28, v28
  v_mfma_f32_16x16x32_bf16 v[72:75], a[168:171], v[32:35], v[72:75]
  v_fma_f32 v29, v29, s24, v9
  v_cvt_pk_bf16_f32 v37, v26, v27
  v_mfma_f32_16x16x32_bf16 v[76:79], a[172:175], v[32:35], v[76:79]
  v_exp_f32 v29, v29
  v_mfma_f32_16x16x32_bf16 v[80:83], a[176:179], v[32:35], v[80:83]
  v_fma_f32 v30, v30, s24, v9
  v_fma_f32 v31, v31, s24, v9
  v_mfma_f32_16x16x32_bf16 v[84:87], a[180:183], v[32:35], v[84:87]
  v_exp_f32 v30, v30
  v_mfma_f32_16x16x32_bf16 v[88:91], a[184:187], v[32:35], v[88:91]
  v_exp_f32 v31, v31
  v_mfma_f32_16x16x32_bf16 v[92:95], a[188:191], v[32:35], v[92:95]
  v_cvt_pk_bf16_f32 v38, v28, v29
  v_cvt_pk_bf16_f32 v39, v30, v31
  v_mfma_f32_16x16x32_bf16 v[24:27], a[96:99], a[48:51], 0
  ds_read_b64_tr_b16 a[192:193], v2 offset:16384
  v_fma_f32 v16, v16, s24, v10
  v_smfmac_f32_16x16x64_bf16 v[40:43], a[224:227], v[32:39], v7
  buffer_load_dwordx4 v4, s[12:15], s20 offen lds
  v_mfma_f32_16x16x32_bf16 v[24:27], a[100:103], a[52:55], v[24:27]
  v_exp_f32 v16, v16
  v_mfma_f32_16x16x32_bf16 v[24:27], a[104:107], a[56:59], v[24:27]
  ds_read_b64_tr_b16 a[194:195], v2 offset:24576
  v_fma_f32 v17, v17, s24, v10
  v_mfma_f32_16x16x32_bf16 v[24:27], a[108:111], a[60:63], v[24:27]
  v_exp_f32 v17, v17
  v_mfma_f32_16x16x32_bf16 v[28:31], a[124:127], a[60:63], 0
  ds_read_b64_tr_b16 a[196:197], v2 offset:16392
  v_fma_f32 v18, v18, s24, v10
  v_mfma_f32_16x16x32_bf16 v[28:31], a[120:123], a[56:59], v[28:31]
  v_exp_f32 v18, v18
  v_mfma_f32_16x16x32_bf16 v[28:31], a[116:119], a[52:55], v[28:31]
  ds_read_b64_tr_b16 a[198:199], v2 offset:24584
  v_fma_f32 v19, v19, s24, v10
  v_mfma_f32_16x16x32_bf16 v[28:31], a[112:115], a[48:51], v[28:31]
  v_exp_f32 v19, v19
  v_mfma_f32_16x16x32_bf16 v[96:99], a[160:163], v[36:39], v[96:99]
  v_fma_f32 v20, v20, s24, v10
  v_cvt_pk_bf16_f32 v32, v16, v17
  v_mfma_f32_16x16x32_bf16 v[100:103], a[164:167], v[36:39], v[100:103]
  v_exp_f32 v20, v20
  v_mfma_f32_16x16x32_bf16 v[104:107], a[168:171], v[36:39], v[104:107]
  v_fma_f32 v21, v21, s24, v10
  v_cvt_pk_bf16_f32 v33, v18, v19
  v_mfma_f32_16x16x32_bf16 v[108:111], a[172:175], v[36:39], v[108:111]
  v_exp_f32 v21, v21
  v_mfma_f32_16x16x32_bf16 v[112:115], a[176:179], v[36:39], v[112:115]
  v_fma_f32 v22, v22, s24, v10
  v_fma_f32 v23, v23, s24, v10
  v_mfma_f32_16x16x32_bf16 v[116:119], a[180:183], v[36:39], v[116:119]
  v_exp_f32 v22, v22
  v_mfma_f32_16x16x32_bf16 v[120:123], a[184:187], v[36:39], v[120:123]
  v_exp_f32 v23, v23
  v_mfma_f32_16x16x32_bf16 v[124:127], a[188:191], v[36:39], v[124:127]
  v_cvt_pk_bf16_f32 v34, v20, v21
  v_cvt_pk_bf16_f32 v35, v22, v23
  v_mfma_f32_16x16x32_bf16 v[16:19], a[96:99], a[64:67], 0
  ds_read_b64_tr_b16 a[200:201], v2 offset:16640
  v_fma_f32 v24, v24, s24, v11
  v_mfma_f32_16x16x32_bf16 v[16:19], a[100:103], a[68:71], v[16:19]
  v_exp_f32 v24, v24
  v_mfma_f32_16x16x32_bf16 v[16:19], a[104:107], a[72:75], v[16:19]
  ds_read_b64_tr_b16 a[202:203], v2 offset:24832
  v_fma_f32 v25, v25, s24, v11
  v_mfma_f32_16x16x32_bf16 v[16:19], a[108:111], a[76:79], v[16:19]
  v_exp_f32 v25, v25
  v_mfma_f32_16x16x32_bf16 v[20:23], a[124:127], a[76:79], 0
  ds_read_b64_tr_b16 a[204:205], v2 offset:16648
  v_fma_f32 v26, v26, s24, v11
  v_mfma_f32_16x16x32_bf16 v[20:23], a[120:123], a[72:75], v[20:23]
  v_exp_f32 v26, v26
  v_mfma_f32_16x16x32_bf16 v[20:23], a[116:119], a[68:71], v[20:23]
  ds_read_b64_tr_b16 a[206:207], v2 offset:24840
  v_fma_f32 v27, v27, s24, v11
  v_mfma_f32_16x16x32_bf16 v[20:23], a[112:115], a[64:67], v[20:23]
  v_exp_f32 v27, v27
  v_mfma_f32_16x16x32_bf16 v[128:131], a[160:163], v[32:35], v[128:131]
  s_waitcnt lgkmcnt(8)
  v_fma_f32 v28, v28, s24, v11
  v_cvt_pk_bf16_f32 v36, v24, v25
  v_mfma_f32_16x16x32_bf16 v[132:135], a[164:167], v[32:35], v[132:135]
  buffer_store_dwordx4 a[228:231], v6, s[16:19], s22 offen offset:128 sc1
  ds_read_b128 a[232:235], v63 offset:18944
  v_exp_f32 v28, v28
  v_mfma_f32_16x16x32_bf16 v[136:139], a[168:171], v[32:35], v[136:139]
  v_fma_f32 v29, v29, s24, v11
  v_cvt_pk_bf16_f32 v37, v26, v27
  v_mfma_f32_16x16x32_bf16 v[140:143], a[172:175], v[32:35], v[140:143]
  v_exp_f32 v29, v29
  v_mfma_f32_16x16x32_bf16 v[144:147], a[176:179], v[32:35], v[144:147]
  v_fma_f32 v30, v30, s24, v11
  v_fma_f32 v31, v31, s24, v11
  v_mfma_f32_16x16x32_bf16 v[148:151], a[180:183], v[32:35], v[148:151]
  v_exp_f32 v30, v30
  v_mfma_f32_16x16x32_bf16 v[152:155], a[184:187], v[32:35], v[152:155]
  v_exp_f32 v31, v31
  v_mfma_f32_16x16x32_bf16 v[156:159], a[188:191], v[32:35], v[156:159]
  v_cvt_pk_bf16_f32 v38, v28, v29
  v_cvt_pk_bf16_f32 v39, v30, v31
  v_mfma_f32_16x16x32_bf16 v[24:27], a[96:99], a[80:83], 0
  ds_read_b64_tr_b16 a[208:209], v2 offset:16896
  v_fma_f32 v16, v16, s24, v12
  v_smfmac_f32_16x16x64_bf16 v[44:47], a[224:227], v[32:39], v7
  buffer_load_dwordx4 v4, s[12:15], s20 offen offset:1024 lds
  v_mfma_f32_16x16x32_bf16 v[24:27], a[100:103], a[84:87], v[24:27]
  v_exp_f32 v16, v16
  v_mfma_f32_16x16x32_bf16 v[24:27], a[104:107], a[88:91], v[24:27]
  ds_read_b64_tr_b16 a[210:211], v2 offset:25088
  v_fma_f32 v17, v17, s24, v12
  v_mfma_f32_16x16x32_bf16 v[24:27], a[108:111], a[92:95], v[24:27]
  v_exp_f32 v17, v17
  v_mfma_f32_16x16x32_bf16 v[28:31], a[124:127], a[92:95], 0
  ds_read_b64_tr_b16 a[212:213], v2 offset:16904
  v_fma_f32 v18, v18, s24, v12
  v_mfma_f32_16x16x32_bf16 v[28:31], a[120:123], a[88:91], v[28:31]
  v_exp_f32 v18, v18
  v_mfma_f32_16x16x32_bf16 v[28:31], a[116:119], a[84:87], v[28:31]
  ds_read_b64_tr_b16 a[214:215], v2 offset:25096
  v_fma_f32 v19, v19, s24, v12
  v_mfma_f32_16x16x32_bf16 v[28:31], a[112:115], a[80:83], v[28:31]
  v_exp_f32 v19, v19
  v_mfma_f32_16x16x32_bf16 v[160:163], a[160:163], v[36:39], v[160:163]
  v_fma_f32 v20, v20, s24, v12
  v_cvt_pk_bf16_f32 v32, v16, v17
  v_mfma_f32_16x16x32_bf16 v[164:167], a[164:167], v[36:39], v[164:167]
  v_exp_f32 v20, v20
  v_mfma_f32_16x16x32_bf16 v[168:171], a[168:171], v[36:39], v[168:171]
  v_fma_f32 v21, v21, s24, v12
  v_cvt_pk_bf16_f32 v33, v18, v19
  v_mfma_f32_16x16x32_bf16 v[172:175], a[172:175], v[36:39], v[172:175]
  v_exp_f32 v21, v21
  v_mfma_f32_16x16x32_bf16 v[176:179], a[176:179], v[36:39], v[176:179]
  v_fma_f32 v22, v22, s24, v12
  v_fma_f32 v23, v23, s24, v12
  v_mfma_f32_16x16x32_bf16 v[180:183], a[180:183], v[36:39], v[180:183]
  v_exp_f32 v22, v22
  v_mfma_f32_16x16x32_bf16 v[184:187], a[184:187], v[36:39], v[184:187]
  v_exp_f32 v23, v23
  v_mfma_f32_16x16x32_bf16 v[188:191], a[188:191], v[36:39], v[188:191]
  s_waitcnt lgkmcnt(14)
  v_cvt_pk_bf16_f32 v34, v20, v21
  v_cvt_pk_bf16_f32 v35, v22, v23
  v_mfma_f32_16x16x32_bf16 v[16:19], a[128:131], a[0:3], 0
  ds_read_b64_tr_b16 a[216:217], v2 offset:17152
  v_fma_f32 v24, v24, s24, v13
  v_mfma_f32_16x16x32_bf16 v[16:19], a[132:135], a[4:7], v[16:19]
  v_exp_f32 v24, v24
  v_mfma_f32_16x16x32_bf16 v[16:19], a[136:139], a[8:11], v[16:19]
  ds_read_b64_tr_b16 a[218:219], v2 offset:25344
  v_fma_f32 v25, v25, s24, v13
  v_mfma_f32_16x16x32_bf16 v[16:19], a[140:143], a[12:15], v[16:19]
  v_exp_f32 v25, v25
  v_mfma_f32_16x16x32_bf16 v[20:23], a[156:159], a[12:15], 0
  ds_read_b64_tr_b16 a[220:221], v2 offset:17160
  v_fma_f32 v26, v26, s24, v13
  v_mfma_f32_16x16x32_bf16 v[20:23], a[152:155], a[8:11], v[20:23]
  v_exp_f32 v26, v26
  v_mfma_f32_16x16x32_bf16 v[20:23], a[148:151], a[4:7], v[20:23]
  ds_read_b64_tr_b16 a[222:223], v2 offset:25352
  v_fma_f32 v27, v27, s24, v13
  v_mfma_f32_16x16x32_bf16 v[20:23], a[144:147], a[0:3], v[20:23]
  v_exp_f32 v27, v27
  v_mfma_f32_16x16x32_bf16 v[192:195], a[160:163], v[32:35], v[192:195]
  s_waitcnt lgkmcnt(8)
  v_fma_f32 v28, v28, s24, v13
  v_cvt_pk_bf16_f32 v36, v24, v25
  v_mfma_f32_16x16x32_bf16 v[196:199], a[164:167], v[32:35], v[196:199]
  buffer_store_dwordx4 a[232:235], v6, s[16:19], s22 offen offset:2176 sc1
  ds_read_b128 a[228:231], v63 offset:20480
  v_exp_f32 v28, v28
  v_mfma_f32_16x16x32_bf16 v[200:203], a[168:171], v[32:35], v[200:203]
  s_add_u32 s22, s22, 4096
  v_fma_f32 v29, v29, s24, v13
  v_cvt_pk_bf16_f32 v37, v26, v27
  v_mfma_f32_16x16x32_bf16 v[204:207], a[172:175], v[32:35], v[204:207]
  v_exp_f32 v29, v29
  v_mfma_f32_16x16x32_bf16 v[208:211], a[176:179], v[32:35], v[208:211]
  s_add_u32 s20, s20, 8192
  v_fma_f32 v30, v30, s24, v13
  v_fma_f32 v31, v31, s24, v13
  v_mfma_f32_16x16x32_bf16 v[212:215], a[180:183], v[32:35], v[212:215]
  v_exp_f32 v30, v30
  v_mfma_f32_16x16x32_bf16 v[216:219], a[184:187], v[32:35], v[216:219]
  s_add_u32 m0, s32, 16384
  v_exp_f32 v31, v31
  v_mfma_f32_16x16x32_bf16 v[220:223], a[188:191], v[32:35], v[220:223]
  s_waitcnt vmcnt(16) lgkmcnt(0)
  v_cvt_pk_bf16_f32 v38, v28, v29
  v_cvt_pk_bf16_f32 v39, v30, v31
  v_mfma_f32_16x16x32_bf16 v[24:27], a[128:131], a[16:19], 0
  s_barrier
  ds_read_b128 a[96:99], v1 offset:34816
  v_fma_f32 v16, v16, s24, v8
  v_smfmac_f32_16x16x64_bf16 v[48:51], a[224:227], v[32:39], v7
  buffer_load_dwordx4 v5, s[8:11], s20 offen offset:2048 lds
  v_mfma_f32_16x16x32_bf16 v[24:27], a[132:135], a[20:23], v[24:27]
  v_exp_f32 v16, v16
  v_mfma_f32_16x16x32_bf16 v[24:27], a[136:139], a[24:27], v[24:27]
  ds_read_b128 a[100:103], v1 offset:35072
  v_fma_f32 v17, v17, s24, v8
  v_mfma_f32_16x16x32_bf16 v[24:27], a[140:143], a[28:31], v[24:27]
  v_exp_f32 v17, v17
  v_mfma_f32_16x16x32_bf16 v[28:31], a[156:159], a[28:31], 0
  ds_read_b128 a[104:107], v1 offset:35328
  v_fma_f32 v18, v18, s24, v8
  v_mfma_f32_16x16x32_bf16 v[28:31], a[152:155], a[24:27], v[28:31]
  v_exp_f32 v18, v18
  v_mfma_f32_16x16x32_bf16 v[28:31], a[148:151], a[20:23], v[28:31]
  ds_read_b128 a[108:111], v1 offset:35584
  v_fma_f32 v19, v19, s24, v8
  v_mfma_f32_16x16x32_bf16 v[28:31], a[144:147], a[16:19], v[28:31]
  v_exp_f32 v19, v19
  v_mfma_f32_16x16x32_bf16 v[224:227], a[160:163], v[36:39], v[224:227]
  v_fma_f32 v20, v20, s24, v8
  v_cvt_pk_bf16_f32 v32, v16, v17
  v_mfma_f32_16x16x32_bf16 v[228:231], a[164:167], v[36:39], v[228:231]
  v_exp_f32 v20, v20
  v_mfma_f32_16x16x32_bf16 v[232:235], a[168:171], v[36:39], v[232:235]
  v_fma_f32 v21, v21, s24, v8
  v_cvt_pk_bf16_f32 v33, v18, v19
  v_mfma_f32_16x16x32_bf16 v[236:239], a[172:175], v[36:39], v[236:239]
  v_exp_f32 v21, v21
  v_mfma_f32_16x16x32_bf16 v[240:243], a[176:179], v[36:39], v[240:243]
  v_fma_f32 v22, v22, s24, v8
  v_fma_f32 v23, v23, s24, v8
  v_mfma_f32_16x16x32_bf16 v[244:247], a[180:183], v[36:39], v[244:247]
  v_exp_f32 v22, v22
  v_mfma_f32_16x16x32_bf16 v[248:251], a[184:187], v[36:39], v[248:251]
  v_exp_f32 v23, v23
  v_mfma_f32_16x16x32_bf16 v[252:255], a[188:191], v[36:39], v[252:255]
  v_cvt_pk_bf16_f32 v34, v20, v21
  v_cvt_pk_bf16_f32 v35, v22, v23
  v_mfma_f32_16x16x32_bf16 v[16:19], a[128:131], a[32:35], 0
  ds_read_b128 a[112:115], v1 offset:43008
  v_fma_f32 v24, v24, s24, v9
  v_mfma_f32_16x16x32_bf16 v[16:19], a[132:135], a[36:39], v[16:19]
  v_exp_f32 v24, v24
  v_mfma_f32_16x16x32_bf16 v[16:19], a[136:139], a[40:43], v[16:19]
  ds_read_b128 a[116:119], v1 offset:43264
  v_fma_f32 v25, v25, s24, v9
  v_mfma_f32_16x16x32_bf16 v[16:19], a[140:143], a[44:47], v[16:19]
  buffer_load_dwordx4 v5, s[8:11], s20 offen offset:3072 lds
  v_exp_f32 v25, v25
  v_mfma_f32_16x16x32_bf16 v[20:23], a[156:159], a[44:47], 0
  ds_read_b128 a[120:123], v1 offset:43520
  v_fma_f32 v26, v26, s24, v9
  v_mfma_f32_16x16x32_bf16 v[20:23], a[152:155], a[40:43], v[20:23]
  v_exp_f32 v26, v26
  v_mfma_f32_16x16x32_bf16 v[20:23], a[148:151], a[36:39], v[20:23]
  ds_read_b128 a[124:127], v1 offset:43776
  v_fma_f32 v27, v27, s24, v9
  v_mfma_f32_16x16x32_bf16 v[20:23], a[144:147], a[32:35], v[20:23]
  v_exp_f32 v27, v27
  v_mfma_f32_16x16x32_bf16 v[64:67], a[192:195], v[32:35], v[64:67]
  s_waitcnt lgkmcnt(8)
  v_fma_f32 v28, v28, s24, v9
  v_cvt_pk_bf16_f32 v36, v24, v25
  v_mfma_f32_16x16x32_bf16 v[68:71], a[196:199], v[32:35], v[68:71]
  buffer_store_dwordx4 a[228:231], v6, s[16:19], s22 offen sc1
  ds_read_b128 a[232:235], v63 offset:20992
  v_exp_f32 v28, v28
  v_mfma_f32_16x16x32_bf16 v[72:75], a[200:203], v[32:35], v[72:75]
  v_fma_f32 v29, v29, s24, v9
  v_cvt_pk_bf16_f32 v37, v26, v27
  v_mfma_f32_16x16x32_bf16 v[76:79], a[204:207], v[32:35], v[76:79]
  v_exp_f32 v29, v29
  v_mfma_f32_16x16x32_bf16 v[80:83], a[208:211], v[32:35], v[80:83]
  v_fma_f32 v30, v30, s24, v9
  v_fma_f32 v31, v31, s24, v9
  v_mfma_f32_16x16x32_bf16 v[84:87], a[212:215], v[32:35], v[84:87]
  v_exp_f32 v30, v30
  v_mfma_f32_16x16x32_bf16 v[88:91], a[216:219], v[32:35], v[88:91]
  v_exp_f32 v31, v31
  v_mfma_f32_16x16x32_bf16 v[92:95], a[220:223], v[32:35], v[92:95]
  v_cvt_pk_bf16_f32 v38, v28, v29
  v_cvt_pk_bf16_f32 v39, v30, v31
  v_mfma_f32_16x16x32_bf16 v[24:27], a[128:131], a[48:51], 0
  ds_read_b64_tr_b16 a[160:161], v2 offset:32768
  v_fma_f32 v16, v16, s24, v10
  v_smfmac_f32_16x16x64_bf16 v[40:43], a[224:227], v[32:39], v7
  buffer_load_dwordx4 v4, s[12:15], s20 offen lds
  v_mfma_f32_16x16x32_bf16 v[24:27], a[132:135], a[52:55], v[24:27]
  v_exp_f32 v16, v16
  v_mfma_f32_16x16x32_bf16 v[24:27], a[136:139], a[56:59], v[24:27]
  ds_read_b64_tr_b16 a[162:163], v2 offset:40960
  v_fma_f32 v17, v17, s24, v10
  v_mfma_f32_16x16x32_bf16 v[24:27], a[140:143], a[60:63], v[24:27]
  v_exp_f32 v17, v17
  v_mfma_f32_16x16x32_bf16 v[28:31], a[156:159], a[60:63], 0
  ds_read_b64_tr_b16 a[164:165], v2 offset:32776
  v_fma_f32 v18, v18, s24, v10
  v_mfma_f32_16x16x32_bf16 v[28:31], a[152:155], a[56:59], v[28:31]
  v_exp_f32 v18, v18
  v_mfma_f32_16x16x32_bf16 v[28:31], a[148:151], a[52:55], v[28:31]
  ds_read_b64_tr_b16 a[166:167], v2 offset:40968
  v_fma_f32 v19, v19, s24, v10
  v_mfma_f32_16x16x32_bf16 v[28:31], a[144:147], a[48:51], v[28:31]
  v_exp_f32 v19, v19
  v_mfma_f32_16x16x32_bf16 v[96:99], a[192:195], v[36:39], v[96:99]
  s_waitcnt lgkmcnt(4)
  v_fma_f32 v20, v20, s24, v10
  v_cvt_pk_bf16_f32 v32, v16, v17
  v_mfma_f32_16x16x32_bf16 v[100:103], a[196:199], v[36:39], v[100:103]
  buffer_store_dwordx4 a[232:235], v6, s[16:19], s22 offen offset:2048 sc1
  ds_read_b128 a[228:231], v63 offset:22528
  v_exp_f32 v20, v20
  v_mfma_f32_16x16x32_bf16 v[104:107], a[200:203], v[36:39], v[104:107]
  v_fma_f32 v21, v21, s24, v10
  v_cvt_pk_bf16_f32 v33, v18, v19
  v_mfma_f32_16x16x32_bf16 v[108:111], a[204:207], v[36:39], v[108:111]
  v_exp_f32 v21, v21
  v_mfma_f32_16x16x32_bf16 v[112:115], a[208:211], v[36:39], v[112:115]
  v_fma_f32 v22, v22, s24, v10
  v_fma_f32 v23, v23, s24, v10
  v_mfma_f32_16x16x32_bf16 v[116:119], a[212:215], v[36:39], v[116:119]
  v_exp_f32 v22, v22
  v_mfma_f32_16x16x32_bf16 v[120:123], a[216:219], v[36:39], v[120:123]
  v_exp_f32 v23, v23
  v_mfma_f32_16x16x32_bf16 v[124:127], a[220:223], v[36:39], v[124:127]
  v_cvt_pk_bf16_f32 v34, v20, v21
  v_cvt_pk_bf16_f32 v35, v22, v23
  v_mfma_f32_16x16x32_bf16 v[16:19], a[128:131], a[64:67], 0
  ds_read_b64_tr_b16 a[168:169], v2 offset:33024
  v_fma_f32 v24, v24, s24, v11
  v_mfma_f32_16x16x32_bf16 v[16:19], a[132:135], a[68:71], v[16:19]
  v_exp_f32 v24, v24
  v_mfma_f32_16x16x32_bf16 v[16:19], a[136:139], a[72:75], v[16:19]
  ds_read_b64_tr_b16 a[170:171], v2 offset:41216
  v_fma_f32 v25, v25, s24, v11
  v_mfma_f32_16x16x32_bf16 v[16:19], a[140:143], a[76:79], v[16:19]
  v_exp_f32 v25, v25
  v_mfma_f32_16x16x32_bf16 v[20:23], a[156:159], a[76:79], 0
  ds_read_b64_tr_b16 a[172:173], v2 offset:33032
  v_fma_f32 v26, v26, s24, v11
  v_mfma_f32_16x16x32_bf16 v[20:23], a[152:155], a[72:75], v[20:23]
  v_exp_f32 v26, v26
  v_mfma_f32_16x16x32_bf16 v[20:23], a[148:151], a[68:71], v[20:23]
  ds_read_b64_tr_b16 a[174:175], v2 offset:41224
  v_fma_f32 v27, v27, s24, v11
  v_mfma_f32_16x16x32_bf16 v[20:23], a[144:147], a[64:67], v[20:23]
  v_exp_f32 v27, v27
  v_mfma_f32_16x16x32_bf16 v[128:131], a[192:195], v[32:35], v[128:131]
  v_fma_f32 v28, v28, s24, v11
  v_cvt_pk_bf16_f32 v36, v24, v25
  v_mfma_f32_16x16x32_bf16 v[132:135], a[196:199], v[32:35], v[132:135]
  v_exp_f32 v28, v28
  v_mfma_f32_16x16x32_bf16 v[136:139], a[200:203], v[32:35], v[136:139]
  v_fma_f32 v29, v29, s24, v11
  v_cvt_pk_bf16_f32 v37, v26, v27
  v_mfma_f32_16x16x32_bf16 v[140:143], a[204:207], v[32:35], v[140:143]
  v_exp_f32 v29, v29
  v_mfma_f32_16x16x32_bf16 v[144:147], a[208:211], v[32:35], v[144:147]
  v_fma_f32 v30, v30, s24, v11
  v_fma_f32 v31, v31, s24, v11
  v_mfma_f32_16x16x32_bf16 v[148:151], a[212:215], v[32:35], v[148:151]
  v_exp_f32 v30, v30
  v_mfma_f32_16x16x32_bf16 v[152:155], a[216:219], v[32:35], v[152:155]
  v_exp_f32 v31, v31
  v_mfma_f32_16x16x32_bf16 v[156:159], a[220:223], v[32:35], v[156:159]
  v_cvt_pk_bf16_f32 v38, v28, v29
  v_cvt_pk_bf16_f32 v39, v30, v31
  v_mfma_f32_16x16x32_bf16 v[24:27], a[128:131], a[80:83], 0
  ds_read_b64_tr_b16 a[176:177], v2 offset:33280
  v_fma_f32 v16, v16, s24, v12
  v_smfmac_f32_16x16x64_bf16 v[44:47], a[224:227], v[32:39], v7
  buffer_load_dwordx4 v4, s[12:15], s20 offen offset:1024 lds
  v_mfma_f32_16x16x32_bf16 v[24:27], a[132:135], a[84:87], v[24:27]
  v_exp_f32 v16, v16
  v_mfma_f32_16x16x32_bf16 v[24:27], a[136:139], a[88:91], v[24:27]
  ds_read_b64_tr_b16 a[178:179], v2 offset:41472
  v_fma_f32 v17, v17, s24, v12
  v_mfma_f32_16x16x32_bf16 v[24:27], a[140:143], a[92:95], v[24:27]
  v_exp_f32 v17, v17
  v_mfma_f32_16x16x32_bf16 v[28:31], a[156:159], a[92:95], 0
  ds_read_b64_tr_b16 a[180:181], v2 offset:33288
  v_fma_f32 v18, v18, s24, v12
  v_mfma_f32_16x16x32_bf16 v[28:31], a[152:155], a[88:91], v[28:31]
  v_exp_f32 v18, v18
  v_mfma_f32_16x16x32_bf16 v[28:31], a[148:151], a[84:87], v[28:31]
  ds_read_b64_tr_b16 a[182:183], v2 offset:41480
  v_fma_f32 v19, v19, s24, v12
  v_mfma_f32_16x16x32_bf16 v[28:31], a[144:147], a[80:83], v[28:31]
  v_exp_f32 v19, v19
  v_mfma_f32_16x16x32_bf16 v[160:163], a[192:195], v[36:39], v[160:163]
  s_waitcnt lgkmcnt(8)
  v_fma_f32 v20, v20, s24, v12
  v_cvt_pk_bf16_f32 v32, v16, v17
  v_mfma_f32_16x16x32_bf16 v[164:167], a[196:199], v[36:39], v[164:167]
  buffer_store_dwordx4 a[228:231], v6, s[16:19], s22 offen offset:128 sc1
  ds_read_b128 a[232:235], v63 offset:23040
  v_exp_f32 v20, v20
  v_mfma_f32_16x16x32_bf16 v[168:171], a[200:203], v[36:39], v[168:171]
  v_fma_f32 v21, v21, s24, v12
  v_cvt_pk_bf16_f32 v33, v18, v19
  v_mfma_f32_16x16x32_bf16 v[172:175], a[204:207], v[36:39], v[172:175]
  v_exp_f32 v21, v21
  v_mfma_f32_16x16x32_bf16 v[176:179], a[208:211], v[36:39], v[176:179]
  v_fma_f32 v22, v22, s24, v12
  v_fma_f32 v23, v23, s24, v12
  v_mfma_f32_16x16x32_bf16 v[180:183], a[212:215], v[36:39], v[180:183]
  v_exp_f32 v22, v22
  v_mfma_f32_16x16x32_bf16 v[184:187], a[216:219], v[36:39], v[184:187]
  v_exp_f32 v23, v23
  v_mfma_f32_16x16x32_bf16 v[188:191], a[220:223], v[36:39], v[188:191]
  s_waitcnt lgkmcnt(15)
  v_cvt_pk_bf16_f32 v34, v20, v21
  v_cvt_pk_bf16_f32 v35, v22, v23
  v_mfma_f32_16x16x32_bf16 v[16:19], a[96:99], a[0:3], 0
  ds_read_b64_tr_b16 a[184:185], v2 offset:33536
  v_fma_f32 v24, v24, s24, v13
  v_mfma_f32_16x16x32_bf16 v[16:19], a[100:103], a[4:7], v[16:19]
  v_exp_f32 v24, v24
  v_mfma_f32_16x16x32_bf16 v[16:19], a[104:107], a[8:11], v[16:19]
  ds_read_b64_tr_b16 a[186:187], v2 offset:41728
  v_fma_f32 v25, v25, s24, v13
  v_mfma_f32_16x16x32_bf16 v[16:19], a[108:111], a[12:15], v[16:19]
  v_exp_f32 v25, v25
  v_mfma_f32_16x16x32_bf16 v[20:23], a[124:127], a[12:15], 0
  ds_read_b64_tr_b16 a[188:189], v2 offset:33544
  v_fma_f32 v26, v26, s24, v13
  v_mfma_f32_16x16x32_bf16 v[20:23], a[120:123], a[8:11], v[20:23]
  v_exp_f32 v26, v26
  v_mfma_f32_16x16x32_bf16 v[20:23], a[116:119], a[4:7], v[20:23]
  ds_read_b64_tr_b16 a[190:191], v2 offset:41736
  v_fma_f32 v27, v27, s24, v13
  v_mfma_f32_16x16x32_bf16 v[20:23], a[112:115], a[0:3], v[20:23]
  v_exp_f32 v27, v27
  v_mfma_f32_16x16x32_bf16 v[192:195], a[192:195], v[32:35], v[192:195]
  v_fma_f32 v28, v28, s24, v13
  v_cvt_pk_bf16_f32 v36, v24, v25
  v_mfma_f32_16x16x32_bf16 v[196:199], a[196:199], v[32:35], v[196:199]
  v_exp_f32 v28, v28
  v_mfma_f32_16x16x32_bf16 v[200:203], a[200:203], v[32:35], v[200:203]
  v_fma_f32 v29, v29, s24, v13
  v_cvt_pk_bf16_f32 v37, v26, v27
  v_mfma_f32_16x16x32_bf16 v[204:207], a[204:207], v[32:35], v[204:207]
  v_exp_f32 v29, v29
  v_mfma_f32_16x16x32_bf16 v[208:211], a[208:211], v[32:35], v[208:211]
  s_add_u32 s20, s20, 8192
  v_fma_f32 v30, v30, s24, v13
  v_fma_f32 v31, v31, s24, v13
  v_mfma_f32_16x16x32_bf16 v[212:215], a[212:215], v[32:35], v[212:215]
  v_exp_f32 v30, v30
  v_mfma_f32_16x16x32_bf16 v[216:219], a[216:219], v[32:35], v[216:219]
  s_add_u32 m0, s32, 32768
  v_exp_f32 v31, v31
  v_mfma_f32_16x16x32_bf16 v[220:223], a[220:223], v[32:35], v[220:223]
  s_waitcnt vmcnt(16) lgkmcnt(0)
  v_cvt_pk_bf16_f32 v38, v28, v29
  v_cvt_pk_bf16_f32 v39, v30, v31
  v_mfma_f32_16x16x32_bf16 v[24:27], a[96:99], a[16:19], 0
  s_barrier
  ds_read_b128 a[128:131], v1 offset:51200
  v_fma_f32 v16, v16, s24, v8
  v_smfmac_f32_16x16x64_bf16 v[48:51], a[224:227], v[32:39], v7
  buffer_load_dwordx4 v5, s[8:11], s20 offen offset:2048 lds
  v_mfma_f32_16x16x32_bf16 v[24:27], a[100:103], a[20:23], v[24:27]
L_pad4:
  s_cbranch_execz L_pad5
  v_exp_f32 v16, v16
  v_mfma_f32_16x16x32_bf16 v[24:27], a[104:107], a[24:27], v[24:27]
  ds_read_b128 a[132:135], v1 offset:51456
  v_fma_f32 v17, v17, s24, v8
  v_mfma_f32_16x16x32_bf16 v[24:27], a[108:111], a[28:31], v[24:27]
  v_exp_f32 v17, v17
  v_mfma_f32_16x16x32_bf16 v[28:31], a[124:127], a[28:31], 0
  ds_read_b128 a[136:139], v1 offset:51712
  v_fma_f32 v18, v18, s24, v8
  v_mfma_f32_16x16x32_bf16 v[28:31], a[120:123], a[24:27], v[28:31]
  v_exp_f32 v18, v18
  v_mfma_f32_16x16x32_bf16 v[28:31], a[116:119], a[20:23], v[28:31]
  ds_read_b128 a[140:143], v1 offset:51968
  v_fma_f32 v19, v19, s24, v8
  v_mfma_f32_16x16x32_bf16 v[28:31], a[112:115], a[16:19], v[28:31]
  v_exp_f32 v19, v19
  v_mfma_f32_16x16x32_bf16 v[224:227], a[192:195], v[36:39], v[224:227]
  s_waitcnt lgkmcnt(8)
  v_fma_f32 v20, v20, s24, v8
  v_cvt_pk_bf16_f32 v32, v16, v17
  v_mfma_f32_16x16x32_bf16 v[228:231], a[196:199], v[36:39], v[228:231]
  buffer_store_dwordx4 a[232:235], v6, s[16:19], s22 offen offset:2176 sc1
  v_exp_f32 v20, v20
  v_mfma_f32_16x16x32_bf16 v[232:235], a[200:203], v[36:39], v[232:235]
  v_fma_f32 v21, v21, s24, v8
  v_cvt_pk_bf16_f32 v33, v18, v19
  v_mfma_f32_16x16x32_bf16 v[236:239], a[204:207], v[36:39], v[236:239]
  v_exp_f32 v21, v21
  v_mfma_f32_16x16x32_bf16 v[240:243], a[208:211], v[36:39], v[240:243]
  v_fma_f32 v22, v22, s24, v8
  v_fma_f32 v23, v23, s24, v8
  v_mfma_f32_16x16x32_bf16 v[244:247], a[212:215], v[36:39], v[244:247]
  v_exp_f32 v22, v22
  v_mfma_f32_16x16x32_bf16 v[248:251], a[216:219], v[36:39], v[248:251]
  v_exp_f32 v23, v23
  v_mfma_f32_16x16x32_bf16 v[252:255], a[220:223], v[36:39], v[252:255]
  v_cvt_pk_bf16_f32 v34, v20, v21
  v_cvt_pk_bf16_f32 v35, v22, v23
  v_mfma_f32_16x16x32_bf16 v[16:19], a[96:99], a[32:35], 0
  ds_read_b128 a[144:147], v1 offset:59392
  v_fma_f32 v24, v24, s24, v9
  v_mfma_f32_16x16x32_bf16 v[16:19], a[100:103], a[36:39], v[16:19]
  v_exp_f32 v24, v24
  v_mfma_f32_16x16x32_bf16 v[16:19], a[104:107], a[40:43], v[16:19]
  ds_read_b128 a[148:151], v1 offset:59648
  v_fma_f32 v25, v25, s24, v9
  v_mfma_f32_16x16x32_bf16 v[16:19], a[108:111], a[44:47], v[16:19]
  buffer_load_dwordx4 v5, s[8:11], s20 offen offset:3072 lds
  v_exp_f32 v25, v25
  v_mfma_f32_16x16x32_bf16 v[20:23], a[124:127], a[44:47], 0
  ds_read_b128 a[152:155], v1 offset:59904
  v_fma_f32 v26, v26, s24, v9
  v_mfma_f32_16x16x32_bf16 v[20:23], a[120:123], a[40:43], v[20:23]
  v_exp_f32 v26, v26
  v_mfma_f32_16x16x32_bf16 v[20:23], a[116:119], a[36:39], v[20:23]
  ds_read_b128 a[156:159], v1 offset:60160
  v_fma_f32 v27, v27, s24, v9
  v_mfma_f32_16x16x32_bf16 v[20:23], a[112:115], a[32:35], v[20:23]
  v_exp_f32 v27, v27
  v_mfma_f32_16x16x32_bf16 v[64:67], a[160:163], v[32:35], v[64:67]
  s_mov_b32 m0, s33
  v_fma_f32 v28, v28, s24, v9
  v_cvt_pk_bf16_f32 v36, v24, v25
  v_mfma_f32_16x16x32_bf16 v[68:71], a[164:167], v[32:35], v[68:71]
  buffer_load_dwordx4 v4, s[4:7], s21 offen nt lds
  v_exp_f32 v28, v28
  v_mfma_f32_16x16x32_bf16 v[72:75], a[168:171], v[32:35], v[72:75]
  v_fma_f32 v29, v29, s24, v9
  v_cvt_pk_bf16_f32 v37, v26, v27
  v_mfma_f32_16x16x32_bf16 v[76:79], a[172:175], v[32:35], v[76:79]
  v_exp_f32 v29, v29
  v_mfma_f32_16x16x32_bf16 v[80:83], a[176:179], v[32:35], v[80:83]
  v_fma_f32 v30, v30, s24, v9
  v_fma_f32 v31, v31, s24, v9
  v_mfma_f32_16x16x32_bf16 v[84:87], a[180:183], v[32:35], v[84:87]
  v_exp_f32 v30, v30
  v_mfma_f32_16x16x32_bf16 v[88:91], a[184:187], v[32:35], v[88:91]
  v_exp_f32 v31, v31
  v_mfma_f32_16x16x32_bf16 v[92:95], a[188:191], v[32:35], v[92:95]
  v_cvt_pk_bf16_f32 v38, v28, v29
  v_cvt_pk_bf16_f32 v39, v30, v31
  v_mfma_f32_16x16x32_bf16 v[24:27], a[96:99], a[48:51], 0
  s_add_u32 m0, s32, 32768
  ds_read_b64_tr_b16 a[192:193], v2 offset:49152
  v_fma_f32 v16, v16, s24, v10
  v_smfmac_f32_16x16x64_bf16 v[40:43], a[224:227], v[32:39], v7
  buffer_load_dwordx4 v4, s[12:15], s20 offen lds
  v_mfma_f32_16x16x32_bf16 v[24:27], a[100:103], a[52:55], v[24:27]
  v_exp_f32 v16, v16
  v_mfma_f32_16x16x32_bf16 v[24:27], a[104:107], a[56:59], v[24:27]
  ds_read_b64_tr_b16 a[194:195], v2 offset:57344
  v_fma_f32 v17, v17, s24, v10
  v_mfma_f32_16x16x32_bf16 v[24:27], a[108:111], a[60:63], v[24:27]
  v_exp_f32 v17, v17
  v_mfma_f32_16x16x32_bf16 v[28:31], a[124:127], a[60:63], 0
  ds_read_b64_tr_b16 a[196:197], v2 offset:49160
  v_fma_f32 v18, v18, s24, v10
  v_mfma_f32_16x16x32_bf16 v[28:31], a[120:123], a[56:59], v[28:31]
  v_exp_f32 v18, v18
  v_mfma_f32_16x16x32_bf16 v[28:31], a[116:119], a[52:55], v[28:31]
  ds_read_b64_tr_b16 a[198:199], v2 offset:57352
  v_fma_f32 v19, v19, s24, v10
  v_mfma_f32_16x16x32_bf16 v[28:31], a[112:115], a[48:51], v[28:31]
  v_exp_f32 v19, v19
  v_mfma_f32_16x16x32_bf16 v[96:99], a[160:163], v[36:39], v[96:99]
  v_fma_f32 v20, v20, s24, v10
  v_cvt_pk_bf16_f32 v32, v16, v17
  v_mfma_f32_16x16x32_bf16 v[100:103], a[164:167], v[36:39], v[100:103]
  v_exp_f32 v20, v20
  v_mfma_f32_16x16x32_bf16 v[104:107], a[168:171], v[36:39], v[104:107]
  v_fma_f32 v21, v21, s24, v10
  v_cvt_pk_bf16_f32 v33, v18, v19
  v_mfma_f32_16x16x32_bf16 v[108:111], a[172:175], v[36:39], v[108:111]
  v_exp_f32 v21, v21
  v_mfma_f32_16x16x32_bf16 v[112:115], a[176:179], v[36:39], v[112:115]
  v_fma_f32 v22, v22, s24, v10
  v_fma_f32 v23, v23, s24, v10
  v_mfma_f32_16x16x32_bf16 v[116:119], a[180:183], v[36:39], v[116:119]
  v_exp_f32 v22, v22
  v_mfma_f32_16x16x32_bf16 v[120:123], a[184:187], v[36:39], v[120:123]
  v_exp_f32 v23, v23
  v_mfma_f32_16x16x32_bf16 v[124:127], a[188:191], v[36:39], v[124:127]
  v_cvt_pk_bf16_f32 v34, v20, v21
  v_cvt_pk_bf16_f32 v35, v22, v23
  v_mfma_f32_16x16x32_bf16 v[16:19], a[96:99], a[64:67], 0
  ds_read_b64_tr_b16 a[200:201], v2 offset:49408
  v_fma_f32 v24, v24, s24, v11
  v_mfma_f32_16x16x32_bf16 v[16:19], a[100:103], a[68:71], v[16:19]
  v_exp_f32 v24, v24
  v_mfma_f32_16x16x32_bf16 v[16:19], a[104:107], a[72:75], v[16:19]
  ds_read_b64_tr_b16 a[202:203], v2 offset:57600
  v_fma_f32 v25, v25, s24, v11
  v_mfma_f32_16x16x32_bf16 v[16:19], a[108:111], a[76:79], v[16:19]
  v_exp_f32 v25, v25
  v_mfma_f32_16x16x32_bf16 v[20:23], a[124:127], a[76:79], 0
  ds_read_b64_tr_b16 a[204:205], v2 offset:49416
  v_fma_f32 v26, v26, s24, v11
  v_mfma_f32_16x16x32_bf16 v[20:23], a[120:123], a[72:75], v[20:23]
  v_exp_f32 v26, v26
  v_mfma_f32_16x16x32_bf16 v[20:23], a[116:119], a[68:71], v[20:23]
  ds_read_b64_tr_b16 a[206:207], v2 offset:57608
  v_fma_f32 v27, v27, s24, v11
  v_mfma_f32_16x16x32_bf16 v[20:23], a[112:115], a[64:67], v[20:23]
  v_exp_f32 v27, v27
  v_mfma_f32_16x16x32_bf16 v[128:131], a[160:163], v[32:35], v[128:131]
  s_mov_b32 m0, s33
  v_fma_f32 v28, v28, s24, v11
  v_cvt_pk_bf16_f32 v36, v24, v25
  v_mfma_f32_16x16x32_bf16 v[132:135], a[164:167], v[32:35], v[132:135]
  buffer_load_dwordx4 v4, s[4:7], s21 offen offset:1024 nt lds
  v_exp_f32 v28, v28
  v_mfma_f32_16x16x32_bf16 v[136:139], a[168:171], v[32:35], v[136:139]
  v_fma_f32 v29, v29, s24, v11
  v_cvt_pk_bf16_f32 v37, v26, v27
  v_mfma_f32_16x16x32_bf16 v[140:143], a[172:175], v[32:35], v[140:143]
  v_exp_f32 v29, v29
  v_mfma_f32_16x16x32_bf16 v[144:147], a[176:179], v[32:35], v[144:147]
  v_fma_f32 v30, v30, s24, v11
  v_fma_f32 v31, v31, s24, v11
  v_mfma_f32_16x16x32_bf16 v[148:151], a[180:183], v[32:35], v[148:151]
  v_exp_f32 v30, v30
  v_mfma_f32_16x16x32_bf16 v[152:155], a[184:187], v[32:35], v[152:155]
  v_exp_f32 v31, v31
  v_mfma_f32_16x16x32_bf16 v[156:159], a[188:191], v[32:35], v[156:159]
  v_cvt_pk_bf16_f32 v38, v28, v29
  v_cvt_pk_bf16_f32 v39, v30, v31
  v_mfma_f32_16x16x32_bf16 v[24:27], a[96:99], a[80:83], 0
  s_add_u32 m0, s32, 32768
  ds_read_b64_tr_b16 a[208:209], v2 offset:49664
  v_fma_f32 v16, v16, s24, v12
  v_smfmac_f32_16x16x64_bf16 v[44:47], a[224:227], v[32:39], v7
  buffer_load_dwordx4 v4, s[12:15], s20 offen offset:1024 lds
  v_mfma_f32_16x16x32_bf16 v[24:27], a[100:103], a[84:87], v[24:27]
  v_exp_f32 v16, v16
  v_mfma_f32_16x16x32_bf16 v[24:27], a[104:107], a[88:91], v[24:27]
  ds_read_b64_tr_b16 a[210:211], v2 offset:57856
  v_fma_f32 v17, v17, s24, v12
  v_mfma_f32_16x16x32_bf16 v[24:27], a[108:111], a[92:95], v[24:27]
  v_exp_f32 v17, v17
  v_mfma_f32_16x16x32_bf16 v[28:31], a[124:127], a[92:95], 0
  ds_read_b64_tr_b16 a[212:213], v2 offset:49672
  v_fma_f32 v18, v18, s24, v12
  v_mfma_f32_16x16x32_bf16 v[28:31], a[120:123], a[88:91], v[28:31]
  v_exp_f32 v18, v18
  v_mfma_f32_16x16x32_bf16 v[28:31], a[116:119], a[84:87], v[28:31]
  ds_read_b64_tr_b16 a[214:215], v2 offset:57864
  v_fma_f32 v19, v19, s24, v12
  v_mfma_f32_16x16x32_bf16 v[28:31], a[112:115], a[80:83], v[28:31]
  v_exp_f32 v19, v19
  v_mfma_f32_16x16x32_bf16 v[160:163], a[160:163], v[36:39], v[160:163]
  v_fma_f32 v20, v20, s24, v12
  v_cvt_pk_bf16_f32 v32, v16, v17
  v_mfma_f32_16x16x32_bf16 v[164:167], a[164:167], v[36:39], v[164:167]
  v_exp_f32 v20, v20
  v_mfma_f32_16x16x32_bf16 v[168:171], a[168:171], v[36:39], v[168:171]
  v_fma_f32 v21, v21, s24, v12
  v_cvt_pk_bf16_f32 v33, v18, v19
  v_mfma_f32_16x16x32_bf16 v[172:175], a[172:175], v[36:39], v[172:175]
  v_exp_f32 v21, v21
  v_mfma_f32_16x16x32_bf16 v[176:179], a[176:179], v[36:39], v[176:179]
  v_fma_f32 v22, v22, s24, v12
  v_fma_f32 v23, v23, s24, v12
  v_mfma_f32_16x16x32_bf16 v[180:183], a[180:183], v[36:39], v[180:183]
  v_exp_f32 v22, v22
  v_mfma_f32_16x16x32_bf16 v[184:187], a[184:187], v[36:39], v[184:187]
  v_exp_f32 v23, v23
  v_mfma_f32_16x16x32_bf16 v[188:191], a[188:191], v[36:39], v[188:191]
  s_waitcnt lgkmcnt(12)
  v_cvt_pk_bf16_f32 v34, v20, v21
  v_cvt_pk_bf16_f32 v35, v22, v23
  v_mfma_f32_16x16x32_bf16 v[16:19], a[128:131], a[0:3], 0
  ds_read_b64_tr_b16 a[216:217], v2 offset:49920
  v_fma_f32 v24, v24, s24, v13
  v_mfma_f32_16x16x32_bf16 v[16:19], a[132:135], a[4:7], v[16:19]
  v_exp_f32 v24, v24
  v_mfma_f32_16x16x32_bf16 v[16:19], a[136:139], a[8:11], v[16:19]
  ds_read_b64_tr_b16 a[218:219], v2 offset:58112
  v_fma_f32 v25, v25, s24, v13
  v_mfma_f32_16x16x32_bf16 v[16:19], a[140:143], a[12:15], v[16:19]
  v_exp_f32 v25, v25
  v_mfma_f32_16x16x32_bf16 v[20:23], a[156:159], a[12:15], 0
  ds_read_b64_tr_b16 a[220:221], v2 offset:49928
  v_fma_f32 v26, v26, s24, v13
  v_mfma_f32_16x16x32_bf16 v[20:23], a[152:155], a[8:11], v[20:23]
  v_exp_f32 v26, v26
  v_mfma_f32_16x16x32_bf16 v[20:23], a[148:151], a[4:7], v[20:23]
  ds_read_b64_tr_b16 a[222:223], v2 offset:58120
  v_fma_f32 v27, v27, s24, v13
  v_mfma_f32_16x16x32_bf16 v[20:23], a[144:147], a[0:3], v[20:23]
  v_exp_f32 v27, v27
  v_mfma_f32_16x16x32_bf16 v[192:195], a[160:163], v[32:35], v[192:195]
  s_mov_b32 m0, s33
  v_fma_f32 v28, v28, s24, v13
  v_cvt_pk_bf16_f32 v36, v24, v25
  v_mfma_f32_16x16x32_bf16 v[196:199], a[164:167], v[32:35], v[196:199]
  buffer_load_dwordx4 v4, s[4:7], s21 offen offset:2048 nt lds
  v_exp_f32 v28, v28
  v_mfma_f32_16x16x32_bf16 v[200:203], a[168:171], v[32:35], v[200:203]
  v_fma_f32 v29, v29, s24, v13
  v_cvt_pk_bf16_f32 v37, v26, v27
  v_mfma_f32_16x16x32_bf16 v[204:207], a[172:175], v[32:35], v[204:207]
  v_exp_f32 v29, v29
  v_mfma_f32_16x16x32_bf16 v[208:211], a[176:179], v[32:35], v[208:211]
  s_add_u32 s20, s20, 8192
  v_fma_f32 v30, v30, s24, v13
  v_fma_f32 v31, v31, s24, v13
  v_mfma_f32_16x16x32_bf16 v[212:215], a[180:183], v[32:35], v[212:215]
  v_exp_f32 v30, v30
  v_mfma_f32_16x16x32_bf16 v[216:219], a[184:187], v[32:35], v[216:219]
  s_add_u32 m0, s32, 49152
  v_exp_f32 v31, v31
  v_mfma_f32_16x16x32_bf16 v[220:223], a[188:191], v[32:35], v[220:223]
  s_waitcnt vmcnt(16) lgkmcnt(0)
  v_cvt_pk_bf16_f32 v38, v28, v29
  v_cvt_pk_bf16_f32 v39, v30, v31
  v_mfma_f32_16x16x32_bf16 v[24:27], a[128:131], a[16:19], 0
  s_barrier
  ds_read_b128 a[96:99], v1 offset:2048
  v_fma_f32 v16, v16, s24, v8
  v_smfmac_f32_16x16x64_bf16 v[48:51], a[224:227], v[32:39], v7
  buffer_load_dwordx4 v5, s[8:11], s20 offen offset:2048 lds
  v_mfma_f32_16x16x32_bf16 v[24:27], a[132:135], a[20:23], v[24:27]
  v_exp_f32 v16, v16
  v_mfma_f32_16x16x32_bf16 v[24:27], a[136:139], a[24:27], v[24:27]
  ds_read_b128 a[100:103], v1 offset:2304
  v_fma_f32 v17, v17, s24, v8
  v_mfma_f32_16x16x32_bf16 v[24:27], a[140:143], a[28:31], v[24:27]
  v_exp_f32 v17, v17
  v_mfma_f32_16x16x32_bf16 v[28:31], a[156:159], a[28:31], 0
  ds_read_b128 a[104:107], v1 offset:2560
  v_fma_f32 v18, v18, s24, v8
  v_mfma_f32_16x16x32_bf16 v[28:31], a[152:155], a[24:27], v[28:31]
  v_exp_f32 v18, v18
  v_mfma_f32_16x16x32_bf16 v[28:31], a[148:151], a[20:23], v[28:31]
  ds_read_b128 a[108:111], v1 offset:2816
  v_fma_f32 v19, v19, s24, v8
  v_mfma_f32_16x16x32_bf16 v[28:31], a[144:147], a[16:19], v[28:31]
  v_exp_f32 v19, v19
  v_mfma_f32_16x16x32_bf16 v[224:227], a[160:163], v[36:39], v[224:227]
  v_fma_f32 v20, v20, s24, v8
  v_cvt_pk_bf16_f32 v32, v16, v17
  v_mfma_f32_16x16x32_bf16 v[228:231], a[164:167], v[36:39], v[228:231]
  v_exp_f32 v20, v20
  v_mfma_f32_16x16x32_bf16 v[232:235], a[168:171], v[36:39], v[232:235]
  v_fma_f32 v21, v21, s24, v8
  v_cvt_pk_bf16_f32 v33, v18, v19
  v_mfma_f32_16x16x32_bf16 v[236:239], a[172:175], v[36:39], v[236:239]
  v_exp_f32 v21, v21
  v_mfma_f32_16x16x32_bf16 v[240:243], a[176:179], v[36:39], v[240:243]
  v_fma_f32 v22, v22, s24, v8
  v_fma_f32 v23, v23, s24, v8
  v_mfma_f32_16x16x32_bf16 v[244:247], a[180:183], v[36:39], v[244:247]
  v_exp_f32 v22, v22
  v_mfma_f32_16x16x32_bf16 v[248:251], a[184:187], v[36:39], v[248:251]
  v_exp_f32 v23, v23
  v_mfma_f32_16x16x32_bf16 v[252:255], a[188:191], v[36:39], v[252:255]
  v_cvt_pk_bf16_f32 v34, v20, v21
  v_cvt_pk_bf16_f32 v35, v22, v23
  v_mfma_f32_16x16x32_bf16 v[16:19], a[128:131], a[32:35], 0
  ds_read_b128 a[112:115], v1 offset:10240
  v_fma_f32 v24, v24, s24, v9
  v_mfma_f32_16x16x32_bf16 v[16:19], a[132:135], a[36:39], v[16:19]
  v_exp_f32 v24, v24
  v_mfma_f32_16x16x32_bf16 v[16:19], a[136:139], a[40:43], v[16:19]
  ds_read_b128 a[116:119], v1 offset:10496
  v_fma_f32 v25, v25, s24, v9
  v_mfma_f32_16x16x32_bf16 v[16:19], a[140:143], a[44:47], v[16:19]
  buffer_load_dwordx4 v5, s[8:11], s20 offen offset:3072 lds
  v_exp_f32 v25, v25
  v_mfma_f32_16x16x32_bf16 v[20:23], a[156:159], a[44:47], 0
  ds_read_b128 a[120:123], v1 offset:10752
  v_fma_f32 v26, v26, s24, v9
  v_mfma_f32_16x16x32_bf16 v[20:23], a[152:155], a[40:43], v[20:23]
  v_exp_f32 v26, v26
  v_mfma_f32_16x16x32_bf16 v[20:23], a[148:151], a[36:39], v[20:23]
  ds_read_b128 a[124:127], v1 offset:11008
  v_fma_f32 v27, v27, s24, v9
  v_mfma_f32_16x16x32_bf16 v[20:23], a[144:147], a[32:35], v[20:23]
  v_exp_f32 v27, v27
  v_mfma_f32_16x16x32_bf16 v[64:67], a[192:195], v[32:35], v[64:67]
  s_mov_b32 m0, s33
  v_fma_f32 v28, v28, s24, v9
  v_cvt_pk_bf16_f32 v36, v24, v25
  v_mfma_f32_16x16x32_bf16 v[68:71], a[196:199], v[32:35], v[68:71]
  buffer_load_dwordx4 v4, s[4:7], s21 offen offset:3072 nt lds
  v_exp_f32 v28, v28
  v_mfma_f32_16x16x32_bf16 v[72:75], a[200:203], v[32:35], v[72:75]
  v_fma_f32 v29, v29, s24, v9
  v_cvt_pk_bf16_f32 v37, v26, v27
  v_mfma_f32_16x16x32_bf16 v[76:79], a[204:207], v[32:35], v[76:79]
  v_exp_f32 v29, v29
  v_mfma_f32_16x16x32_bf16 v[80:83], a[208:211], v[32:35], v[80:83]
  s_add_u32 s21, s21, 4096
  v_fma_f32 v30, v30, s24, v9
  v_fma_f32 v31, v31, s24, v9
  v_mfma_f32_16x16x32_bf16 v[84:87], a[212:215], v[32:35], v[84:87]
  v_exp_f32 v30, v30
  v_mfma_f32_16x16x32_bf16 v[88:91], a[216:219], v[32:35], v[88:91]
  v_exp_f32 v31, v31
  v_mfma_f32_16x16x32_bf16 v[92:95], a[220:223], v[32:35], v[92:95]
  v_cvt_pk_bf16_f32 v38, v28, v29
  v_cvt_pk_bf16_f32 v39, v30, v31
  v_mfma_f32_16x16x32_bf16 v[24:27], a[128:131], a[48:51], 0
  s_add_u32 m0, s32, 49152
  ds_read_b64_tr_b16 a[160:161], v2 offset:0
  v_fma_f32 v16, v16, s24, v10
  v_smfmac_f32_16x16x64_bf16 v[40:43], a[224:227], v[32:39], v7
  buffer_load_dwordx4 v4, s[12:15], s20 offen lds
  v_mfma_f32_16x16x32_bf16 v[24:27], a[132:135], a[52:55], v[24:27]
  v_exp_f32 v16, v16
  v_mfma_f32_16x16x32_bf16 v[24:27], a[136:139], a[56:59], v[24:27]
  ds_read_b64_tr_b16 a[162:163], v2 offset:8192
  v_fma_f32 v17, v17, s24, v10
  v_mfma_f32_16x16x32_bf16 v[24:27], a[140:143], a[60:63], v[24:27]
  v_exp_f32 v17, v17
  v_mfma_f32_16x16x32_bf16 v[28:31], a[156:159], a[60:63], 0
  ds_read_b64_tr_b16 a[164:165], v2 offset:8
  v_fma_f32 v18, v18, s24, v10
  v_mfma_f32_16x16x32_bf16 v[28:31], a[152:155], a[56:59], v[28:31]
  v_exp_f32 v18, v18
  v_mfma_f32_16x16x32_bf16 v[28:31], a[148:151], a[52:55], v[28:31]
  ds_read_b64_tr_b16 a[166:167], v2 offset:8200
  v_fma_f32 v19, v19, s24, v10
  v_mfma_f32_16x16x32_bf16 v[28:31], a[144:147], a[48:51], v[28:31]
  v_exp_f32 v19, v19
  v_mfma_f32_16x16x32_bf16 v[96:99], a[192:195], v[36:39], v[96:99]
  v_fma_f32 v20, v20, s24, v10
  v_cvt_pk_bf16_f32 v32, v16, v17
  v_mfma_f32_16x16x32_bf16 v[100:103], a[196:199], v[36:39], v[100:103]
  v_exp_f32 v20, v20
  v_mfma_f32_16x16x32_bf16 v[104:107], a[200:203], v[36:39], v[104:107]
  v_fma_f32 v21, v21, s24, v10
  v_cvt_pk_bf16_f32 v33, v18, v19
  v_mfma_f32_16x16x32_bf16 v[108:111], a[204:207], v[36:39], v[108:111]
  v_exp_f32 v21, v21
  v_mfma_f32_16x16x32_bf16 v[112:115], a[208:211], v[36:39], v[112:115]
  v_fma_f32 v22, v22, s24, v10
  v_fma_f32 v23, v23, s24, v10
  v_mfma_f32_16x16x32_bf16 v[116:119], a[212:215], v[36:39], v[116:119]
  v_exp_f32 v22, v22
  v_mfma_f32_16x16x32_bf16 v[120:123], a[216:219], v[36:39], v[120:123]
  v_exp_f32 v23, v23
  v_mfma_f32_16x16x32_bf16 v[124:127], a[220:223], v[36:39], v[124:127]
  v_cvt_pk_bf16_f32 v34, v20, v21
  v_cvt_pk_bf16_f32 v35, v22, v23
  v_mfma_f32_16x16x32_bf16 v[16:19], a[128:131], a[64:67], 0
  ds_read_b64_tr_b16 a[168:169], v2 offset:256
  v_fma_f32 v24, v24, s24, v11
  v_mfma_f32_16x16x32_bf16 v[16:19], a[132:135], a[68:71], v[16:19]
  v_exp_f32 v24, v24
  v_mfma_f32_16x16x32_bf16 v[16:19], a[136:139], a[72:75], v[16:19]
  ds_read_b64_tr_b16 a[170:171], v2 offset:8448
  v_fma_f32 v25, v25, s24, v11
  v_mfma_f32_16x16x32_bf16 v[16:19], a[140:143], a[76:79], v[16:19]
  v_exp_f32 v25, v25
  v_mfma_f32_16x16x32_bf16 v[20:23], a[156:159], a[76:79], 0
  ds_read_b64_tr_b16 a[172:173], v2 offset:264
  v_fma_f32 v26, v26, s24, v11
  v_mfma_f32_16x16x32_bf16 v[20:23], a[152:155], a[72:75], v[20:23]
  v_exp_f32 v26, v26
  v_mfma_f32_16x16x32_bf16 v[20:23], a[148:151], a[68:71], v[20:23]
  ds_read_b64_tr_b16 a[174:175], v2 offset:8456
  v_fma_f32 v27, v27, s24, v11
  v_mfma_f32_16x16x32_bf16 v[20:23], a[144:147], a[64:67], v[20:23]
  v_exp_f32 v27, v27
  v_mfma_f32_16x16x32_bf16 v[128:131], a[192:195], v[32:35], v[128:131]
  s_add_u32 m0, s33, 4096
  v_fma_f32 v28, v28, s24, v11
  v_cvt_pk_bf16_f32 v36, v24, v25
  v_mfma_f32_16x16x32_bf16 v[132:135], a[196:199], v[32:35], v[132:135]
  buffer_load_dwordx4 v4, s[4:7], s21 offen nt lds
  v_exp_f32 v28, v28
  v_mfma_f32_16x16x32_bf16 v[136:139], a[200:203], v[32:35], v[136:139]
  v_fma_f32 v29, v29, s24, v11
  v_cvt_pk_bf16_f32 v37, v26, v27
  v_mfma_f32_16x16x32_bf16 v[140:143], a[204:207], v[32:35], v[140:143]
  v_exp_f32 v29, v29
  v_mfma_f32_16x16x32_bf16 v[144:147], a[208:211], v[32:35], v[144:147]
  v_fma_f32 v30, v30, s24, v11
  v_fma_f32 v31, v31, s24, v11
  v_mfma_f32_16x16x32_bf16 v[148:151], a[212:215], v[32:35], v[148:151]
  v_exp_f32 v30, v30
  v_mfma_f32_16x16x32_bf16 v[152:155], a[216:219], v[32:35], v[152:155]
  v_exp_f32 v31, v31
  v_mfma_f32_16x16x32_bf16 v[156:159], a[220:223], v[32:35], v[156:159]
  v_cvt_pk_bf16_f32 v38, v28, v29
  v_cvt_pk_bf16_f32 v39, v30, v31
  v_mfma_f32_16x16x32_bf16 v[24:27], a[128:131], a[80:83], 0
  s_add_u32 m0, s32, 49152
  ds_read_b64_tr_b16 a[176:177], v2 offset:512
  v_fma_f32 v16, v16, s24, v12
  v_smfmac_f32_16x16x64_bf16 v[44:47], a[224:227], v[32:39], v7
  buffer_load_dwordx4 v4, s[12:15], s20 offen offset:1024 lds
  v_mfma_f32_16x16x32_bf16 v[24:27], a[132:135], a[84:87], v[24:27]
  v_exp_f32 v16, v16
  v_mfma_f32_16x16x32_bf16 v[24:27], a[136:139], a[88:91], v[24:27]
  ds_read_b64_tr_b16 a[178:179], v2 offset:8704
  v_fma_f32 v17, v17, s24, v12
  v_mfma_f32_16x16x32_bf16 v[24:27], a[140:143], a[92:95], v[24:27]
  v_exp_f32 v17, v17
  v_mfma_f32_16x16x32_bf16 v[28:31], a[156:159], a[92:95], 0
  ds_read_b64_tr_b16 a[180:181], v2 offset:520
  v_fma_f32 v18, v18, s24, v12
  v_mfma_f32_16x16x32_bf16 v[28:31], a[152:155], a[88:91], v[28:31]
  v_exp_f32 v18, v18
  v_mfma_f32_16x16x32_bf16 v[28:31], a[148:151], a[84:87], v[28:31]
  ds_read_b64_tr_b16 a[182:183], v2 offset:8712
  v_fma_f32 v19, v19, s24, v12
  v_mfma_f32_16x16x32_bf16 v[28:31], a[144:147], a[80:83], v[28:31]
  v_exp_f32 v19, v19
  v_mfma_f32_16x16x32_bf16 v[160:163], a[192:195], v[36:39], v[160:163]
  v_fma_f32 v20, v20, s24, v12
  v_cvt_pk_bf16_f32 v32, v16, v17
  v_mfma_f32_16x16x32_bf16 v[164:167], a[196:199], v[36:39], v[164:167]
  v_exp_f32 v20, v20
  v_mfma_f32_16x16x32_bf16 v[168:171], a[200:203], v[36:39], v[168:171]
  v_fma_f32 v21, v21, s24, v12
  v_cvt_pk_bf16_f32 v33, v18, v19
  v_mfma_f32_16x16x32_bf16 v[172:175], a[204:207], v[36:39], v[172:175]
  v_exp_f32 v21, v21
  v_mfma_f32_16x16x32_bf16 v[176:179], a[208:211], v[36:39], v[176:179]
  v_fma_f32 v22, v22, s24, v12
  v_fma_f32 v23, v23, s24, v12
  v_mfma_f32_16x16x32_bf16 v[180:183], a[212:215], v[36:39], v[180:183]
  v_exp_f32 v22, v22
  v_mfma_f32_16x16x32_bf16 v[184:187], a[216:219], v[36:39], v[184:187]
  v_exp_f32 v23, v23
  v_mfma_f32_16x16x32_bf16 v[188:191], a[220:223], v[36:39], v[188:191]
  s_waitcnt lgkmcnt(12)
  v_cvt_pk_bf16_f32 v34, v20, v21
  v_cvt_pk_bf16_f32 v35, v22, v23
  v_mfma_f32_16x16x32_bf16 v[16:19], a[96:99], a[0:3], 0
  ds_read_b64_tr_b16 a[184:185], v2 offset:768
  v_fma_f32 v24, v24, s24, v13
  v_mfma_f32_16x16x32_bf16 v[16:19], a[100:103], a[4:7], v[16:19]
  v_exp_f32 v24, v24
  v_mfma_f32_16x16x32_bf16 v[16:19], a[104:107], a[8:11], v[16:19]
  ds_read_b64_tr_b16 a[186:187], v2 offset:8960
  v_fma_f32 v25, v25, s24, v13
  v_mfma_f32_16x16x32_bf16 v[16:19], a[108:111], a[12:15], v[16:19]
  v_exp_f32 v25, v25
  v_mfma_f32_16x16x32_bf16 v[20:23], a[124:127], a[12:15], 0
  ds_read_b64_tr_b16 a[188:189], v2 offset:776
  v_fma_f32 v26, v26, s24, v13
  v_mfma_f32_16x16x32_bf16 v[20:23], a[120:123], a[8:11], v[20:23]
  v_exp_f32 v26, v26
  v_mfma_f32_16x16x32_bf16 v[20:23], a[116:119], a[4:7], v[20:23]
  ds_read_b64_tr_b16 a[190:191], v2 offset:8968
  v_fma_f32 v27, v27, s24, v13
  v_mfma_f32_16x16x32_bf16 v[20:23], a[112:115], a[0:3], v[20:23]
  v_exp_f32 v27, v27
  v_mfma_f32_16x16x32_bf16 v[192:195], a[192:195], v[32:35], v[192:195]
  s_add_u32 m0, s33, 4096
  v_fma_f32 v28, v28, s24, v13
  v_cvt_pk_bf16_f32 v36, v24, v25
  v_mfma_f32_16x16x32_bf16 v[196:199], a[196:199], v[32:35], v[196:199]
  buffer_load_dwordx4 v4, s[4:7], s21 offen offset:1024 nt lds
  v_exp_f32 v28, v28
  v_mfma_f32_16x16x32_bf16 v[200:203], a[200:203], v[32:35], v[200:203]
  v_fma_f32 v29, v29, s24, v13
  v_cvt_pk_bf16_f32 v37, v26, v27
  v_mfma_f32_16x16x32_bf16 v[204:207], a[204:207], v[32:35], v[204:207]
  v_exp_f32 v29, v29
  v_mfma_f32_16x16x32_bf16 v[208:211], a[208:211], v[32:35], v[208:211]
  s_add_u32 s20, s20, 8192
  v_fma_f32 v30, v30, s24, v13
  v_fma_f32 v31, v31, s24, v13
  v_mfma_f32_16x16x32_bf16 v[212:215], a[212:215], v[32:35], v[212:215]
  v_exp_f32 v30, v30
  v_mfma_f32_16x16x32_bf16 v[216:219], a[216:219], v[32:35], v[216:219]
  s_mov_b32 m0, s32
  v_exp_f32 v31, v31
  v_mfma_f32_16x16x32_bf16 v[220:223], a[220:223], v[32:35], v[220:223]
  s_waitcnt vmcnt(16) lgkmcnt(0)
  v_cvt_pk_bf16_f32 v38, v28, v29
  v_cvt_pk_bf16_f32 v39, v30, v31
  v_mfma_f32_16x16x32_bf16 v[24:27], a[96:99], a[16:19], 0
  s_barrier
  ds_read_b128 a[128:131], v1 offset:18432
  v_fma_f32 v16, v16, s24, v8
  v_smfmac_f32_16x16x64_bf16 v[48:51], a[224:227], v[32:39], v7
  buffer_load_dwordx4 v5, s[8:11], s20 offen offset:2048 lds
  v_mfma_f32_16x16x32_bf16 v[24:27], a[100:103], a[20:23], v[24:27]
  v_exp_f32 v16, v16
  v_mfma_f32_16x16x32_bf16 v[24:27], a[104:107], a[24:27], v[24:27]
  ds_read_b128 a[132:135], v1 offset:18688
  v_fma_f32 v17, v17, s24, v8
  v_mfma_f32_16x16x32_bf16 v[24:27], a[108:111], a[28:31], v[24:27]
  v_exp_f32 v17, v17
  v_mfma_f32_16x16x32_bf16 v[28:31], a[124:127], a[28:31], 0
  ds_read_b128 a[136:139], v1 offset:18944
  v_fma_f32 v18, v18, s24, v8
  v_mfma_f32_16x16x32_bf16 v[28:31], a[120:123], a[24:27], v[28:31]
  v_exp_f32 v18, v18
  v_mfma_f32_16x16x32_bf16 v[28:31], a[116:119], a[20:23], v[28:31]
  ds_read_b128 a[140:143], v1 offset:19200
  v_fma_f32 v19, v19, s24, v8
  v_mfma_f32_16x16x32_bf16 v[28:31], a[112:115], a[16:19], v[28:31]
  v_exp_f32 v19, v19
  v_mfma_f32_16x16x32_bf16 v[224:227], a[192:195], v[36:39], v[224:227]
  v_fma_f32 v20, v20, s24, v8
  v_cvt_pk_bf16_f32 v32, v16, v17
  v_mfma_f32_16x16x32_bf16 v[228:231], a[196:199], v[36:39], v[228:231]
  v_exp_f32 v20, v20
  v_mfma_f32_16x16x32_bf16 v[232:235], a[200:203], v[36:39], v[232:235]
  v_fma_f32 v21, v21, s24, v8
  v_cvt_pk_bf16_f32 v33, v18, v19
  v_mfma_f32_16x16x32_bf16 v[236:239], a[204:207], v[36:39], v[236:239]
  v_exp_f32 v21, v21
  v_mfma_f32_16x16x32_bf16 v[240:243], a[208:211], v[36:39], v[240:243]
  v_fma_f32 v22, v22, s24, v8
  v_fma_f32 v23, v23, s24, v8
  v_mfma_f32_16x16x32_bf16 v[244:247], a[212:215], v[36:39], v[244:247]
  v_exp_f32 v22, v22
  v_mfma_f32_16x16x32_bf16 v[248:251], a[216:219], v[36:39], v[248:251]
  v_exp_f32 v23, v23
  v_mfma_f32_16x16x32_bf16 v[252:255], a[220:223], v[36:39], v[252:255]
  v_cvt_pk_bf16_f32 v34, v20, v21
  v_cvt_pk_bf16_f32 v35, v22, v23
  v_mfma_f32_16x16x32_bf16 v[16:19], a[96:99], a[32:35], 0
  ds_read_b128 a[144:147], v1 offset:26624
  v_fma_f32 v24, v24, s24, v9
  v_mfma_f32_16x16x32_bf16 v[16:19], a[100:103], a[36:39], v[16:19]
L_pad5:
  s_cbranch_execz L_padret
  v_exp_f32 v24, v24
  v_mfma_f32_16x16x32_bf16 v[16:19], a[104:107], a[40:43], v[16:19]
  ds_read_b128 a[148:151], v1 offset:26880
  v_fma_f32 v25, v25, s24, v9
  v_mfma_f32_16x16x32_bf16 v[16:19], a[108:111], a[44:47], v[16:19]
  buffer_load_dwordx4 v5, s[8:11], s20 offen offset:3072 lds
  v_exp_f32 v25, v25
  v_mfma_f32_16x16x32_bf16 v[20:23], a[124:127], a[44:47], 0
  ds_read_b128 a[152:155], v1 offset:27136
  v_fma_f32 v26, v26, s24, v9
  v_mfma_f32_16x16x32_bf16 v[20:23], a[120:123], a[40:43], v[20:23]
  v_exp_f32 v26, v26
  v_mfma_f32_16x16x32_bf16 v[20:23], a[116:119], a[36:39], v[20:23]
  ds_read_b128 a[156:159], v1 offset:27392
  v_fma_f32 v27, v27, s24, v9
  v_mfma_f32_16x16x32_bf16 v[20:23], a[112:115], a[32:35], v[20:23]
  v_exp_f32 v27, v27
  v_mfma_f32_16x16x32_bf16 v[64:67], a[160:163], v[32:35], v[64:67]
  s_add_u32 m0, s33, 4096
  v_fma_f32 v28, v28, s24, v9
  v_cvt_pk_bf16_f32 v36, v24, v25
  v_mfma_f32_16x16x32_bf16 v[68:71], a[164:167], v[32:35], v[68:71]
  buffer_load_dwordx4 v4, s[4:7], s21 offen offset:2048 nt lds
  v_exp_f32 v28, v28
  v_mfma_f32_16x16x32_bf16 v[72:75], a[168:171], v[32:35], v[72:75]
  v_fma_f32 v29, v29, s24, v9
  v_cvt_pk_bf16_f32 v37, v26, v27
  v_mfma_f32_16x16x32_bf16 v[76:79], a[172:175], v[32:35], v[76:79]
  v_exp_f32 v29, v29
  v_mfma_f32_16x16x32_bf16 v[80:83], a[176:179], v[32:35], v[80:83]
  v_fma_f32 v30, v30, s24, v9
  v_fma_f32 v31, v31, s24, v9
  v_mfma_f32_16x16x32_bf16 v[84:87], a[180:183], v[32:35], v[84:87]
  v_exp_f32 v30, v30
  v_mfma_f32_16x16x32_bf16 v[88:91], a[184:187], v[32:35], v[88:91]
  v_exp_f32 v31, v31
  v_mfma_f32_16x16x32_bf16 v[92:95], a[188:191], v[32:35], v[92:95]
  v_cvt_pk_bf16_f32 v38, v28, v29
  v_cvt_pk_bf16_f32 v39, v30, v31
  v_mfma_f32_16x16x32_bf16 v[24:27], a[96:99], a[48:51], 0
  s_mov_b32 m0, s32
  ds_read_b64_tr_b16 a[192:193], v2 offset:16384
  v_fma_f32 v16, v16, s24, v10
  v_smfmac_f32_16x16x64_bf16 v[40:43], a[224:227], v[32:39], v7
  buffer_load_dwordx4 v4, s[12:15], s20 offen lds
  v_mfma_f32_16x16x32_bf16 v[24:27], a[100:103], a[52:55], v[24:27]
  v_exp_f32 v16, v16
  v_mfma_f32_16x16x32_bf16 v[24:27], a[104:107], a[56:59], v[24:27]
  ds_read_b64_tr_b16 a[194:195], v2 offset:24576
  v_fma_f32 v17, v17, s24, v10
  v_mfma_f32_16x16x32_bf16 v[24:27], a[108:111], a[60:63], v[24:27]
  v_exp_f32 v17, v17
  v_mfma_f32_16x16x32_bf16 v[28:31], a[124:127], a[60:63], 0
  ds_read_b64_tr_b16 a[196:197], v2 offset:16392
  v_fma_f32 v18, v18, s24, v10
  v_mfma_f32_16x16x32_bf16 v[28:31], a[120:123], a[56:59], v[28:31]
  v_exp_f32 v18, v18
  v_mfma_f32_16x16x32_bf16 v[28:31], a[116:119], a[52:55], v[28:31]
  ds_read_b64_tr_b16 a[198:199], v2 offset:24584
  v_fma_f32 v19, v19, s24, v10
  v_mfma_f32_16x16x32_bf16 v[28:31], a[112:115], a[48:51], v[28:31]
  v_exp_f32 v19, v19
  v_mfma_f32_16x16x32_bf16 v[96:99], a[160:163], v[36:39], v[96:99]
  v_fma_f32 v20, v20, s24, v10
  v_cvt_pk_bf16_f32 v32, v16, v17
  v_mfma_f32_16x16x32_bf16 v[100:103], a[164:167], v[36:39], v[100:103]
  v_exp_f32 v20, v20
  v_mfma_f32_16x16x32_bf16 v[104:107], a[168:171], v[36:39], v[104:107]
  v_fma_f32 v21, v21, s24, v10
  v_cvt_pk_bf16_f32 v33, v18, v19
  v_mfma_f32_16x16x32_bf16 v[108:111], a[172:175], v[36:39], v[108:111]
  v_exp_f32 v21, v21
  v_mfma_f32_16x16x32_bf16 v[112:115], a[176:179], v[36:39], v[112:115]
  v_fma_f32 v22, v22, s24, v10
  v_fma_f32 v23, v23, s24, v10
  v_mfma_f32_16x16x32_bf16 v[116:119], a[180:183], v[36:39], v[116:119]
  v_exp_f32 v22, v22
  v_mfma_f32_16x16x32_bf16 v[120:123], a[184:187], v[36:39], v[120:123]
  v_exp_f32 v23, v23
  v_mfma_f32_16x16x32_bf16 v[124:127], a[188:191], v[36:39], v[124:127]
  v_cvt_pk_bf16_f32 v34, v20, v21
  v_cvt_pk_bf16_f32 v35, v22, v23
  v_mfma_f32_16x16x32_bf16 v[16:19], a[96:99], a[64:67], 0
  ds_read_b64_tr_b16 a[200:201], v2 offset:16640
  v_fma_f32 v24, v24, s24, v11
  v_mfma_f32_16x16x32_bf16 v[16:19], a[100:103], a[68:71], v[16:19]
  v_exp_f32 v24, v24
  v_mfma_f32_16x16x32_bf16 v[16:19], a[104:107], a[72:75], v[16:19]
  ds_read_b64_tr_b16 a[202:203], v2 offset:24832
  v_fma_f32 v25, v25, s24, v11
  v_mfma_f32_16x16x32_bf16 v[16:19], a[108:111], a[76:79], v[16:19]
  v_exp_f32 v25, v25
  v_mfma_f32_16x16x32_bf16 v[20:23], a[124:127], a[76:79], 0
  ds_read_b64_tr_b16 a[204:205], v2 offset:16648
  v_fma_f32 v26, v26, s24, v11
  v_mfma_f32_16x16x32_bf16 v[20:23], a[120:123], a[72:75], v[20:23]
  v_exp_f32 v26, v26
  v_mfma_f32_16x16x32_bf16 v[20:23], a[116:119], a[68:71], v[20:23]
  ds_read_b64_tr_b16 a[206:207], v2 offset:24840
  v_fma_f32 v27, v27, s24, v11
  v_mfma_f32_16x16x32_bf16 v[20:23], a[112:115], a[64:67], v[20:23]
  v_exp_f32 v27, v27
  v_mfma_f32_16x16x32_bf16 v[128:131], a[160:163], v[32:35], v[128:131]
  s_add_u32 m0, s33, 4096
  v_fma_f32 v28, v28, s24, v11
  v_cvt_pk_bf16_f32 v36, v24, v25
  v_mfma_f32_16x16x32_bf16 v[132:135], a[164:167], v[32:35], v[132:135]
  buffer_load_dwordx4 v4, s[4:7], s21 offen offset:3072 nt lds
  v_exp_f32 v28, v28
  v_mfma_f32_16x16x32_bf16 v[136:139], a[168:171], v[32:35], v[136:139]
  v_fma_f32 v29, v29, s24, v11
  v_cvt_pk_bf16_f32 v37, v26, v27
  v_mfma_f32_16x16x32_bf16 v[140:143], a[172:175], v[32:35], v[140:143]
  v_exp_f32 v29, v29
  v_mfma_f32_16x16x32_bf16 v[144:147], a[176:179], v[32:35], v[144:147]
  s_add_u32 s21, s21, 4096
  v_fma_f32 v30, v30, s24, v11
  v_fma_f32 v31, v31, s24, v11
  v_mfma_f32_16x16x32_bf16 v[148:151], a[180:183], v[32:35], v[148:151]
  v_exp_f32 v30, v30
  v_mfma_f32_16x16x32_bf16 v[152:155], a[184:187], v[32:35], v[152:155]
  v_exp_f32 v31, v31
  v_mfma_f32_16x16x32_bf16 v[156:159], a[188:191], v[32:35], v[156:159]
  v_cvt_pk_bf16_f32 v38, v28, v29
  v_cvt_pk_bf16_f32 v39, v30, v31
  v_mfma_f32_16x16x32_bf16 v[24:27], a[96:99], a[80:83], 0
  s_mov_b32 m0, s32
  ds_read_b64_tr_b16 a[208:209], v2 offset:16896
  v_fma_f32 v16, v16, s24, v12
  v_smfmac_f32_16x16x64_bf16 v[44:47], a[224:227], v[32:39], v7
  buffer_load_dwordx4 v4, s[12:15], s20 offen offset:1024 lds
  v_mfma_f32_16x16x32_bf16 v[24:27], a[100:103], a[84:87], v[24:27]
  v_exp_f32 v16, v16
  v_mfma_f32_16x16x32_bf16 v[24:27], a[104:107], a[88:91], v[24:27]
  ds_read_b64_tr_b16 a[210:211], v2 offset:25088
  v_fma_f32 v17, v17, s24, v12
  v_mfma_f32_16x16x32_bf16 v[24:27], a[108:111], a[92:95], v[24:27]
  v_exp_f32 v17, v17
  v_mfma_f32_16x16x32_bf16 v[28:31], a[124:127], a[92:95], 0
  ds_read_b64_tr_b16 a[212:213], v2 offset:16904
  v_fma_f32 v18, v18, s24, v12
  v_mfma_f32_16x16x32_bf16 v[28:31], a[120:123], a[88:91], v[28:31]
  v_exp_f32 v18, v18
  v_mfma_f32_16x16x32_bf16 v[28:31], a[116:119], a[84:87], v[28:31]
  ds_read_b64_tr_b16 a[214:215], v2 offset:25096
  v_fma_f32 v19, v19, s24, v12
  v_mfma_f32_16x16x32_bf16 v[28:31], a[112:115], a[80:83], v[28:31]
  v_exp_f32 v19, v19
  v_mfma_f32_16x16x32_bf16 v[160:163], a[160:163], v[36:39], v[160:163]
  v_fma_f32 v20, v20, s24, v12
  v_cvt_pk_bf16_f32 v32, v16, v17
  v_mfma_f32_16x16x32_bf16 v[164:167], a[164:167], v[36:39], v[164:167]
  v_exp_f32 v20, v20
  v_mfma_f32_16x16x32_bf16 v[168:171], a[168:171], v[36:39], v[168:171]
  v_fma_f32 v21, v21, s24, v12
  v_cvt_pk_bf16_f32 v33, v18, v19
  v_mfma_f32_16x16x32_bf16 v[172:175], a[172:175], v[36:39], v[172:175]
  v_exp_f32 v21, v21
  v_mfma_f32_16x16x32_bf16 v[176:179], a[176:179], v[36:39], v[176:179]
  v_fma_f32 v22, v22, s24, v12
  v_fma_f32 v23, v23, s24, v12
  v_mfma_f32_16x16x32_bf16 v[180:183], a[180:183], v[36:39], v[180:183]
  v_exp_f32 v22, v22
  v_mfma_f32_16x16x32_bf16 v[184:187], a[184:187], v[36:39], v[184:187]
  v_exp_f32 v23, v23
  v_mfma_f32_16x16x32_bf16 v[188:191], a[188:191], v[36:39], v[188:191]
  s_waitcnt lgkmcnt(12)
  v_cvt_pk_bf16_f32 v34, v20, v21
  v_cvt_pk_bf16_f32 v35, v22, v23
  v_mfma_f32_16x16x32_bf16 v[16:19], a[128:131], a[0:3], 0
  ds_read_b64_tr_b16 a[216:217], v2 offset:17152
  v_fma_f32 v24, v24, s24, v13
  v_mfma_f32_16x16x32_bf16 v[16:19], a[132:135], a[4:7], v[16:19]
  v_exp_f32 v24, v24
  v_mfma_f32_16x16x32_bf16 v[16:19], a[136:139], a[8:11], v[16:19]
  ds_read_b64_tr_b16 a[218:219], v2 offset:25344
  v_fma_f32 v25, v25, s24, v13
  v_mfma_f32_16x16x32_bf16 v[16:19], a[140:143], a[12:15], v[16:19]
  v_exp_f32 v25, v25
  v_mfma_f32_16x16x32_bf16 v[20:23], a[156:159], a[12:15], 0
  ds_read_b64_tr_b16 a[220:221], v2 offset:17160
  v_fma_f32 v26, v26, s24, v13
  v_mfma_f32_16x16x32_bf16 v[20:23], a[152:155], a[8:11], v[20:23]
  v_exp_f32 v26, v26
  v_mfma_f32_16x16x32_bf16 v[20:23], a[148:151], a[4:7], v[20:23]
  ds_read_b64_tr_b16 a[222:223], v2 offset:25352
  v_fma_f32 v27, v27, s24, v13
  v_mfma_f32_16x16x32_bf16 v[20:23], a[144:147], a[0:3], v[20:23]
  v_exp_f32 v27, v27
  v_mfma_f32_16x16x32_bf16 v[192:195], a[160:163], v[32:35], v[192:195]
  s_add_u32 m0, s33, 8192
  v_fma_f32 v28, v28, s24, v13
  v_cvt_pk_bf16_f32 v36, v24, v25
  v_mfma_f32_16x16x32_bf16 v[196:199], a[164:167], v[32:35], v[196:199]
  buffer_load_dwordx4 v4, s[4:7], s21 offen nt lds
  v_exp_f32 v28, v28
  v_mfma_f32_16x16x32_bf16 v[200:203], a[168:171], v[32:35], v[200:203]
  v_fma_f32 v29, v29, s24, v13
  v_cvt_pk_bf16_f32 v37, v26, v27
  v_mfma_f32_16x16x32_bf16 v[204:207], a[172:175], v[32:35], v[204:207]
  v_exp_f32 v29, v29
  v_mfma_f32_16x16x32_bf16 v[208:211], a[176:179], v[32:35], v[208:211]
  s_add_u32 s20, s20, 8192
  v_fma_f32 v30, v30, s24, v13
  v_fma_f32 v31, v31, s24, v13
  v_mfma_f32_16x16x32_bf16 v[212:215], a[180:183], v[32:35], v[212:215]
  v_exp_f32 v30, v30
  v_mfma_f32_16x16x32_bf16 v[216:219], a[184:187], v[32:35], v[216:219]
  s_add_u32 m0, s32, 16384
  v_exp_f32 v31, v31
  v_mfma_f32_16x16x32_bf16 v[220:223], a[188:191], v[32:35], v[220:223]
  s_waitcnt vmcnt(15) lgkmcnt(0)
  v_cvt_pk_bf16_f32 v38, v28, v29
  v_cvt_pk_bf16_f32 v39, v30, v31
  v_mfma_f32_16x16x32_bf16 v[24:27], a[128:131], a[16:19], 0
  s_barrier
  ds_read_b128 a[96:99], v1 offset:34816
  v_fma_f32 v16, v16, s24, v8
  v_smfmac_f32_16x16x64_bf16 v[48:51], a[224:227], v[32:39], v7
  buffer_load_dwordx4 v5, s[8:11], s20 offen offset:2048 lds
  v_mfma_f32_16x16x32_bf16 v[24:27], a[132:135], a[20:23], v[24:27]
  v_exp_f32 v16, v16
  v_mfma_f32_16x16x32_bf16 v[24:27], a[136:139], a[24:27], v[24:27]
  ds_read_b128 a[100:103], v1 offset:35072
  v_fma_f32 v17, v17, s24, v8
  v_mfma_f32_16x16x32_bf16 v[24:27], a[140:143], a[28:31], v[24:27]
  v_exp_f32 v17, v17
  v_mfma_f32_16x16x32_bf16 v[28:31], a[156:159], a[28:31], 0
  ds_read_b128 a[104:107], v1 offset:35328
  v_fma_f32 v18, v18, s24, v8
  v_mfma_f32_16x16x32_bf16 v[28:31], a[152:155], a[24:27], v[28:31]
  v_exp_f32 v18, v18
  v_mfma_f32_16x16x32_bf16 v[28:31], a[148:151], a[20:23], v[28:31]
  ds_read_b128 a[108:111], v1 offset:35584
  v_fma_f32 v19, v19, s24, v8
  v_mfma_f32_16x16x32_bf16 v[28:31], a[144:147], a[16:19], v[28:31]
  v_exp_f32 v19, v19
  v_mfma_f32_16x16x32_bf16 v[224:227], a[160:163], v[36:39], v[224:227]
  v_fma_f32 v20, v20, s24, v8
  v_cvt_pk_bf16_f32 v32, v16, v17
  v_mfma_f32_16x16x32_bf16 v[228:231], a[164:167], v[36:39], v[228:231]
  v_exp_f32 v20, v20
  v_mfma_f32_16x16x32_bf16 v[232:235], a[168:171], v[36:39], v[232:235]
  v_fma_f32 v21, v21, s24, v8
  v_cvt_pk_bf16_f32 v33, v18, v19
  v_mfma_f32_16x16x32_bf16 v[236:239], a[172:175], v[36:39], v[236:239]
  v_exp_f32 v21, v21
  v_mfma_f32_16x16x32_bf16 v[240:243], a[176:179], v[36:39], v[240:243]
  v_fma_f32 v22, v22, s24, v8
  v_fma_f32 v23, v23, s24, v8
  v_mfma_f32_16x16x32_bf16 v[244:247], a[180:183], v[36:39], v[244:247]
  v_exp_f32 v22, v22
  v_mfma_f32_16x16x32_bf16 v[248:251], a[184:187], v[36:39], v[248:251]
  v_exp_f32 v23, v23
  v_mfma_f32_16x16x32_bf16 v[252:255], a[188:191], v[36:39], v[252:255]
  v_cvt_pk_bf16_f32 v34, v20, v21
  v_cvt_pk_bf16_f32 v35, v22, v23
  v_mfma_f32_16x16x32_bf16 v[16:19], a[128:131], a[32:35], 0
  ds_read_b128 a[112:115], v1 offset:43008
  v_fma_f32 v24, v24, s24, v9
  v_mfma_f32_16x16x32_bf16 v[16:19], a[132:135], a[36:39], v[16:19]
  v_exp_f32 v24, v24
  v_mfma_f32_16x16x32_bf16 v[16:19], a[136:139], a[40:43], v[16:19]
  ds_read_b128 a[116:119], v1 offset:43264
  v_fma_f32 v25, v25, s24, v9
  v_mfma_f32_16x16x32_bf16 v[16:19], a[140:143], a[44:47], v[16:19]
  buffer_load_dwordx4 v5, s[8:11], s20 offen offset:3072 lds
  v_exp_f32 v25, v25
  v_mfma_f32_16x16x32_bf16 v[20:23], a[156:159], a[44:47], 0
  ds_read_b128 a[120:123], v1 offset:43520
  v_fma_f32 v26, v26, s24, v9
  v_mfma_f32_16x16x32_bf16 v[20:23], a[152:155], a[40:43], v[20:23]
  v_exp_f32 v26, v26
  v_mfma_f32_16x16x32_bf16 v[20:23], a[148:151], a[36:39], v[20:23]
  ds_read_b128 a[124:127], v1 offset:43776
  v_fma_f32 v27, v27, s24, v9
  v_mfma_f32_16x16x32_bf16 v[20:23], a[144:147], a[32:35], v[20:23]
  v_exp_f32 v27, v27
  v_mfma_f32_16x16x32_bf16 v[64:67], a[192:195], v[32:35], v[64:67]
  s_add_u32 m0, s33, 8192
  v_fma_f32 v28, v28, s24, v9
  v_cvt_pk_bf16_f32 v36, v24, v25
  v_mfma_f32_16x16x32_bf16 v[68:71], a[196:199], v[32:35], v[68:71]
  buffer_load_dwordx4 v4, s[4:7], s21 offen offset:1024 nt lds
  v_exp_f32 v28, v28
  v_mfma_f32_16x16x32_bf16 v[72:75], a[200:203], v[32:35], v[72:75]
  v_fma_f32 v29, v29, s24, v9
  v_cvt_pk_bf16_f32 v37, v26, v27
  v_mfma_f32_16x16x32_bf16 v[76:79], a[204:207], v[32:35], v[76:79]
  v_exp_f32 v29, v29
  v_mfma_f32_16x16x32_bf16 v[80:83], a[208:211], v[32:35], v[80:83]
  v_fma_f32 v30, v30, s24, v9
  v_fma_f32 v31, v31, s24, v9
  v_mfma_f32_16x16x32_bf16 v[84:87], a[212:215], v[32:35], v[84:87]
  v_exp_f32 v30, v30
  v_mfma_f32_16x16x32_bf16 v[88:91], a[216:219], v[32:35], v[88:91]
  v_exp_f32 v31, v31
  v_mfma_f32_16x16x32_bf16 v[92:95], a[220:223], v[32:35], v[92:95]
  v_cvt_pk_bf16_f32 v38, v28, v29
  v_cvt_pk_bf16_f32 v39, v30, v31
  v_mfma_f32_16x16x32_bf16 v[24:27], a[128:131], a[48:51], 0
  s_add_u32 m0, s32, 16384
  ds_read_b64_tr_b16 a[160:161], v2 offset:32768
  v_fma_f32 v16, v16, s24, v10
  v_smfmac_f32_16x16x64_bf16 v[40:43], a[224:227], v[32:39], v7
  buffer_load_dwordx4 v4, s[12:15], s20 offen lds
  v_mfma_f32_16x16x32_bf16 v[24:27], a[132:135], a[52:55], v[24:27]
  v_exp_f32 v16, v16
  v_mfma_f32_16x16x32_bf16 v[24:27], a[136:139], a[56:59], v[24:27]
  ds_read_b64_tr_b16 a[162:163], v2 offset:40960
  v_fma_f32 v17, v17, s24, v10
  v_mfma_f32_16x16x32_bf16 v[24:27], a[140:143], a[60:63], v[24:27]
  v_exp_f32 v17, v17
  v_mfma_f32_16x16x32_bf16 v[28:31], a[156:159], a[60:63], 0
  ds_read_b64_tr_b16 a[164:165], v2 offset:32776
  v_fma_f32 v18, v18, s24, v10
  v_mfma_f32_16x16x32_bf16 v[28:31], a[152:155], a[56:59], v[28:31]
  v_exp_f32 v18, v18
  v_mfma_f32_16x16x32_bf16 v[28:31], a[148:151], a[52:55], v[28:31]
  ds_read_b64_tr_b16 a[166:167], v2 offset:40968
  v_fma_f32 v19, v19, s24, v10
  v_mfma_f32_16x16x32_bf16 v[28:31], a[144:147], a[48:51], v[28:31]
  v_exp_f32 v19, v19
  v_mfma_f32_16x16x32_bf16 v[96:99], a[192:195], v[36:39], v[96:99]
  v_fma_f32 v20, v20, s24, v10
  v_cvt_pk_bf16_f32 v32, v16, v17
  v_mfma_f32_16x16x32_bf16 v[100:103], a[196:199], v[36:39], v[100:103]
  v_exp_f32 v20, v20
  v_mfma_f32_16x16x32_bf16 v[104:107], a[200:203], v[36:39], v[104:107]
  v_fma_f32 v21, v21, s24, v10
  v_cvt_pk_bf16_f32 v33, v18, v19
  v_mfma_f32_16x16x32_bf16 v[108:111], a[204:207], v[36:39], v[108:111]
  v_exp_f32 v21, v21
  v_mfma_f32_16x16x32_bf16 v[112:115], a[208:211], v[36:39], v[112:115]
  v_fma_f32 v22, v22, s24, v10
  v_fma_f32 v23, v23, s24, v10
  v_mfma_f32_16x16x32_bf16 v[116:119], a[212:215], v[36:39], v[116:119]
  v_exp_f32 v22, v22
  v_mfma_f32_16x16x32_bf16 v[120:123], a[216:219], v[36:39], v[120:123]
  v_exp_f32 v23, v23
  v_mfma_f32_16x16x32_bf16 v[124:127], a[220:223], v[36:39], v[124:127]
  v_cvt_pk_bf16_f32 v34, v20, v21
  v_cvt_pk_bf16_f32 v35, v22, v23
  v_mfma_f32_16x16x32_bf16 v[16:19], a[128:131], a[64:67], 0
  ds_read_b64_tr_b16 a[168:169], v2 offset:33024
  v_fma_f32 v24, v24, s24, v11
  v_mfma_f32_16x16x32_bf16 v[16:19], a[132:135], a[68:71], v[16:19]
  v_exp_f32 v24, v24
  v_mfma_f32_16x16x32_bf16 v[16:19], a[136:139], a[72:75], v[16:19]
  ds_read_b64_tr_b16 a[170:171], v2 offset:41216
  v_fma_f32 v25, v25, s24, v11
  v_mfma_f32_16x16x32_bf16 v[16:19], a[140:143], a[76:79], v[16:19]
  v_exp_f32 v25, v25
  v_mfma_f32_16x16x32_bf16 v[20:23], a[156:159], a[76:79], 0
  ds_read_b64_tr_b16 a[172:173], v2 offset:33032
  v_fma_f32 v26, v26, s24, v11
  v_mfma_f32_16x16x32_bf16 v[20:23], a[152:155], a[72:75], v[20:23]
  v_exp_f32 v26, v26
  v_mfma_f32_16x16x32_bf16 v[20:23], a[148:151], a[68:71], v[20:23]
  ds_read_b64_tr_b16 a[174:175], v2 offset:41224
  v_fma_f32 v27, v27, s24, v11
  v_mfma_f32_16x16x32_bf16 v[20:23], a[144:147], a[64:67], v[20:23]
  v_exp_f32 v27, v27
  v_mfma_f32_16x16x32_bf16 v[128:131], a[192:195], v[32:35], v[128:131]
  s_add_u32 m0, s33, 8192
  v_fma_f32 v28, v28, s24, v11
  v_cvt_pk_bf16_f32 v36, v24, v25
  v_mfma_f32_16x16x32_bf16 v[132:135], a[196:199], v[32:35], v[132:135]
  buffer_load_dwordx4 v4, s[4:7], s21 offen offset:2048 nt lds
  v_exp_f32 v28, v28
  v_mfma_f32_16x16x32_bf16 v[136:139], a[200:203], v[32:35], v[136:139]
  v_fma_f32 v29, v29, s24, v11
  v_cvt_pk_bf16_f32 v37, v26, v27
  v_mfma_f32_16x16x32_bf16 v[140:143], a[204:207], v[32:35], v[140:143]
  v_exp_f32 v29, v29
  v_mfma_f32_16x16x32_bf16 v[144:147], a[208:211], v[32:35], v[144:147]
  v_fma_f32 v30, v30, s24, v11
  v_fma_f32 v31, v31, s24, v11
  v_mfma_f32_16x16x32_bf16 v[148:151], a[212:215], v[32:35], v[148:151]
  v_exp_f32 v30, v30
  v_mfma_f32_16x16x32_bf16 v[152:155], a[216:219], v[32:35], v[152:155]
  v_exp_f32 v31, v31
  v_mfma_f32_16x16x32_bf16 v[156:159], a[220:223], v[32:35], v[156:159]
  v_cvt_pk_bf16_f32 v38, v28, v29
  v_cvt_pk_bf16_f32 v39, v30, v31
  v_mfma_f32_16x16x32_bf16 v[24:27], a[128:131], a[80:83], 0
  s_add_u32 m0, s32, 16384
  ds_read_b64_tr_b16 a[176:177], v2 offset:33280
  v_fma_f32 v16, v16, s24, v12
  v_smfmac_f32_16x16x64_bf16 v[44:47], a[224:227], v[32:39], v7
  buffer_load_dwordx4 v4, s[12:15], s20 offen offset:1024 lds
  v_mfma_f32_16x16x32_bf16 v[24:27], a[132:135], a[84:87], v[24:27]
  v_exp_f32 v16, v16
  v_mfma_f32_16x16x32_bf16 v[24:27], a[136:139], a[88:91], v[24:27]
  ds_read_b64_tr_b16 a[178:179], v2 offset:41472
  v_fma_f32 v17, v17, s24, v12
  v_mfma_f32_16x16x32_bf16 v[24:27], a[140:143], a[92:95], v[24:27]
  v_exp_f32 v17, v17
  v_mfma_f32_16x16x32_bf16 v[28:31], a[156:159], a[92:95], 0
  ds_read_b64_tr_b16 a[180:181], v2 offset:33288
  v_fma_f32 v18, v18, s24, v12
  v_mfma_f32_16x16x32_bf16 v[28:31], a[152:155], a[88:91], v[28:31]
  v_exp_f32 v18, v18
  v_mfma_f32_16x16x32_bf16 v[28:31], a[148:151], a[84:87], v[28:31]
  ds_read_b64_tr_b16 a[182:183], v2 offset:41480
  v_fma_f32 v19, v19, s24, v12
  v_mfma_f32_16x16x32_bf16 v[28:31], a[144:147], a[80:83], v[28:31]
  v_exp_f32 v19, v19
  v_mfma_f32_16x16x32_bf16 v[160:163], a[192:195], v[36:39], v[160:163]
  v_fma_f32 v20, v20, s24, v12
  v_cvt_pk_bf16_f32 v32, v16, v17
  v_mfma_f32_16x16x32_bf16 v[164:167], a[196:199], v[36:39], v[164:167]
  v_exp_f32 v20, v20
  v_mfma_f32_16x16x32_bf16 v[168:171], a[200:203], v[36:39], v[168:171]
  v_fma_f32 v21, v21, s24, v12
  v_cvt_pk_bf16_f32 v33, v18, v19
  v_mfma_f32_16x16x32_bf16 v[172:175], a[204:207], v[36:39], v[172:175]
  v_exp_f32 v21, v21
  v_mfma_f32_16x16x32_bf16 v[176:179], a[208:211], v[36:39], v[176:179]
  v_fma_f32 v22, v22, s24, v12
  v_fma_f32 v23, v23, s24, v12
  v_mfma_f32_16x16x32_bf16 v[180:183], a[212:215], v[36:39], v[180:183]
  v_exp_f32 v22, v22
  v_mfma_f32_16x16x32_bf16 v[184:187], a[216:219], v[36:39], v[184:187]
  v_exp_f32 v23, v23
  v_mfma_f32_16x16x32_bf16 v[188:191], a[220:223], v[36:39], v[188:191]
  s_waitcnt lgkmcnt(12)
  v_cvt_pk_bf16_f32 v34, v20, v21
  v_cvt_pk_bf16_f32 v35, v22, v23
  v_mfma_f32_16x16x32_bf16 v[16:19], a[96:99], a[0:3], 0
  ds_read_b64_tr_b16 a[184:185], v2 offset:33536
  v_fma_f32 v24, v24, s24, v13
  v_mfma_f32_16x16x32_bf16 v[16:19], a[100:103], a[4:7], v[16:19]
  v_exp_f32 v24, v24
  v_mfma_f32_16x16x32_bf16 v[16:19], a[104:107], a[8:11], v[16:19]
  ds_read_b64_tr_b16 a[186:187], v2 offset:41728
  v_fma_f32 v25, v25, s24, v13
  v_mfma_f32_16x16x32_bf16 v[16:19], a[108:111], a[12:15], v[16:19]
  v_exp_f32 v25, v25
  v_mfma_f32_16x16x32_bf16 v[20:23], a[124:127], a[12:15], 0
  ds_read_b64_tr_b16 a[188:189], v2 offset:33544
  v_fma_f32 v26, v26, s24, v13
  v_mfma_f32_16x16x32_bf16 v[20:23], a[120:123], a[8:11], v[20:23]
  v_exp_f32 v26, v26
  v_mfma_f32_16x16x32_bf16 v[20:23], a[116:119], a[4:7], v[20:23]
  ds_read_b64_tr_b16 a[190:191], v2 offset:41736
  v_fma_f32 v27, v27, s24, v13
  v_mfma_f32_16x16x32_bf16 v[20:23], a[112:115], a[0:3], v[20:23]
  v_exp_f32 v27, v27
  v_mfma_f32_16x16x32_bf16 v[192:195], a[192:195], v[32:35], v[192:195]
  s_add_u32 m0, s33, 8192
  v_fma_f32 v28, v28, s24, v13
  v_cvt_pk_bf16_f32 v36, v24, v25
  v_mfma_f32_16x16x32_bf16 v[196:199], a[196:199], v[32:35], v[196:199]
  buffer_load_dwordx4 v4, s[4:7], s21 offen offset:3072 nt lds
  v_exp_f32 v28, v28
  v_mfma_f32_16x16x32_bf16 v[200:203], a[200:203], v[32:35], v[200:203]
  v_fma_f32 v29, v29, s24, v13
  v_cvt_pk_bf16_f32 v37, v26, v27
  v_mfma_f32_16x16x32_bf16 v[204:207], a[204:207], v[32:35], v[204:207]
  v_exp_f32 v29, v29
  v_mfma_f32_16x16x32_bf16 v[208:211], a[208:211], v[32:35], v[208:211]
  s_add_u32 s21, s21, 4096
  s_add_u32 s20, s20, 8192
  v_fma_f32 v30, v30, s24, v13
  v_fma_f32 v31, v31, s24, v13
  v_mfma_f32_16x16x32_bf16 v[212:215], a[212:215], v[32:35], v[212:215]
  v_exp_f32 v30, v30
  v_mfma_f32_16x16x32_bf16 v[216:219], a[216:219], v[32:35], v[216:219]
  s_add_u32 m0, s33, 12288
  v_exp_f32 v31, v31
  v_mfma_f32_16x16x32_bf16 v[220:223], a[220:223], v[32:35], v[220:223]
  s_waitcnt vmcnt(15) lgkmcnt(0)
  v_cvt_pk_bf16_f32 v38, v28, v29
  v_cvt_pk_bf16_f32 v39, v30, v31
  v_mfma_f32_16x16x32_bf16 v[24:27], a[96:99], a[16:19], 0
  s_barrier
  ds_read_b128 a[128:131], v1 offset:51200
  v_fma_f32 v16, v16, s24, v8
  v_smfmac_f32_16x16x64_bf16 v[48:51], a[224:227], v[32:39], v7
  buffer_load_dwordx4 v4, s[4:7], s21 offen nt lds
  v_mfma_f32_16x16x32_bf16 v[24:27], a[100:103], a[20:23], v[24:27]
  v_exp_f32 v16, v16
  v_mfma_f32_16x16x32_bf16 v[24:27], a[104:107], a[24:27], v[24:27]
  ds_read_b128 a[132:135], v1 offset:51456
  v_fma_f32 v17, v17, s24, v8
  v_mfma_f32_16x16x32_bf16 v[24:27], a[108:111], a[28:31], v[24:27]
  v_exp_f32 v17, v17
  v_mfma_f32_16x16x32_bf16 v[28:31], a[124:127], a[28:31], 0
  ds_read_b128 a[136:139], v1 offset:51712
  v_fma_f32 v18, v18, s24, v8
  v_mfma_f32_16x16x32_bf16 v[28:31], a[120:123], a[24:27], v[28:31]
  v_exp_f32 v18, v18
  v_mfma_f32_16x16x32_bf16 v[28:31], a[116:119], a[20:23], v[28:31]
  ds_read_b128 a[140:143], v1 offset:51968
  v_fma_f32 v19, v19, s24, v8
  v_mfma_f32_16x16x32_bf16 v[28:31], a[112:115], a[16:19], v[28:31]
  v_exp_f32 v19, v19
  v_mfma_f32_16x16x32_bf16 v[224:227], a[192:195], v[36:39], v[224:227]
  v_fma_f32 v20, v20, s24, v8
  v_cvt_pk_bf16_f32 v32, v16, v17
  v_mfma_f32_16x16x32_bf16 v[228:231], a[196:199], v[36:39], v[228:231]
  v_exp_f32 v20, v20
  v_mfma_f32_16x16x32_bf16 v[232:235], a[200:203], v[36:39], v[232:235]
  s_add_u32 m0, s32, 32768
  v_fma_f32 v21, v21, s24, v8
  v_cvt_pk_bf16_f32 v33, v18, v19
  v_mfma_f32_16x16x32_bf16 v[236:239], a[204:207], v[36:39], v[236:239]
  buffer_load_dwordx4 v5, s[8:11], s20 offen offset:2048 lds
  v_exp_f32 v21, v21
  v_mfma_f32_16x16x32_bf16 v[240:243], a[208:211], v[36:39], v[240:243]
  v_fma_f32 v22, v22, s24, v8
  v_fma_f32 v23, v23, s24, v8
  v_mfma_f32_16x16x32_bf16 v[244:247], a[212:215], v[36:39], v[244:247]
  v_exp_f32 v22, v22
  v_mfma_f32_16x16x32_bf16 v[248:251], a[216:219], v[36:39], v[248:251]
  v_exp_f32 v23, v23
  v_mfma_f32_16x16x32_bf16 v[252:255], a[220:223], v[36:39], v[252:255]
  v_cvt_pk_bf16_f32 v34, v20, v21
  v_cvt_pk_bf16_f32 v35, v22, v23
  v_mfma_f32_16x16x32_bf16 v[16:19], a[96:99], a[32:35], 0
  ds_read_b128 a[144:147], v1 offset:59392
  v_fma_f32 v24, v24, s24, v9
  v_mfma_f32_16x16x32_bf16 v[16:19], a[100:103], a[36:39], v[16:19]
  v_exp_f32 v24, v24
  v_mfma_f32_16x16x32_bf16 v[16:19], a[104:107], a[40:43], v[16:19]
  ds_read_b128 a[148:151], v1 offset:59648
  v_fma_f32 v25, v25, s24, v9
  v_mfma_f32_16x16x32_bf16 v[16:19], a[108:111], a[44:47], v[16:19]
  buffer_load_dwordx4 v5, s[8:11], s20 offen offset:3072 lds
  v_exp_f32 v25, v25
  v_mfma_f32_16x16x32_bf16 v[20:23], a[124:127], a[44:47], 0
  ds_read_b128 a[152:155], v1 offset:59904
  v_fma_f32 v26, v26, s24, v9
  v_mfma_f32_16x16x32_bf16 v[20:23], a[120:123], a[40:43], v[20:23]
  v_exp_f32 v26, v26
  v_mfma_f32_16x16x32_bf16 v[20:23], a[116:119], a[36:39], v[20:23]
  ds_read_b128 a[156:159], v1 offset:60160
  v_fma_f32 v27, v27, s24, v9
  v_mfma_f32_16x16x32_bf16 v[20:23], a[112:115], a[32:35], v[20:23]
  v_exp_f32 v27, v27
  v_mfma_f32_16x16x32_bf16 v[64:67], a[160:163], v[32:35], v[64:67]
  v_fma_f32 v28, v28, s24, v9
  v_cvt_pk_bf16_f32 v36, v24, v25
  v_mfma_f32_16x16x32_bf16 v[68:71], a[164:167], v[32:35], v[68:71]
  v_exp_f32 v28, v28
  v_mfma_f32_16x16x32_bf16 v[72:75], a[168:171], v[32:35], v[72:75]
  v_fma_f32 v29, v29, s24, v9
  v_cvt_pk_bf16_f32 v37, v26, v27
  v_mfma_f32_16x16x32_bf16 v[76:79], a[172:175], v[32:35], v[76:79]
  v_exp_f32 v29, v29
  v_mfma_f32_16x16x32_bf16 v[80:83], a[176:179], v[32:35], v[80:83]
  v_fma_f32 v30, v30, s24, v9
  v_fma_f32 v31, v31, s24, v9
  v_mfma_f32_16x16x32_bf16 v[84:87], a[180:183], v[32:35], v[84:87]
  v_exp_f32 v30, v30
  v_mfma_f32_16x16x32_bf16 v[88:91], a[184:187], v[32:35], v[88:91]
  v_exp_f32 v31, v31
  v_mfma_f32_16x16x32_bf16 v[92:95], a[188:191], v[32:35], v[92:95]
  v_cvt_pk_bf16_f32 v38, v28, v29
  v_cvt_pk_bf16_f32 v39, v30, v31
  v_mfma_f32_16x16x32_bf16 v[24:27], a[96:99], a[48:51], 0
  s_add_u32 m0, s33, 12288
  ds_read_b64_tr_b16 a[192:193], v2 offset:49152
  v_fma_f32 v16, v16, s24, v10
  v_smfmac_f32_16x16x64_bf16 v[40:43], a[224:227], v[32:39], v7
  buffer_load_dwordx4 v4, s[4:7], s21 offen offset:1024 nt lds
  v_mfma_f32_16x16x32_bf16 v[24:27], a[100:103], a[52:55], v[24:27]
L_pad6:
  s_cbranch_execz L_pad7
  v_exp_f32 v16, v16
  v_mfma_f32_16x16x32_bf16 v[24:27], a[104:107], a[56:59], v[24:27]
  ds_read_b64_tr_b16 a[194:195], v2 offset:57344
  v_fma_f32 v17, v17, s24, v10
  v_mfma_f32_16x16x32_bf16 v[24:27], a[108:111], a[60:63], v[24:27]
  v_exp_f32 v17, v17
  v_mfma_f32_16x16x32_bf16 v[28:31], a[124:127], a[60:63], 0
  ds_read_b64_tr_b16 a[196:197], v2 offset:49160
  v_fma_f32 v18, v18, s24, v10
  v_mfma_f32_16x16x32_bf16 v[28:31], a[120:123], a[56:59], v[28:31]
  v_exp_f32 v18, v18
  v_mfma_f32_16x16x32_bf16 v[28:31], a[116:119], a[52:55], v[28:31]
  ds_read_b64_tr_b16 a[198:199], v2 offset:57352
  v_fma_f32 v19, v19, s24, v10
  v_mfma_f32_16x16x32_bf16 v[28:31], a[112:115], a[48:51], v[28:31]
  v_exp_f32 v19, v19
  v_mfma_f32_16x16x32_bf16 v[96:99], a[160:163], v[36:39], v[96:99]
  v_fma_f32 v20, v20, s24, v10
  v_cvt_pk_bf16_f32 v32, v16, v17
  v_mfma_f32_16x16x32_bf16 v[100:103], a[164:167], v[36:39], v[100:103]
  v_exp_f32 v20, v20
  v_mfma_f32_16x16x32_bf16 v[104:107], a[168:171], v[36:39], v[104:107]
  s_add_u32 m0, s32, 32768
  v_fma_f32 v21, v21, s24, v10
  v_cvt_pk_bf16_f32 v33, v18, v19
  v_mfma_f32_16x16x32_bf16 v[108:111], a[172:175], v[36:39], v[108:111]
  buffer_load_dwordx4 v4, s[12:15], s20 offen lds
  v_exp_f32 v21, v21
  v_mfma_f32_16x16x32_bf16 v[112:115], a[176:179], v[36:39], v[112:115]
  v_fma_f32 v22, v22, s24, v10
  v_fma_f32 v23, v23, s24, v10
  v_mfma_f32_16x16x32_bf16 v[116:119], a[180:183], v[36:39], v[116:119]
  v_exp_f32 v22, v22
  v_mfma_f32_16x16x32_bf16 v[120:123], a[184:187], v[36:39], v[120:123]
  v_exp_f32 v23, v23
  v_mfma_f32_16x16x32_bf16 v[124:127], a[188:191], v[36:39], v[124:127]
  v_cvt_pk_bf16_f32 v34, v20, v21
  v_cvt_pk_bf16_f32 v35, v22, v23
  v_mfma_f32_16x16x32_bf16 v[16:19], a[96:99], a[64:67], 0
  ds_read_b64_tr_b16 a[200:201], v2 offset:49408
  v_fma_f32 v24, v24, s24, v11
  v_mfma_f32_16x16x32_bf16 v[16:19], a[100:103], a[68:71], v[16:19]
  v_exp_f32 v24, v24
  v_mfma_f32_16x16x32_bf16 v[16:19], a[104:107], a[72:75], v[16:19]
  ds_read_b64_tr_b16 a[202:203], v2 offset:57600
  v_fma_f32 v25, v25, s24, v11
  v_mfma_f32_16x16x32_bf16 v[16:19], a[108:111], a[76:79], v[16:19]
  buffer_load_dwordx4 v4, s[12:15], s20 offen offset:1024 lds
  v_exp_f32 v25, v25
  v_mfma_f32_16x16x32_bf16 v[20:23], a[124:127], a[76:79], 0
  ds_read_b64_tr_b16 a[204:205], v2 offset:49416
  v_fma_f32 v26, v26, s24, v11
  v_mfma_f32_16x16x32_bf16 v[20:23], a[120:123], a[72:75], v[20:23]
  v_exp_f32 v26, v26
  v_mfma_f32_16x16x32_bf16 v[20:23], a[116:119], a[68:71], v[20:23]
  ds_read_b64_tr_b16 a[206:207], v2 offset:57608
  v_fma_f32 v27, v27, s24, v11
  v_mfma_f32_16x16x32_bf16 v[20:23], a[112:115], a[64:67], v[20:23]
  v_exp_f32 v27, v27
  v_mfma_f32_16x16x32_bf16 v[128:131], a[160:163], v[32:35], v[128:131]
  v_fma_f32 v28, v28, s24, v11
  v_cvt_pk_bf16_f32 v36, v24, v25
  v_mfma_f32_16x16x32_bf16 v[132:135], a[164:167], v[32:35], v[132:135]
  v_exp_f32 v28, v28
  v_mfma_f32_16x16x32_bf16 v[136:139], a[168:171], v[32:35], v[136:139]
  v_fma_f32 v29, v29, s24, v11
  v_cvt_pk_bf16_f32 v37, v26, v27
  v_mfma_f32_16x16x32_bf16 v[140:143], a[172:175], v[32:35], v[140:143]
  v_exp_f32 v29, v29
  v_mfma_f32_16x16x32_bf16 v[144:147], a[176:179], v[32:35], v[144:147]
  v_fma_f32 v30, v30, s24, v11
  v_fma_f32 v31, v31, s24, v11
  v_mfma_f32_16x16x32_bf16 v[148:151], a[180:183], v[32:35], v[148:151]
  v_exp_f32 v30, v30
  v_mfma_f32_16x16x32_bf16 v[152:155], a[184:187], v[32:35], v[152:155]
  v_exp_f32 v31, v31
  v_mfma_f32_16x16x32_bf16 v[156:159], a[188:191], v[32:35], v[156:159]
  v_cvt_pk_bf16_f32 v38, v28, v29
  v_cvt_pk_bf16_f32 v39, v30, v31
  v_mfma_f32_16x16x32_bf16 v[24:27], a[96:99], a[80:83], 0
  s_add_u32 m0, s33, 12288
  ds_read_b64_tr_b16 a[208:209], v2 offset:49664
  v_fma_f32 v16, v16, s24, v12
  v_smfmac_f32_16x16x64_bf16 v[44:47], a[224:227], v[32:39], v7
  buffer_load_dwordx4 v4, s[4:7], s21 offen offset:2048 nt lds
  v_mfma_f32_16x16x32_bf16 v[24:27], a[100:103], a[84:87], v[24:27]
  v_exp_f32 v16, v16
  v_mfma_f32_16x16x32_bf16 v[24:27], a[104:107], a[88:91], v[24:27]
  ds_read_b64_tr_b16 a[210:211], v2 offset:57856
  v_fma_f32 v17, v17, s24, v12
  v_mfma_f32_16x16x32_bf16 v[24:27], a[108:111], a[92:95], v[24:27]
  v_exp_f32 v17, v17
  v_mfma_f32_16x16x32_bf16 v[28:31], a[124:127], a[92:95], 0
  ds_read_b64_tr_b16 a[212:213], v2 offset:49672
  v_fma_f32 v18, v18, s24, v12
  v_mfma_f32_16x16x32_bf16 v[28:31], a[120:123], a[88:91], v[28:31]
  v_exp_f32 v18, v18
  v_mfma_f32_16x16x32_bf16 v[28:31], a[116:119], a[84:87], v[28:31]
  ds_read_b64_tr_b16 a[214:215], v2 offset:57864
  v_fma_f32 v19, v19, s24, v12
  v_mfma_f32_16x16x32_bf16 v[28:31], a[112:115], a[80:83], v[28:31]
  v_exp_f32 v19, v19
  v_mfma_f32_16x16x32_bf16 v[160:163], a[160:163], v[36:39], v[160:163]
  v_fma_f32 v20, v20, s24, v12
  v_cvt_pk_bf16_f32 v32, v16, v17
  v_mfma_f32_16x16x32_bf16 v[164:167], a[164:167], v[36:39], v[164:167]
  v_exp_f32 v20, v20
  v_mfma_f32_16x16x32_bf16 v[168:171], a[168:171], v[36:39], v[168:171]
  v_fma_f32 v21, v21, s24, v12
  v_cvt_pk_bf16_f32 v33, v18, v19
  v_mfma_f32_16x16x32_bf16 v[172:175], a[172:175], v[36:39], v[172:175]
  v_exp_f32 v21, v21
  v_mfma_f32_16x16x32_bf16 v[176:179], a[176:179], v[36:39], v[176:179]
  v_fma_f32 v22, v22, s24, v12
  v_fma_f32 v23, v23, s24, v12
  v_mfma_f32_16x16x32_bf16 v[180:183], a[180:183], v[36:39], v[180:183]
  v_exp_f32 v22, v22
  v_mfma_f32_16x16x32_bf16 v[184:187], a[184:187], v[36:39], v[184:187]
  v_exp_f32 v23, v23
  v_mfma_f32_16x16x32_bf16 v[188:191], a[188:191], v[36:39], v[188:191]
  s_waitcnt lgkmcnt(12)
  v_cvt_pk_bf16_f32 v34, v20, v21
  v_cvt_pk_bf16_f32 v35, v22, v23
  v_mfma_f32_16x16x32_bf16 v[16:19], a[128:131], a[0:3], 0
  ds_read_b64_tr_b16 a[216:217], v2 offset:49920
  v_fma_f32 v24, v24, s24, v13
  v_mfma_f32_16x16x32_bf16 v[16:19], a[132:135], a[4:7], v[16:19]
  v_exp_f32 v24, v24
  v_mfma_f32_16x16x32_bf16 v[16:19], a[136:139], a[8:11], v[16:19]
  ds_read_b64_tr_b16 a[218:219], v2 offset:58112
  v_fma_f32 v25, v25, s24, v13
  v_mfma_f32_16x16x32_bf16 v[16:19], a[140:143], a[12:15], v[16:19]
  v_exp_f32 v25, v25
  v_mfma_f32_16x16x32_bf16 v[20:23], a[156:159], a[12:15], 0
  ds_read_b64_tr_b16 a[220:221], v2 offset:49928
  v_fma_f32 v26, v26, s24, v13
  v_mfma_f32_16x16x32_bf16 v[20:23], a[152:155], a[8:11], v[20:23]
  v_exp_f32 v26, v26
  v_mfma_f32_16x16x32_bf16 v[20:23], a[148:151], a[4:7], v[20:23]
  ds_read_b64_tr_b16 a[222:223], v2 offset:58120
  v_fma_f32 v27, v27, s24, v13
  v_mfma_f32_16x16x32_bf16 v[20:23], a[144:147], a[0:3], v[20:23]
  v_exp_f32 v27, v27
  v_mfma_f32_16x16x32_bf16 v[192:195], a[160:163], v[32:35], v[192:195]
  v_fma_f32 v28, v28, s24, v13
  v_cvt_pk_bf16_f32 v36, v24, v25
  v_mfma_f32_16x16x32_bf16 v[196:199], a[164:167], v[32:35], v[196:199]
  v_exp_f32 v28, v28
  v_mfma_f32_16x16x32_bf16 v[200:203], a[168:171], v[32:35], v[200:203]
  v_fma_f32 v29, v29, s24, v13
  v_cvt_pk_bf16_f32 v37, v26, v27
  v_mfma_f32_16x16x32_bf16 v[204:207], a[172:175], v[32:35], v[204:207]
  v_exp_f32 v29, v29
  v_mfma_f32_16x16x32_bf16 v[208:211], a[176:179], v[32:35], v[208:211]
  s_add_u32 s20, s20, 8192
  v_fma_f32 v30, v30, s24, v13
  v_fma_f32 v31, v31, s24, v13
  v_mfma_f32_16x16x32_bf16 v[212:215], a[180:183], v[32:35], v[212:215]
  v_exp_f32 v30, v30
  v_mfma_f32_16x16x32_bf16 v[216:219], a[184:187], v[32:35], v[216:219]
  v_exp_f32 v31, v31
  v_mfma_f32_16x16x32_bf16 v[220:223], a[188:191], v[32:35], v[220:223]
  s_waitcnt vmcnt(15) lgkmcnt(0)
  v_cvt_pk_bf16_f32 v38, v28, v29
  v_cvt_pk_bf16_f32 v39, v30, v31
  v_mfma_f32_16x16x32_bf16 v[24:27], a[128:131], a[16:19], 0
  s_barrier
  ds_read_b128 a[96:99], v1 offset:2048
  v_fma_f32 v16, v16, s24, v8
  v_smfmac_f32_16x16x64_bf16 v[48:51], a[224:227], v[32:39], v7
  buffer_load_dwordx4 v4, s[4:7], s21 offen offset:3072 nt lds
  v_mfma_f32_16x16x32_bf16 v[24:27], a[132:135], a[20:23], v[24:27]
  v_exp_f32 v16, v16
  v_mfma_f32_16x16x32_bf16 v[24:27], a[136:139], a[24:27], v[24:27]
  ds_read_b128 a[100:103], v1 offset:2304
  v_fma_f32 v17, v17, s24, v8
  v_mfma_f32_16x16x32_bf16 v[24:27], a[140:143], a[28:31], v[24:27]
  v_exp_f32 v17, v17
  v_mfma_f32_16x16x32_bf16 v[28:31], a[156:159], a[28:31], 0
  ds_read_b128 a[104:107], v1 offset:2560
  v_fma_f32 v18, v18, s24, v8
  v_mfma_f32_16x16x32_bf16 v[28:31], a[152:155], a[24:27], v[28:31]
  v_exp_f32 v18, v18
  v_mfma_f32_16x16x32_bf16 v[28:31], a[148:151], a[20:23], v[28:31]
  ds_read_b128 a[108:111], v1 offset:2816
  v_fma_f32 v19, v19, s24, v8
  v_mfma_f32_16x16x32_bf16 v[28:31], a[144:147], a[16:19], v[28:31]
  v_exp_f32 v19, v19
  v_mfma_f32_16x16x32_bf16 v[224:227], a[160:163], v[36:39], v[224:227]
  v_fma_f32 v20, v20, s24, v8
  v_cvt_pk_bf16_f32 v32, v16, v17
  v_mfma_f32_16x16x32_bf16 v[228:231], a[164:167], v[36:39], v[228:231]
  v_exp_f32 v20, v20
  v_mfma_f32_16x16x32_bf16 v[232:235], a[168:171], v[36:39], v[232:235]
  s_add_u32 m0, s32, 49152
  v_fma_f32 v21, v21, s24, v8
  v_cvt_pk_bf16_f32 v33, v18, v19
  v_mfma_f32_16x16x32_bf16 v[236:239], a[172:175], v[36:39], v[236:239]
  buffer_load_dwordx4 v5, s[8:11], s20 offen offset:2048 lds
  v_exp_f32 v21, v21
  v_mfma_f32_16x16x32_bf16 v[240:243], a[176:179], v[36:39], v[240:243]
  s_add_u32 s21, s21, 4096
  v_fma_f32 v22, v22, s24, v8
  v_fma_f32 v23, v23, s24, v8
  v_mfma_f32_16x16x32_bf16 v[244:247], a[180:183], v[36:39], v[244:247]
  v_exp_f32 v22, v22
  v_mfma_f32_16x16x32_bf16 v[248:251], a[184:187], v[36:39], v[248:251]
  v_exp_f32 v23, v23
  v_mfma_f32_16x16x32_bf16 v[252:255], a[188:191], v[36:39], v[252:255]
  v_cvt_pk_bf16_f32 v34, v20, v21
  v_cvt_pk_bf16_f32 v35, v22, v23
  v_mfma_f32_16x16x32_bf16 v[16:19], a[128:131], a[32:35], 0
  ds_read_b128 a[112:115], v1 offset:10240
  v_fma_f32 v24, v24, s24, v9
  v_mfma_f32_16x16x32_bf16 v[16:19], a[132:135], a[36:39], v[16:19]
  v_exp_f32 v24, v24
  v_mfma_f32_16x16x32_bf16 v[16:19], a[136:139], a[40:43], v[16:19]
  ds_read_b128 a[116:119], v1 offset:10496
  v_fma_f32 v25, v25, s24, v9
  v_mfma_f32_16x16x32_bf16 v[16:19], a[140:143], a[44:47], v[16:19]
  buffer_load_dwordx4 v5, s[8:11], s20 offen offset:3072 lds
  v_exp_f32 v25, v25
  v_mfma_f32_16x16x32_bf16 v[20:23], a[156:159], a[44:47], 0
  ds_read_b128 a[120:123], v1 offset:10752
  v_fma_f32 v26, v26, s24, v9
  v_mfma_f32_16x16x32_bf16 v[20:23], a[152:155], a[40:43], v[20:23]
  v_exp_f32 v26, v26
  v_mfma_f32_16x16x32_bf16 v[20:23], a[148:151], a[36:39], v[20:23]
  ds_read_b128 a[124:127], v1 offset:11008
  v_fma_f32 v27, v27, s24, v9
  v_mfma_f32_16x16x32_bf16 v[20:23], a[144:147], a[32:35], v[20:23]
  v_exp_f32 v27, v27
  v_mfma_f32_16x16x32_bf16 v[64:67], a[192:195], v[32:35], v[64:67]
  v_fma_f32 v28, v28, s24, v9
  v_cvt_pk_bf16_f32 v36, v24, v25
  v_mfma_f32_16x16x32_bf16 v[68:71], a[196:199], v[32:35], v[68:71]
  v_exp_f32 v28, v28
  v_mfma_f32_16x16x32_bf16 v[72:75], a[200:203], v[32:35], v[72:75]
  v_fma_f32 v29, v29, s24, v9
  v_cvt_pk_bf16_f32 v37, v26, v27
  v_mfma_f32_16x16x32_bf16 v[76:79], a[204:207], v[32:35], v[76:79]
  v_exp_f32 v29, v29
  v_mfma_f32_16x16x32_bf16 v[80:83], a[208:211], v[32:35], v[80:83]
  v_fma_f32 v30, v30, s24, v9
  v_fma_f32 v31, v31, s24, v9
  v_mfma_f32_16x16x32_bf16 v[84:87], a[212:215], v[32:35], v[84:87]
  v_exp_f32 v30, v30
  v_mfma_f32_16x16x32_bf16 v[88:91], a[216:219], v[32:35], v[88:91]
  v_exp_f32 v31, v31
  v_mfma_f32_16x16x32_bf16 v[92:95], a[220:223], v[32:35], v[92:95]
  v_cvt_pk_bf16_f32 v38, v28, v29
  v_cvt_pk_bf16_f32 v39, v30, v31
  v_mfma_f32_16x16x32_bf16 v[24:27], a[128:131], a[48:51], 0
  s_add_u32 m0, s33, 16384
  ds_read_b64_tr_b16 a[160:161], v2 offset:0
  v_fma_f32 v16, v16, s24, v10
  v_smfmac_f32_16x16x64_bf16 v[40:43], a[224:227], v[32:39], v7
  buffer_load_dwordx4 v4, s[4:7], s21 offen nt lds
  v_mfma_f32_16x16x32_bf16 v[24:27], a[132:135], a[52:55], v[24:27]
  v_exp_f32 v16, v16
  v_mfma_f32_16x16x32_bf16 v[24:27], a[136:139], a[56:59], v[24:27]
  ds_read_b64_tr_b16 a[162:163], v2 offset:8192
  v_fma_f32 v17, v17, s24, v10
  v_mfma_f32_16x16x32_bf16 v[24:27], a[140:143], a[60:63], v[24:27]
  v_exp_f32 v17, v17
  v_mfma_f32_16x16x32_bf16 v[28:31], a[156:159], a[60:63], 0
  ds_read_b64_tr_b16 a[164:165], v2 offset:8
  v_fma_f32 v18, v18, s24, v10
  v_mfma_f32_16x16x32_bf16 v[28:31], a[152:155], a[56:59], v[28:31]
  v_exp_f32 v18, v18
  v_mfma_f32_16x16x32_bf16 v[28:31], a[148:151], a[52:55], v[28:31]
  ds_read_b64_tr_b16 a[166:167], v2 offset:8200
  v_fma_f32 v19, v19, s24, v10
  v_mfma_f32_16x16x32_bf16 v[28:31], a[144:147], a[48:51], v[28:31]
  v_exp_f32 v19, v19
  v_mfma_f32_16x16x32_bf16 v[96:99], a[192:195], v[36:39], v[96:99]
  v_fma_f32 v20, v20, s24, v10
  v_cvt_pk_bf16_f32 v32, v16, v17
  v_mfma_f32_16x16x32_bf16 v[100:103], a[196:199], v[36:39], v[100:103]
  v_exp_f32 v20, v20
  v_mfma_f32_16x16x32_bf16 v[104:107], a[200:203], v[36:39], v[104:107]
  s_add_u32 m0, s32, 49152
  v_fma_f32 v21, v21, s24, v10
  v_cvt_pk_bf16_f32 v33, v18, v19
  v_mfma_f32_16x16x32_bf16 v[108:111], a[204:207], v[36:39], v[108:111]
  buffer_load_dwordx4 v4, s[12:15], s20 offen lds
  v_exp_f32 v21, v21
  v_mfma_f32_16x16x32_bf16 v[112:115], a[208:211], v[36:39], v[112:115]
  v_fma_f32 v22, v22, s24, v10
  v_fma_f32 v23, v23, s24, v10
  v_mfma_f32_16x16x32_bf16 v[116:119], a[212:215], v[36:39], v[116:119]
  v_exp_f32 v22, v22
  v_mfma_f32_16x16x32_bf16 v[120:123], a[216:219], v[36:39], v[120:123]
  v_exp_f32 v23, v23
  v_mfma_f32_16x16x32_bf16 v[124:127], a[220:223], v[36:39], v[124:127]
  v_cvt_pk_bf16_f32 v34, v20, v21
  v_cvt_pk_bf16_f32 v35, v22, v23
  v_mfma_f32_16x16x32_bf16 v[16:19], a[128:131], a[64:67], 0
  ds_read_b64_tr_b16 a[168:169], v2 offset:256
  v_fma_f32 v24, v24, s24, v11
  v_mfma_f32_16x16x32_bf16 v[16:19], a[132:135], a[68:71], v[16:19]
  v_exp_f32 v24, v24
  v_mfma_f32_16x16x32_bf16 v[16:19], a[136:139], a[72:75], v[16:19]
  ds_read_b64_tr_b16 a[170:171], v2 offset:8448
  v_fma_f32 v25, v25, s24, v11
  v_mfma_f32_16x16x32_bf16 v[16:19], a[140:143], a[76:79], v[16:19]
  buffer_load_dwordx4 v4, s[12:15], s20 offen offset:1024 lds
  v_exp_f32 v25, v25
  v_mfma_f32_16x16x32_bf16 v[20:23], a[156:159], a[76:79], 0
  ds_read_b64_tr_b16 a[172:173], v2 offset:264
  v_fma_f32 v26, v26, s24, v11
  v_mfma_f32_16x16x32_bf16 v[20:23], a[152:155], a[72:75], v[20:23]
  v_exp_f32 v26, v26
  v_mfma_f32_16x16x32_bf16 v[20:23], a[148:151], a[68:71], v[20:23]
  ds_read_b64_tr_b16 a[174:175], v2 offset:8456
  v_fma_f32 v27, v27, s24, v11
  v_mfma_f32_16x16x32_bf16 v[20:23], a[144:147], a[64:67], v[20:23]
  v_exp_f32 v27, v27
  v_mfma_f32_16x16x32_bf16 v[128:131], a[192:195], v[32:35], v[128:131]
  v_fma_f32 v28, v28, s24, v11
  v_cvt_pk_bf16_f32 v36, v24, v25
  v_mfma_f32_16x16x32_bf16 v[132:135], a[196:199], v[32:35], v[132:135]
  v_exp_f32 v28, v28
  v_mfma_f32_16x16x32_bf16 v[136:139], a[200:203], v[32:35], v[136:139]
  v_fma_f32 v29, v29, s24, v11
  v_cvt_pk_bf16_f32 v37, v26, v27
  v_mfma_f32_16x16x32_bf16 v[140:143], a[204:207], v[32:35], v[140:143]
  v_exp_f32 v29, v29
  v_mfma_f32_16x16x32_bf16 v[144:147], a[208:211], v[32:35], v[144:147]
  v_fma_f32 v30, v30, s24, v11
  v_fma_f32 v31, v31, s24, v11
  v_mfma_f32_16x16x32_bf16 v[148:151], a[212:215], v[32:35], v[148:151]
  v_exp_f32 v30, v30
  v_mfma_f32_16x16x32_bf16 v[152:155], a[216:219], v[32:35], v[152:155]
  v_exp_f32 v31, v31
  v_mfma_f32_16x16x32_bf16 v[156:159], a[220:223], v[32:35], v[156:159]
  v_cvt_pk_bf16_f32 v38, v28, v29
  v_cvt_pk_bf16_f32 v39, v30, v31
  v_mfma_f32_16x16x32_bf16 v[24:27], a[128:131], a[80:83], 0
  s_add_u32 m0, s33, 16384
  ds_read_b64_tr_b16 a[176:177], v2 offset:512
  v_fma_f32 v16, v16, s24, v12
  v_smfmac_f32_16x16x64_bf16 v[44:47], a[224:227], v[32:39], v7
  buffer_load_dwordx4 v4, s[4:7], s21 offen offset:1024 nt lds
  v_mfma_f32_16x16x32_bf16 v[24:27], a[132:135], a[84:87], v[24:27]
  v_exp_f32 v16, v16
  v_mfma_f32_16x16x32_bf16 v[24:27], a[136:139], a[88:91], v[24:27]
  ds_read_b64_tr_b16 a[178:179], v2 offset:8704
  v_fma_f32 v17, v17, s24, v12
  v_mfma_f32_16x16x32_bf16 v[24:27], a[140:143], a[92:95], v[24:27]
  v_exp_f32 v17, v17
  v_mfma_f32_16x16x32_bf16 v[28:31], a[156:159], a[92:95], 0
  ds_read_b64_tr_b16 a[180:181], v2 offset:520
  v_fma_f32 v18, v18, s24, v12
  v_mfma_f32_16x16x32_bf16 v[28:31], a[152:155], a[88:91], v[28:31]
  v_exp_f32 v18, v18
  v_mfma_f32_16x16x32_bf16 v[28:31], a[148:151], a[84:87], v[28:31]
  ds_read_b64_tr_b16 a[182:183], v2 offset:8712
  v_fma_f32 v19, v19, s24, v12
  v_mfma_f32_16x16x32_bf16 v[28:31], a[144:147], a[80:83], v[28:31]
  v_exp_f32 v19, v19
  v_mfma_f32_16x16x32_bf16 v[160:163], a[192:195], v[36:39], v[160:163]
  v_fma_f32 v20, v20, s24, v12
  v_cvt_pk_bf16_f32 v32, v16, v17
  v_mfma_f32_16x16x32_bf16 v[164:167], a[196:199], v[36:39], v[164:167]
  v_exp_f32 v20, v20
  v_mfma_f32_16x16x32_bf16 v[168:171], a[200:203], v[36:39], v[168:171]
  v_fma_f32 v21, v21, s24, v12
  v_cvt_pk_bf16_f32 v33, v18, v19
  v_mfma_f32_16x16x32_bf16 v[172:175], a[204:207], v[36:39], v[172:175]
  v_exp_f32 v21, v21
  v_mfma_f32_16x16x32_bf16 v[176:179], a[208:211], v[36:39], v[176:179]
  v_fma_f32 v22, v22, s24, v12
  v_fma_f32 v23, v23, s24, v12
  v_mfma_f32_16x16x32_bf16 v[180:183], a[212:215], v[36:39], v[180:183]
  v_exp_f32 v22, v22
  v_mfma_f32_16x16x32_bf16 v[184:187], a[216:219], v[36:39], v[184:187]
  v_exp_f32 v23, v23
  v_mfma_f32_16x16x32_bf16 v[188:191], a[220:223], v[36:39], v[188:191]
  s_waitcnt lgkmcnt(12)
  v_cvt_pk_bf16_f32 v34, v20, v21
  v_cvt_pk_bf16_f32 v35, v22, v23
  v_mfma_f32_16x16x32_bf16 v[16:19], a[96:99], a[0:3], 0
  ds_read_b64_tr_b16 a[184:185], v2 offset:768
  v_fma_f32 v24, v24, s24, v13
  v_mfma_f32_16x16x32_bf16 v[16:19], a[100:103], a[4:7], v[16:19]
  v_exp_f32 v24, v24
  v_mfma_f32_16x16x32_bf16 v[16:19], a[104:107], a[8:11], v[16:19]
  ds_read_b64_tr_b16 a[186:187], v2 offset:8960
  v_fma_f32 v25, v25, s24, v13
  v_mfma_f32_16x16x32_bf16 v[16:19], a[108:111], a[12:15], v[16:19]
  s_mov_b32 s22, s23
  v_exp_f32 v25, v25
  v_mfma_f32_16x16x32_bf16 v[20:23], a[124:127], a[12:15], 0
  ds_read_b64_tr_b16 a[188:189], v2 offset:776
  v_fma_f32 v26, v26, s24, v13
  v_mfma_f32_16x16x32_bf16 v[20:23], a[120:123], a[8:11], v[20:23]
  s_add_u32 s23, s23, 25165824
  v_exp_f32 v26, v26
  v_mfma_f32_16x16x32_bf16 v[20:23], a[116:119], a[4:7], v[20:23]
  ds_read_b64_tr_b16 a[190:191], v2 offset:8968
  v_fma_f32 v27, v27, s24, v13
  v_mfma_f32_16x16x32_bf16 v[20:23], a[112:115], a[0:3], v[20:23]
  v_exp_f32 v27, v27
  v_mfma_f32_16x16x32_bf16 v[192:195], a[192:195], v[32:35], v[192:195]
  v_fma_f32 v28, v28, s24, v13
  v_cvt_pk_bf16_f32 v36, v24, v25
  v_mfma_f32_16x16x32_bf16 v[196:199], a[196:199], v[32:35], v[196:199]
  v_exp_f32 v28, v28
  v_mfma_f32_16x16x32_bf16 v[200:203], a[200:203], v[32:35], v[200:203]
  v_fma_f32 v29, v29, s24, v13
  v_cvt_pk_bf16_f32 v37, v26, v27
  v_mfma_f32_16x16x32_bf16 v[204:207], a[204:207], v[32:35], v[204:207]
  v_exp_f32 v29, v29
  v_mfma_f32_16x16x32_bf16 v[208:211], a[208:211], v[32:35], v[208:211]
  s_add_u32 s20, s20, 16654336
  v_fma_f32 v30, v30, s24, v13
  v_fma_f32 v31, v31, s24, v13
  v_mfma_f32_16x16x32_bf16 v[212:215], a[212:215], v[32:35], v[212:215]
  v_exp_f32 v30, v30
  v_mfma_f32_16x16x32_bf16 v[216:219], a[216:219], v[32:35], v[216:219]
  v_exp_f32 v31, v31
  v_mfma_f32_16x16x32_bf16 v[220:223], a[220:223], v[32:35], v[220:223]
  s_waitcnt vmcnt(15) lgkmcnt(0)
  v_cvt_pk_bf16_f32 v38, v28, v29
  v_cvt_pk_bf16_f32 v39, v30, v31
  v_mfma_f32_16x16x32_bf16 v[24:27], a[96:99], a[16:19], 0
  s_barrier
  ds_read_b128 a[128:131], v1 offset:18432
  v_fma_f32 v16, v16, s24, v8
  v_smfmac_f32_16x16x64_bf16 v[48:51], a[224:227], v[32:39], v7
  buffer_load_dwordx4 v4, s[4:7], s21 offen offset:2048 nt lds
  v_mfma_f32_16x16x32_bf16 v[24:27], a[100:103], a[20:23], v[24:27]
  v_exp_f32 v16, v16
  v_mfma_f32_16x16x32_bf16 v[24:27], a[104:107], a[24:27], v[24:27]
  ds_read_b128 a[132:135], v1 offset:18688
  v_fma_f32 v17, v17, s24, v8
  v_mfma_f32_16x16x32_bf16 v[24:27], a[108:111], a[28:31], v[24:27]
  v_exp_f32 v17, v17
  v_mfma_f32_16x16x32_bf16 v[28:31], a[124:127], a[28:31], 0
  ds_read_b128 a[136:139], v1 offset:18944
  v_fma_f32 v18, v18, s24, v8
  v_mfma_f32_16x16x32_bf16 v[28:31], a[120:123], a[24:27], v[28:31]
  v_exp_f32 v18, v18
  v_mfma_f32_16x16x32_bf16 v[28:31], a[116:119], a[20:23], v[28:31]
  ds_read_b128 a[140:143], v1 offset:19200
  v_fma_f32 v19, v19, s24, v8
  v_mfma_f32_16x16x32_bf16 v[28:31], a[112:115], a[16:19], v[28:31]
  v_exp_f32 v19, v19
  v_mfma_f32_16x16x32_bf16 v[224:227], a[192:195], v[36:39], v[224:227]
  v_fma_f32 v20, v20, s24, v8
  v_cvt_pk_bf16_f32 v32, v16, v17
  v_mfma_f32_16x16x32_bf16 v[228:231], a[196:199], v[36:39], v[228:231]
  v_exp_f32 v20, v20
  v_mfma_f32_16x16x32_bf16 v[232:235], a[200:203], v[36:39], v[232:235]
  s_mov_b32 m0, s32
  v_fma_f32 v21, v21, s24, v8
  v_cvt_pk_bf16_f32 v33, v18, v19
  v_mfma_f32_16x16x32_bf16 v[236:239], a[204:207], v[36:39], v[236:239]
  buffer_load_dwordx4 v5, s[8:11], s20 offen offset:2048 lds
  v_exp_f32 v21, v21
  v_mfma_f32_16x16x32_bf16 v[240:243], a[208:211], v[36:39], v[240:243]
  v_fma_f32 v22, v22, s24, v8
  v_fma_f32 v23, v23, s24, v8
  v_mfma_f32_16x16x32_bf16 v[244:247], a[212:215], v[36:39], v[244:247]
  v_exp_f32 v22, v22
  v_mfma_f32_16x16x32_bf16 v[248:251], a[216:219], v[36:39], v[248:251]
  v_exp_f32 v23, v23
  v_mfma_f32_16x16x32_bf16 v[252:255], a[220:223], v[36:39], v[252:255]
  v_cvt_pk_bf16_f32 v34, v20, v21
  v_cvt_pk_bf16_f32 v35, v22, v23
  v_mfma_f32_16x16x32_bf16 v[16:19], a[96:99], a[32:35], 0
  ds_read_b128 a[144:147], v1 offset:26624
  v_fma_f32 v24, v24, s24, v9
  v_mfma_f32_16x16x32_bf16 v[16:19], a[100:103], a[36:39], v[16:19]
  v_exp_f32 v24, v24
  v_mfma_f32_16x16x32_bf16 v[16:19], a[104:107], a[40:43], v[16:19]
  ds_read_b128 a[148:151], v1 offset:26880
  v_fma_f32 v25, v25, s24, v9
  v_mfma_f32_16x16x32_bf16 v[16:19], a[108:111], a[44:47], v[16:19]
  buffer_load_dwordx4 v5, s[8:11], s20 offen offset:3072 lds
  v_exp_f32 v25, v25
  v_mfma_f32_16x16x32_bf16 v[20:23], a[124:127], a[44:47], 0
  ds_read_b128 a[152:155], v1 offset:27136
  v_fma_f32 v26, v26, s24, v9
  v_mfma_f32_16x16x32_bf16 v[20:23], a[120:123], a[40:43], v[20:23]
  v_exp_f32 v26, v26
  v_mfma_f32_16x16x32_bf16 v[20:23], a[116:119], a[36:39], v[20:23]
  ds_read_b128 a[156:159], v1 offset:27392
  v_fma_f32 v27, v27, s24, v9
  v_mfma_f32_16x16x32_bf16 v[20:23], a[112:115], a[32:35], v[20:23]
  v_exp_f32 v27, v27
  v_mfma_f32_16x16x32_bf16 v[64:67], a[160:163], v[32:35], v[64:67]
  v_fma_f32 v28, v28, s24, v9
  v_cvt_pk_bf16_f32 v36, v24, v25
  v_mfma_f32_16x16x32_bf16 v[68:71], a[164:167], v[32:35], v[68:71]
  v_exp_f32 v28, v28
  v_mfma_f32_16x16x32_bf16 v[72:75], a[168:171], v[32:35], v[72:75]
  v_fma_f32 v29, v29, s24, v9
  v_cvt_pk_bf16_f32 v37, v26, v27
  v_mfma_f32_16x16x32_bf16 v[76:79], a[172:175], v[32:35], v[76:79]
  v_exp_f32 v29, v29
  v_mfma_f32_16x16x32_bf16 v[80:83], a[176:179], v[32:35], v[80:83]
  v_fma_f32 v30, v30, s24, v9
  v_fma_f32 v31, v31, s24, v9
  v_mfma_f32_16x16x32_bf16 v[84:87], a[180:183], v[32:35], v[84:87]
  v_exp_f32 v30, v30
  v_mfma_f32_16x16x32_bf16 v[88:91], a[184:187], v[32:35], v[88:91]
  v_exp_f32 v31, v31
  v_mfma_f32_16x16x32_bf16 v[92:95], a[188:191], v[32:35], v[92:95]
  v_cvt_pk_bf16_f32 v38, v28, v29
  v_cvt_pk_bf16_f32 v39, v30, v31
  v_mfma_f32_16x16x32_bf16 v[24:27], a[96:99], a[48:51], 0
  s_add_u32 m0, s33, 16384
  ds_read_b64_tr_b16 a[192:193], v2 offset:16384
  v_fma_f32 v16, v16, s24, v10
  v_smfmac_f32_16x16x64_bf16 v[40:43], a[224:227], v[32:39], v7
  buffer_load_dwordx4 v4, s[4:7], s21 offen offset:3072 nt lds
  v_mfma_f32_16x16x32_bf16 v[24:27], a[100:103], a[52:55], v[24:27]
  v_exp_f32 v16, v16
  v_mfma_f32_16x16x32_bf16 v[24:27], a[104:107], a[56:59], v[24:27]
  ds_read_b64_tr_b16 a[194:195], v2 offset:24576
  v_fma_f32 v17, v17, s24, v10
  v_mfma_f32_16x16x32_bf16 v[24:27], a[108:111], a[60:63], v[24:27]
  v_exp_f32 v17, v17
  v_mfma_f32_16x16x32_bf16 v[28:31], a[124:127], a[60:63], 0
  ds_read_b64_tr_b16 a[196:197], v2 offset:16392
  v_fma_f32 v18, v18, s24, v10
  v_mfma_f32_16x16x32_bf16 v[28:31], a[120:123], a[56:59], v[28:31]
  v_exp_f32 v18, v18
  v_mfma_f32_16x16x32_bf16 v[28:31], a[116:119], a[52:55], v[28:31]
  ds_read_b64_tr_b16 a[198:199], v2 offset:24584
  v_fma_f32 v19, v19, s24, v10
  v_mfma_f32_16x16x32_bf16 v[28:31], a[112:115], a[48:51], v[28:31]
  v_exp_f32 v19, v19
  v_mfma_f32_16x16x32_bf16 v[96:99], a[160:163], v[36:39], v[96:99]
  v_fma_f32 v20, v20, s24, v10
  v_cvt_pk_bf16_f32 v32, v16, v17
  v_mfma_f32_16x16x32_bf16 v[100:103], a[164:167], v[36:39], v[100:103]
  v_exp_f32 v20, v20
  v_mfma_f32_16x16x32_bf16 v[104:107], a[168:171], v[36:39], v[104:107]
  s_mov_b32 m0, s32
  v_fma_f32 v21, v21, s24, v10
  v_cvt_pk_bf16_f32 v33, v18, v19
  v_mfma_f32_16x16x32_bf16 v[108:111], a[172:175], v[36:39], v[108:111]
  buffer_load_dwordx4 v4, s[12:15], s20 offen lds
  v_exp_f32 v21, v21
  v_mfma_f32_16x16x32_bf16 v[112:115], a[176:179], v[36:39], v[112:115]
  s_add_u32 s21, s21, 4096
  v_fma_f32 v22, v22, s24, v10
  v_fma_f32 v23, v23, s24, v10
  v_mfma_f32_16x16x32_bf16 v[116:119], a[180:183], v[36:39], v[116:119]
  v_exp_f32 v22, v22
  v_mfma_f32_16x16x32_bf16 v[120:123], a[184:187], v[36:39], v[120:123]
  v_exp_f32 v23, v23
  v_mfma_f32_16x16x32_bf16 v[124:127], a[188:191], v[36:39], v[124:127]
  v_cvt_pk_bf16_f32 v34, v20, v21
  v_cvt_pk_bf16_f32 v35, v22, v23
  v_mfma_f32_16x16x32_bf16 v[16:19], a[96:99], a[64:67], 0
  ds_read_b64_tr_b16 a[200:201], v2 offset:16640
  v_fma_f32 v24, v24, s24, v11
  v_mfma_f32_16x16x32_bf16 v[16:19], a[100:103], a[68:71], v[16:19]
  v_exp_f32 v24, v24
  v_mfma_f32_16x16x32_bf16 v[16:19], a[104:107], a[72:75], v[16:19]
  ds_read_b64_tr_b16 a[202:203], v2 offset:24832
  v_fma_f32 v25, v25, s24, v11
  v_mfma_f32_16x16x32_bf16 v[16:19], a[108:111], a[76:79], v[16:19]
  buffer_load_dwordx4 v4, s[12:15], s20 offen offset:1024 lds
  v_exp_f32 v25, v25
  v_mfma_f32_16x16x32_bf16 v[20:23], a[124:127], a[76:79], 0
L_pad7:
  s_cbranch_execz L_pad8
  ds_read_b64_tr_b16 a[204:205], v2 offset:16648
  v_fma_f32 v26, v26, s24, v11
  v_mfma_f32_16x16x32_bf16 v[20:23], a[120:123], a[72:75], v[20:23]
  v_exp_f32 v26, v26
  v_mfma_f32_16x16x32_bf16 v[20:23], a[116:119], a[68:71], v[20:23]
  ds_read_b64_tr_b16 a[206:207], v2 offset:24840
  v_fma_f32 v27, v27, s24, v11
  v_mfma_f32_16x16x32_bf16 v[20:23], a[112:115], a[64:67], v[20:23]
  v_exp_f32 v27, v27
  v_mfma_f32_16x16x32_bf16 v[128:131], a[160:163], v[32:35], v[128:131]
  v_fma_f32 v28, v28, s24, v11
  v_cvt_pk_bf16_f32 v36, v24, v25
  v_mfma_f32_16x16x32_bf16 v[132:135], a[164:167], v[32:35], v[132:135]
  v_exp_f32 v28, v28
  v_mfma_f32_16x16x32_bf16 v[136:139], a[168:171], v[32:35], v[136:139]
  v_fma_f32 v29, v29, s24, v11
  v_cvt_pk_bf16_f32 v37, v26, v27
  v_mfma_f32_16x16x32_bf16 v[140:143], a[172:175], v[32:35], v[140:143]
  v_exp_f32 v29, v29
  v_mfma_f32_16x16x32_bf16 v[144:147], a[176:179], v[32:35], v[144:147]
  v_fma_f32 v30, v30, s24, v11
  v_fma_f32 v31, v31, s24, v11
  v_mfma_f32_16x16x32_bf16 v[148:151], a[180:183], v[32:35], v[148:151]
  v_exp_f32 v30, v30
  v_mfma_f32_16x16x32_bf16 v[152:155], a[184:187], v[32:35], v[152:155]
  v_exp_f32 v31, v31
  v_mfma_f32_16x16x32_bf16 v[156:159], a[188:191], v[32:35], v[156:159]
  v_cvt_pk_bf16_f32 v38, v28, v29
  v_cvt_pk_bf16_f32 v39, v30, v31
  v_mfma_f32_16x16x32_bf16 v[24:27], a[96:99], a[80:83], 0
  s_add_u32 m0, s33, 20480
  ds_read_b64_tr_b16 a[208:209], v2 offset:16896
  v_fma_f32 v16, v16, s24, v12
  v_smfmac_f32_16x16x64_bf16 v[44:47], a[224:227], v[32:39], v7
  buffer_load_dwordx4 v4, s[4:7], s21 offen nt lds
  v_mfma_f32_16x16x32_bf16 v[24:27], a[100:103], a[84:87], v[24:27]
  v_exp_f32 v16, v16
  v_mfma_f32_16x16x32_bf16 v[24:27], a[104:107], a[88:91], v[24:27]
  ds_read_b64_tr_b16 a[210:211], v2 offset:25088
  v_fma_f32 v17, v17, s24, v12
  v_mfma_f32_16x16x32_bf16 v[24:27], a[108:111], a[92:95], v[24:27]
  v_exp_f32 v17, v17
  v_mfma_f32_16x16x32_bf16 v[28:31], a[124:127], a[92:95], 0
  ds_read_b64_tr_b16 a[212:213], v2 offset:16904
  v_fma_f32 v18, v18, s24, v12
  v_mfma_f32_16x16x32_bf16 v[28:31], a[120:123], a[88:91], v[28:31]
  v_exp_f32 v18, v18
  v_mfma_f32_16x16x32_bf16 v[28:31], a[116:119], a[84:87], v[28:31]
  ds_read_b64_tr_b16 a[214:215], v2 offset:25096
  v_fma_f32 v19, v19, s24, v12
  v_mfma_f32_16x16x32_bf16 v[28:31], a[112:115], a[80:83], v[28:31]
  v_exp_f32 v19, v19
  v_mfma_f32_16x16x32_bf16 v[160:163], a[160:163], v[36:39], v[160:163]
  v_fma_f32 v20, v20, s24, v12
  v_cvt_pk_bf16_f32 v32, v16, v17
  v_mfma_f32_16x16x32_bf16 v[164:167], a[164:167], v[36:39], v[164:167]
  v_exp_f32 v20, v20
  v_mfma_f32_16x16x32_bf16 v[168:171], a[168:171], v[36:39], v[168:171]
  v_fma_f32 v21, v21, s24, v12
  v_cvt_pk_bf16_f32 v33, v18, v19
  v_mfma_f32_16x16x32_bf16 v[172:175], a[172:175], v[36:39], v[172:175]
  v_exp_f32 v21, v21
  v_mfma_f32_16x16x32_bf16 v[176:179], a[176:179], v[36:39], v[176:179]
  v_fma_f32 v22, v22, s24, v12
  v_fma_f32 v23, v23, s24, v12
  v_mfma_f32_16x16x32_bf16 v[180:183], a[180:183], v[36:39], v[180:183]
  v_exp_f32 v22, v22
  v_mfma_f32_16x16x32_bf16 v[184:187], a[184:187], v[36:39], v[184:187]
  v_exp_f32 v23, v23
  v_mfma_f32_16x16x32_bf16 v[188:191], a[188:191], v[36:39], v[188:191]
  s_waitcnt lgkmcnt(12)
  v_cvt_pk_bf16_f32 v34, v20, v21
  v_cvt_pk_bf16_f32 v35, v22, v23
  v_mfma_f32_16x16x32_bf16 v[16:19], a[128:131], a[0:3], 0
  ds_read_b64_tr_b16 a[216:217], v2 offset:17152
  v_fma_f32 v24, v24, s24, v13
  v_mfma_f32_16x16x32_bf16 v[16:19], a[132:135], a[4:7], v[16:19]
  v_exp_f32 v24, v24
  v_mfma_f32_16x16x32_bf16 v[16:19], a[136:139], a[8:11], v[16:19]
  ds_read_b64_tr_b16 a[218:219], v2 offset:25344
  v_fma_f32 v25, v25, s24, v13
  v_mfma_f32_16x16x32_bf16 v[16:19], a[140:143], a[12:15], v[16:19]
  v_exp_f32 v25, v25
  v_mfma_f32_16x16x32_bf16 v[20:23], a[156:159], a[12:15], 0
  ds_read_b64_tr_b16 a[220:221], v2 offset:17160
  v_fma_f32 v26, v26, s24, v13
  v_mfma_f32_16x16x32_bf16 v[20:23], a[152:155], a[8:11], v[20:23]
  v_exp_f32 v26, v26
  v_mfma_f32_16x16x32_bf16 v[20:23], a[148:151], a[4:7], v[20:23]
  ds_read_b64_tr_b16 a[222:223], v2 offset:25352
  v_fma_f32 v27, v27, s24, v13
  v_mfma_f32_16x16x32_bf16 v[20:23], a[144:147], a[0:3], v[20:23]
  v_exp_f32 v27, v27
  v_mfma_f32_16x16x32_bf16 v[192:195], a[160:163], v[32:35], v[192:195]
  v_fma_f32 v28, v28, s24, v13
  v_cvt_pk_bf16_f32 v36, v24, v25
  v_mfma_f32_16x16x32_bf16 v[196:199], a[164:167], v[32:35], v[196:199]
  v_exp_f32 v28, v28
  v_mfma_f32_16x16x32_bf16 v[200:203], a[168:171], v[32:35], v[200:203]
  v_fma_f32 v29, v29, s24, v13
  v_cvt_pk_bf16_f32 v37, v26, v27
  v_mfma_f32_16x16x32_bf16 v[204:207], a[172:175], v[32:35], v[204:207]
  v_exp_f32 v29, v29
  v_mfma_f32_16x16x32_bf16 v[208:211], a[176:179], v[32:35], v[208:211]
  s_add_u32 s20, s20, 8192
  v_fma_f32 v30, v30, s24, v13
  v_fma_f32 v31, v31, s24, v13
  v_mfma_f32_16x16x32_bf16 v[212:215], a[180:183], v[32:35], v[212:215]
  v_exp_f32 v30, v30
  v_mfma_f32_16x16x32_bf16 v[216:219], a[184:187], v[32:35], v[216:219]
  s_cmp_eq_u32 s27, 3
  v_exp_f32 v31, v31
  v_mfma_f32_16x16x32_bf16 v[220:223], a[188:191], v[32:35], v[220:223]
  s_waitcnt vmcnt(15) lgkmcnt(0)
  v_cvt_pk_bf16_f32 v38, v28, v29
  v_cvt_pk_bf16_f32 v39, v30, v31
  s_cbranch_scc1 L_tail
  v_mfma_f32_16x16x32_bf16 v[24:27], a[128:131], a[16:19], 0
  s_barrier
  ds_read_b128 a[96:99], v1 offset:34816
  v_fma_f32 v16, v16, s24, v8
  v_smfmac_f32_16x16x64_bf16 v[48:51], a[224:227], v[32:39], v7
  buffer_load_dwordx4 v4, s[4:7], s21 offen offset:1024 nt lds
  v_mfma_f32_16x16x32_bf16 v[24:27], a[132:135], a[20:23], v[24:27]
  v_exp_f32 v16, v16
  v_mfma_f32_16x16x32_bf16 v[24:27], a[136:139], a[24:27], v[24:27]
  ds_read_b128 a[100:103], v1 offset:35072
  v_fma_f32 v17, v17, s24, v8
  v_mfma_f32_16x16x32_bf16 v[24:27], a[140:143], a[28:31], v[24:27]
  v_exp_f32 v17, v17
  v_mfma_f32_16x16x32_bf16 v[28:31], a[156:159], a[28:31], 0
  ds_read_b128 a[104:107], v1 offset:35328
  v_fma_f32 v18, v18, s24, v8
  v_mfma_f32_16x16x32_bf16 v[28:31], a[152:155], a[24:27], v[28:31]
  v_exp_f32 v18, v18
  v_mfma_f32_16x16x32_bf16 v[28:31], a[148:151], a[20:23], v[28:31]
  ds_read_b128 a[108:111], v1 offset:35584
  v_fma_f32 v19, v19, s24, v8
  v_mfma_f32_16x16x32_bf16 v[28:31], a[144:147], a[16:19], v[28:31]
  v_exp_f32 v19, v19
  v_mfma_f32_16x16x32_bf16 v[224:227], a[160:163], v[36:39], v[224:227]
  v_fma_f32 v20, v20, s24, v8
  v_cvt_pk_bf16_f32 v32, v16, v17
  v_mfma_f32_16x16x32_bf16 v[228:231], a[164:167], v[36:39], v[228:231]
  v_exp_f32 v20, v20
  v_mfma_f32_16x16x32_bf16 v[232:235], a[168:171], v[36:39], v[232:235]
  s_add_u32 m0, s32, 16384
  v_fma_f32 v21, v21, s24, v8
  v_cvt_pk_bf16_f32 v33, v18, v19
  v_mfma_f32_16x16x32_bf16 v[236:239], a[172:175], v[36:39], v[236:239]
  buffer_load_dwordx4 v5, s[8:11], s20 offen offset:2048 lds
  v_exp_f32 v21, v21
  v_mfma_f32_16x16x32_bf16 v[240:243], a[176:179], v[36:39], v[240:243]
  v_fma_f32 v22, v22, s24, v8
  v_fma_f32 v23, v23, s24, v8
  v_mfma_f32_16x16x32_bf16 v[244:247], a[180:183], v[36:39], v[244:247]
  v_exp_f32 v22, v22
  v_mfma_f32_16x16x32_bf16 v[248:251], a[184:187], v[36:39], v[248:251]
  v_exp_f32 v23, v23
  v_mfma_f32_16x16x32_bf16 v[252:255], a[188:191], v[36:39], v[252:255]
  v_cvt_pk_bf16_f32 v34, v20, v21
  v_cvt_pk_bf16_f32 v35, v22, v23
  v_mfma_f32_16x16x32_bf16 v[16:19], a[128:131], a[32:35], 0
  ds_read_b128 a[112:115], v1 offset:43008
  v_fma_f32 v24, v24, s24, v9
  v_mfma_f32_16x16x32_bf16 v[16:19], a[132:135], a[36:39], v[16:19]
  v_exp_f32 v24, v24
  v_mfma_f32_16x16x32_bf16 v[16:19], a[136:139], a[40:43], v[16:19]
  ds_read_b128 a[116:119], v1 offset:43264
  v_fma_f32 v25, v25, s24, v9
  v_mfma_f32_16x16x32_bf16 v[16:19], a[140:143], a[44:47], v[16:19]
  buffer_load_dwordx4 v5, s[8:11], s20 offen offset:3072 lds
  v_exp_f32 v25, v25
  v_mfma_f32_16x16x32_bf16 v[20:23], a[156:159], a[44:47], 0
  ds_read_b128 a[120:123], v1 offset:43520
  v_fma_f32 v26, v26, s24, v9
  v_mfma_f32_16x16x32_bf16 v[20:23], a[152:155], a[40:43], v[20:23]
  v_exp_f32 v26, v26
  v_mfma_f32_16x16x32_bf16 v[20:23], a[148:151], a[36:39], v[20:23]
  ds_read_b128 a[124:127], v1 offset:43776
  v_fma_f32 v27, v27, s24, v9
  v_mfma_f32_16x16x32_bf16 v[20:23], a[144:147], a[32:35], v[20:23]
  v_exp_f32 v27, v27
  v_mfma_f32_16x16x32_bf16 v[64:67], a[192:195], v[32:35], v[64:67]
  v_fma_f32 v28, v28, s24, v9
  v_cvt_pk_bf16_f32 v36, v24, v25
  v_mfma_f32_16x16x32_bf16 v[68:71], a[196:199], v[32:35], v[68:71]
  v_exp_f32 v28, v28
  v_mfma_f32_16x16x32_bf16 v[72:75], a[200:203], v[32:35], v[72:75]
  v_fma_f32 v29, v29, s24, v9
  v_cvt_pk_bf16_f32 v37, v26, v27
  v_mfma_f32_16x16x32_bf16 v[76:79], a[204:207], v[32:35], v[76:79]
  v_exp_f32 v29, v29
  v_mfma_f32_16x16x32_bf16 v[80:83], a[208:211], v[32:35], v[80:83]
  v_fma_f32 v30, v30, s24, v9
  v_fma_f32 v31, v31, s24, v9
  v_mfma_f32_16x16x32_bf16 v[84:87], a[212:215], v[32:35], v[84:87]
  v_exp_f32 v30, v30
  v_mfma_f32_16x16x32_bf16 v[88:91], a[216:219], v[32:35], v[88:91]
  v_exp_f32 v31, v31
  v_mfma_f32_16x16x32_bf16 v[92:95], a[220:223], v[32:35], v[92:95]
  v_cvt_pk_bf16_f32 v38, v28, v29
  v_cvt_pk_bf16_f32 v39, v30, v31
  v_mfma_f32_16x16x32_bf16 v[24:27], a[128:131], a[48:51], 0
  s_add_u32 m0, s33, 20480
  ds_read_b64_tr_b16 a[160:161], v2 offset:32768
  v_fma_f32 v16, v16, s24, v10
  v_smfmac_f32_16x16x64_bf16 v[40:43], a[224:227], v[32:39], v7
  buffer_load_dwordx4 v4, s[4:7], s21 offen offset:2048 nt lds
  v_mfma_f32_16x16x32_bf16 v[24:27], a[132:135], a[52:55], v[24:27]
  v_exp_f32 v16, v16
  v_mfma_f32_16x16x32_bf16 v[24:27], a[136:139], a[56:59], v[24:27]
  ds_read_b64_tr_b16 a[162:163], v2 offset:40960
  v_fma_f32 v17, v17, s24, v10
  v_mfma_f32_16x16x32_bf16 v[24:27], a[140:143], a[60:63], v[24:27]
  v_exp_f32 v17, v17
  v_mfma_f32_16x16x32_bf16 v[28:31], a[156:159], a[60:63], 0
  ds_read_b64_tr_b16 a[164:165], v2 offset:32776
  v_fma_f32 v18, v18, s24, v10
  v_mfma_f32_16x16x32_bf16 v[28:31], a[152:155], a[56:59], v[28:31]
  v_exp_f32 v18, v18
  v_mfma_f32_16x16x32_bf16 v[28:31], a[148:151], a[52:55], v[28:31]
  ds_read_b64_tr_b16 a[166:167], v2 offset:40968
  v_fma_f32 v19, v19, s24, v10
  v_mfma_f32_16x16x32_bf16 v[28:31], a[144:147], a[48:51], v[28:31]
  v_exp_f32 v19, v19
  v_mfma_f32_16x16x32_bf16 v[96:99], a[192:195], v[36:39], v[96:99]
  v_fma_f32 v20, v20, s24, v10
  v_cvt_pk_bf16_f32 v32, v16, v17
  v_mfma_f32_16x16x32_bf16 v[100:103], a[196:199], v[36:39], v[100:103]
  v_exp_f32 v20, v20
  v_mfma_f32_16x16x32_bf16 v[104:107], a[200:203], v[36:39], v[104:107]
  s_add_u32 m0, s32, 16384
  v_fma_f32 v21, v21, s24, v10
  v_cvt_pk_bf16_f32 v33, v18, v19
  v_mfma_f32_16x16x32_bf16 v[108:111], a[204:207], v[36:39], v[108:111]
  buffer_load_dwordx4 v4, s[12:15], s20 offen lds
  v_exp_f32 v21, v21
  v_mfma_f32_16x16x32_bf16 v[112:115], a[208:211], v[36:39], v[112:115]
  v_fma_f32 v22, v22, s24, v10
  v_fma_f32 v23, v23, s24, v10
  v_mfma_f32_16x16x32_bf16 v[116:119], a[212:215], v[36:39], v[116:119]
  v_exp_f32 v22, v22
  v_mfma_f32_16x16x32_bf16 v[120:123], a[216:219], v[36:39], v[120:123]
  v_exp_f32 v23, v23
  v_mfma_f32_16x16x32_bf16 v[124:127], a[220:223], v[36:39], v[124:127]
  v_cvt_pk_bf16_f32 v34, v20, v21
  v_cvt_pk_bf16_f32 v35, v22, v23
  v_mfma_f32_16x16x32_bf16 v[16:19], a[128:131], a[64:67], 0
  ds_read_b64_tr_b16 a[168:169], v2 offset:33024
  v_fma_f32 v24, v24, s24, v11
  v_mfma_f32_16x16x32_bf16 v[16:19], a[132:135], a[68:71], v[16:19]
  v_exp_f32 v24, v24
  v_mfma_f32_16x16x32_bf16 v[16:19], a[136:139], a[72:75], v[16:19]
  ds_read_b64_tr_b16 a[170:171], v2 offset:41216
  v_fma_f32 v25, v25, s24, v11
  v_mfma_f32_16x16x32_bf16 v[16:19], a[140:143], a[76:79], v[16:19]
  buffer_load_dwordx4 v4, s[12:15], s20 offen offset:1024 lds
  v_exp_f32 v25, v25
  v_mfma_f32_16x16x32_bf16 v[20:23], a[156:159], a[76:79], 0
  ds_read_b64_tr_b16 a[172:173], v2 offset:33032
  v_fma_f32 v26, v26, s24, v11
  v_mfma_f32_16x16x32_bf16 v[20:23], a[152:155], a[72:75], v[20:23]
  v_exp_f32 v26, v26
  v_mfma_f32_16x16x32_bf16 v[20:23], a[148:151], a[68:71], v[20:23]
  ds_read_b64_tr_b16 a[174:175], v2 offset:41224
  v_fma_f32 v27, v27, s24, v11
  v_mfma_f32_16x16x32_bf16 v[20:23], a[144:147], a[64:67], v[20:23]
  v_exp_f32 v27, v27
  v_mfma_f32_16x16x32_bf16 v[128:131], a[192:195], v[32:35], v[128:131]
  v_fma_f32 v28, v28, s24, v11
  v_cvt_pk_bf16_f32 v36, v24, v25
  v_mfma_f32_16x16x32_bf16 v[132:135], a[196:199], v[32:35], v[132:135]
  v_exp_f32 v28, v28
  v_mfma_f32_16x16x32_bf16 v[136:139], a[200:203], v[32:35], v[136:139]
  v_fma_f32 v29, v29, s24, v11
  v_cvt_pk_bf16_f32 v37, v26, v27
  v_mfma_f32_16x16x32_bf16 v[140:143], a[204:207], v[32:35], v[140:143]
  v_exp_f32 v29, v29
  v_mfma_f32_16x16x32_bf16 v[144:147], a[208:211], v[32:35], v[144:147]
  v_fma_f32 v30, v30, s24, v11
  v_fma_f32 v31, v31, s24, v11
  v_mfma_f32_16x16x32_bf16 v[148:151], a[212:215], v[32:35], v[148:151]
  v_exp_f32 v30, v30
  v_mfma_f32_16x16x32_bf16 v[152:155], a[216:219], v[32:35], v[152:155]
  v_exp_f32 v31, v31
  v_mfma_f32_16x16x32_bf16 v[156:159], a[220:223], v[32:35], v[156:159]
  v_cvt_pk_bf16_f32 v38, v28, v29
  v_cvt_pk_bf16_f32 v39, v30, v31
  v_mfma_f32_16x16x32_bf16 v[24:27], a[128:131], a[80:83], 0
  s_add_u32 m0, s33, 20480
  ds_read_b64_tr_b16 a[176:177], v2 offset:33280
  v_fma_f32 v16, v16, s24, v12
  v_smfmac_f32_16x16x64_bf16 v[44:47], a[224:227], v[32:39], v7
  buffer_load_dwordx4 v4, s[4:7], s21 offen offset:3072 nt lds
  v_mfma_f32_16x16x32_bf16 v[24:27], a[132:135], a[84:87], v[24:27]
  v_exp_f32 v16, v16
  v_mfma_f32_16x16x32_bf16 v[24:27], a[136:139], a[88:91], v[24:27]
  ds_read_b64_tr_b16 a[178:179], v2 offset:41472
  v_fma_f32 v17, v17, s24, v12
  v_mfma_f32_16x16x32_bf16 v[24:27], a[140:143], a[92:95], v[24:27]
  v_exp_f32 v17, v17
  v_mfma_f32_16x16x32_bf16 v[28:31], a[156:159], a[92:95], 0
  ds_read_b64_tr_b16 a[180:181], v2 offset:33288
  v_fma_f32 v18, v18, s24, v12
  v_mfma_f32_16x16x32_bf16 v[28:31], a[152:155], a[88:91], v[28:31]
  v_exp_f32 v18, v18
  v_mfma_f32_16x16x32_bf16 v[28:31], a[148:151], a[84:87], v[28:31]
  ds_read_b64_tr_b16 a[182:183], v2 offset:41480
  v_fma_f32 v19, v19, s24, v12
  v_mfma_f32_16x16x32_bf16 v[28:31], a[144:147], a[80:83], v[28:31]
  v_exp_f32 v19, v19
  v_mfma_f32_16x16x32_bf16 v[160:163], a[192:195], v[36:39], v[160:163]
  v_fma_f32 v20, v20, s24, v12
  v_cvt_pk_bf16_f32 v32, v16, v17
  v_mfma_f32_16x16x32_bf16 v[164:167], a[196:199], v[36:39], v[164:167]
  v_exp_f32 v20, v20
  v_mfma_f32_16x16x32_bf16 v[168:171], a[200:203], v[36:39], v[168:171]
  v_fma_f32 v21, v21, s24, v12
  v_cvt_pk_bf16_f32 v33, v18, v19
  v_mfma_f32_16x16x32_bf16 v[172:175], a[204:207], v[36:39], v[172:175]
  v_exp_f32 v21, v21
  v_mfma_f32_16x16x32_bf16 v[176:179], a[208:211], v[36:39], v[176:179]
  s_add_u32 s21, s21, 25145344
  v_fma_f32 v22, v22, s24, v12
  v_fma_f32 v23, v23, s24, v12
  v_mfma_f32_16x16x32_bf16 v[180:183], a[212:215], v[36:39], v[180:183]
  v_exp_f32 v22, v22
  v_mfma_f32_16x16x32_bf16 v[184:187], a[216:219], v[36:39], v[184:187]
  v_exp_f32 v23, v23
  v_mfma_f32_16x16x32_bf16 v[188:191], a[220:223], v[36:39], v[188:191]
  s_waitcnt lgkmcnt(12)
  v_cvt_pk_bf16_f32 v34, v20, v21
  v_cvt_pk_bf16_f32 v35, v22, v23
  v_mfma_f32_16x16x32_bf16 v[16:19], a[96:99], a[0:3], 0
  ds_read_b64_tr_b16 a[184:185], v2 offset:33536
  v_fma_f32 v24, v24, s24, v13
  v_mfma_f32_16x16x32_bf16 v[16:19], a[100:103], a[4:7], v[16:19]
  v_exp_f32 v24, v24
  v_mfma_f32_16x16x32_bf16 v[16:19], a[104:107], a[8:11], v[16:19]
  ds_read_b64_tr_b16 a[186:187], v2 offset:41728
  v_fma_f32 v25, v25, s24, v13
  v_mfma_f32_16x16x32_bf16 v[16:19], a[108:111], a[12:15], v[16:19]
  v_exp_f32 v25, v25
  v_mfma_f32_16x16x32_bf16 v[20:23], a[124:127], a[12:15], 0
  ds_read_b64_tr_b16 a[188:189], v2 offset:33544
  v_fma_f32 v26, v26, s24, v13
  v_mfma_f32_16x16x32_bf16 v[20:23], a[120:123], a[8:11], v[20:23]
  v_exp_f32 v26, v26
  v_mfma_f32_16x16x32_bf16 v[20:23], a[116:119], a[4:7], v[20:23]
  ds_read_b64_tr_b16 a[190:191], v2 offset:41736
  v_fma_f32 v27, v27, s24, v13
  v_mfma_f32_16x16x32_bf16 v[20:23], a[112:115], a[0:3], v[20:23]
  v_exp_f32 v27, v27
  v_mfma_f32_16x16x32_bf16 v[192:195], a[192:195], v[32:35], v[192:195]
  v_fma_f32 v28, v28, s24, v13
  v_cvt_pk_bf16_f32 v36, v24, v25
  v_mfma_f32_16x16x32_bf16 v[196:199], a[196:199], v[32:35], v[196:199]
  v_exp_f32 v28, v28
  v_mfma_f32_16x16x32_bf16 v[200:203], a[200:203], v[32:35], v[200:203]
  v_fma_f32 v29, v29, s24, v13
  v_cvt_pk_bf16_f32 v37, v26, v27
  v_mfma_f32_16x16x32_bf16 v[204:207], a[204:207], v[32:35], v[204:207]
  v_exp_f32 v29, v29
  v_mfma_f32_16x16x32_bf16 v[208:211], a[208:211], v[32:35], v[208:211]
  s_add_u32 s20, s20, 8192
  v_fma_f32 v30, v30, s24, v13
  v_fma_f32 v31, v31, s24, v13
  v_mfma_f32_16x16x32_bf16 v[212:215], a[212:215], v[32:35], v[212:215]
  v_exp_f32 v30, v30
  v_mfma_f32_16x16x32_bf16 v[216:219], a[216:219], v[32:35], v[216:219]
  s_add_u32 m0, s32, 32768
  v_exp_f32 v31, v31
  v_mfma_f32_16x16x32_bf16 v[220:223], a[220:223], v[32:35], v[220:223]
  s_waitcnt vmcnt(15) lgkmcnt(0)
  v_cvt_pk_bf16_f32 v38, v28, v29
  v_cvt_pk_bf16_f32 v39, v30, v31
  v_mfma_f32_16x16x32_bf16 v[24:27], a[96:99], a[16:19], 0
  s_barrier
  ds_read_b128 a[128:131], v1 offset:51200
  v_fma_f32 v16, v16, s24, v8
  v_smfmac_f32_16x16x64_bf16 v[48:51], a[224:227], v[32:39], v7
  buffer_load_dwordx4 v5, s[8:11], s20 offen offset:2048 lds
  v_mfma_f32_16x16x32_bf16 v[24:27], a[100:103], a[20:23], v[24:27]
  v_exp_f32 v16, v16
  v_mfma_f32_16x16x32_bf16 v[24:27], a[104:107], a[24:27], v[24:27]
  ds_read_b128 a[132:135], v1 offset:51456
  v_fma_f32 v17, v17, s24, v8
  v_mfma_f32_16x16x32_bf16 v[24:27], a[108:111], a[28:31], v[24:27]
  v_exp_f32 v17, v17
  v_mfma_f32_16x16x32_bf16 v[28:31], a[124:127], a[28:31], 0
  ds_read_b128 a[136:139], v1 offset:51712
  v_fma_f32 v18, v18, s24, v8
  v_mfma_f32_16x16x32_bf16 v[28:31], a[120:123], a[24:27], v[28:31]
  v_exp_f32 v18, v18
  v_mfma_f32_16x16x32_bf16 v[28:31], a[116:119], a[20:23], v[28:31]
  ds_read_b128 a[140:143], v1 offset:51968
  v_fma_f32 v19, v19, s24, v8
  v_mfma_f32_16x16x32_bf16 v[28:31], a[112:115], a[16:19], v[28:31]
  v_exp_f32 v19, v19
  v_mfma_f32_16x16x32_bf16 v[224:227], a[192:195], v[36:39], v[224:227]
  v_fma_f32 v20, v20, s24, v8
  v_cvt_pk_bf16_f32 v32, v16, v17
  v_mfma_f32_16x16x32_bf16 v[228:231], a[196:199], v[36:39], v[228:231]
  v_exp_f32 v20, v20
  v_mfma_f32_16x16x32_bf16 v[232:235], a[200:203], v[36:39], v[232:235]
  v_fma_f32 v21, v21, s24, v8
  v_cvt_pk_bf16_f32 v33, v18, v19
  v_mfma_f32_16x16x32_bf16 v[236:239], a[204:207], v[36:39], v[236:239]
  v_exp_f32 v21, v21
  v_mfma_f32_16x16x32_bf16 v[240:243], a[208:211], v[36:39], v[240:243]
  v_fma_f32 v22, v22, s24, v8
  v_fma_f32 v23, v23, s24, v8
  v_mfma_f32_16x16x32_bf16 v[244:247], a[212:215], v[36:39], v[244:247]
  v_exp_f32 v22, v22
  v_mfma_f32_16x16x32_bf16 v[248:251], a[216:219], v[36:39], v[248:251]
  v_exp_f32 v23, v23
  v_mfma_f32_16x16x32_bf16 v[252:255], a[220:223], v[36:39], v[252:255]
  v_cvt_pk_bf16_f32 v34, v20, v21
  v_cvt_pk_bf16_f32 v35, v22, v23
  v_mfma_f32_16x16x32_bf16 v[16:19], a[96:99], a[32:35], 0
  ds_read_b128 a[144:147], v1 offset:59392
  v_fma_f32 v24, v24, s24, v9
  v_mfma_f32_16x16x32_bf16 v[16:19], a[100:103], a[36:39], v[16:19]
  v_exp_f32 v24, v24
  v_mfma_f32_16x16x32_bf16 v[16:19], a[104:107], a[40:43], v[16:19]
  ds_read_b128 a[148:151], v1 offset:59648
  v_fma_f32 v25, v25, s24, v9
  v_mfma_f32_16x16x32_bf16 v[16:19], a[108:111], a[44:47], v[16:19]
  buffer_load_dwordx4 v5, s[8:11], s20 offen offset:3072 lds
  v_exp_f32 v25, v25
  v_mfma_f32_16x16x32_bf16 v[20:23], a[124:127], a[44:47], 0
  ds_read_b128 a[152:155], v1 offset:59904
  v_fma_f32 v26, v26, s24, v9
  v_mfma_f32_16x16x32_bf16 v[20:23], a[120:123], a[40:43], v[20:23]
  v_exp_f32 v26, v26
  v_mfma_f32_16x16x32_bf16 v[20:23], a[116:119], a[36:39], v[20:23]
  ds_read_b128 a[156:159], v1 offset:60160
  v_fma_f32 v27, v27, s24, v9
  v_mfma_f32_16x16x32_bf16 v[20:23], a[112:115], a[32:35], v[20:23]
  v_exp_f32 v27, v27
  v_mfma_f32_16x16x32_bf16 v[64:67], a[160:163], v[32:35], v[64:67]
  v_fma_f32 v28, v28, s24, v9
  v_cvt_pk_bf16_f32 v36, v24, v25
  v_mfma_f32_16x16x32_bf16 v[68:71], a[164:167], v[32:35], v[68:71]
  v_exp_f32 v28, v28
  v_mfma_f32_16x16x32_bf16 v[72:75], a[168:171], v[32:35], v[72:75]
  v_fma_f32 v29, v29, s24, v9
  v_cvt_pk_bf16_f32 v37, v26, v27
  v_mfma_f32_16x16x32_bf16 v[76:79], a[172:175], v[32:35], v[76:79]
  v_exp_f32 v29, v29
  v_mfma_f32_16x16x32_bf16 v[80:83], a[176:179], v[32:35], v[80:83]
  v_fma_f32 v30, v30, s24, v9
  v_fma_f32 v31, v31, s24, v9
  v_mfma_f32_16x16x32_bf16 v[84:87], a[180:183], v[32:35], v[84:87]
  v_exp_f32 v30, v30
  v_mfma_f32_16x16x32_bf16 v[88:91], a[184:187], v[32:35], v[88:91]
  v_exp_f32 v31, v31
  v_mfma_f32_16x16x32_bf16 v[92:95], a[188:191], v[32:35], v[92:95]
  v_cvt_pk_bf16_f32 v38, v28, v29
  v_cvt_pk_bf16_f32 v39, v30, v31
  v_mfma_f32_16x16x32_bf16 v[24:27], a[96:99], a[48:51], 0
  ds_read_b64_tr_b16 a[192:193], v2 offset:49152
  v_fma_f32 v16, v16, s24, v10
  v_smfmac_f32_16x16x64_bf16 v[40:43], a[224:227], v[32:39], v7
  buffer_load_dwordx4 v4, s[12:15], s20 offen lds
  v_mfma_f32_16x16x32_bf16 v[24:27], a[100:103], a[52:55], v[24:27]
  v_exp_f32 v16, v16
  v_mfma_f32_16x16x32_bf16 v[24:27], a[104:107], a[56:59], v[24:27]
  ds_read_b64_tr_b16 a[194:195], v2 offset:57344
  v_fma_f32 v17, v17, s24, v10
  v_mfma_f32_16x16x32_bf16 v[24:27], a[108:111], a[60:63], v[24:27]
  v_exp_f32 v17, v17
  v_mfma_f32_16x16x32_bf16 v[28:31], a[124:127], a[60:63], 0
  ds_read_b64_tr_b16 a[196:197], v2 offset:49160
  v_fma_f32 v18, v18, s24, v10
  v_mfma_f32_16x16x32_bf16 v[28:31], a[120:123], a[56:59], v[28:31]
  v_exp_f32 v18, v18
  v_mfma_f32_16x16x32_bf16 v[28:31], a[116:119], a[52:55], v[28:31]
  ds_read_b64_tr_b16 a[198:199], v2 offset:57352
  v_fma_f32 v19, v19, s24, v10
  v_mfma_f32_16x16x32_bf16 v[28:31], a[112:115], a[48:51], v[28:31]
  v_exp_f32 v19, v19
  v_mfma_f32_16x16x32_bf16 v[96:99], a[160:163], v[36:39], v[96:99]
  v_fma_f32 v20, v20, s24, v10
  v_cvt_pk_bf16_f32 v32, v16, v17
  v_mfma_f32_16x16x32_bf16 v[100:103], a[164:167], v[36:39], v[100:103]
  v_exp_f32 v20, v20
  v_mfma_f32_16x16x32_bf16 v[104:107], a[168:171], v[36:39], v[104:107]
  v_fma_f32 v21, v21, s24, v10
  v_cvt_pk_bf16_f32 v33, v18, v19
  v_mfma_f32_16x16x32_bf16 v[108:111], a[172:175], v[36:39], v[108:111]
  v_exp_f32 v21, v21
  v_mfma_f32_16x16x32_bf16 v[112:115], a[176:179], v[36:39], v[112:115]
  v_fma_f32 v22, v22, s24, v10
  v_fma_f32 v23, v23, s24, v10
  v_mfma_f32_16x16x32_bf16 v[116:119], a[180:183], v[36:39], v[116:119]
  v_exp_f32 v22, v22
  v_mfma_f32_16x16x32_bf16 v[120:123], a[184:187], v[36:39], v[120:123]
  v_exp_f32 v23, v23
  v_mfma_f32_16x16x32_bf16 v[124:127], a[188:191], v[36:39], v[124:127]
  v_cvt_pk_bf16_f32 v34, v20, v21
  v_cvt_pk_bf16_f32 v35, v22, v23
  v_mfma_f32_16x16x32_bf16 v[16:19], a[96:99], a[64:67], 0
  ds_read_b64_tr_b16 a[200:201], v2 offset:49408
  v_fma_f32 v24, v24, s24, v11
  v_mfma_f32_16x16x32_bf16 v[16:19], a[100:103], a[68:71], v[16:19]
  v_exp_f32 v24, v24
  v_mfma_f32_16x16x32_bf16 v[16:19], a[104:107], a[72:75], v[16:19]
  ds_read_b64_tr_b16 a[202:203], v2 offset:57600
  v_fma_f32 v25, v25, s24, v11
  v_mfma_f32_16x16x32_bf16 v[16:19], a[108:111], a[76:79], v[16:19]
  v_exp_f32 v25, v25
  v_mfma_f32_16x16x32_bf16 v[20:23], a[124:127], a[76:79], 0
  ds_read_b64_tr_b16 a[204:205], v2 offset:49416
  v_fma_f32 v26, v26, s24, v11
  v_mfma_f32_16x16x32_bf16 v[20:23], a[120:123], a[72:75], v[20:23]
  v_exp_f32 v26, v26
  v_mfma_f32_16x16x32_bf16 v[20:23], a[116:119], a[68:71], v[20:23]
  ds_read_b64_tr_b16 a[206:207], v2 offset:57608
  v_fma_f32 v27, v27, s24, v11
  v_mfma_f32_16x16x32_bf16 v[20:23], a[112:115], a[64:67], v[20:23]
  v_exp_f32 v27, v27
  v_mfma_f32_16x16x32_bf16 v[128:131], a[160:163], v[32:35], v[128:131]
  v_fma_f32 v28, v28, s24, v11
  v_cvt_pk_bf16_f32 v36, v24, v25
  v_mfma_f32_16x16x32_bf16 v[132:135], a[164:167], v[32:35], v[132:135]
  v_exp_f32 v28, v28
  v_mfma_f32_16x16x32_bf16 v[136:139], a[168:171], v[32:35], v[136:139]
  v_fma_f32 v29, v29, s24, v11
  v_cvt_pk_bf16_f32 v37, v26, v27
  v_mfma_f32_16x16x32_bf16 v[140:143], a[172:175], v[32:35], v[140:143]
  v_exp_f32 v29, v29
  v_mfma_f32_16x16x32_bf16 v[144:147], a[176:179], v[32:35], v[144:147]
  v_fma_f32 v30, v30, s24, v11
  v_fma_f32 v31, v31, s24, v11
  v_mfma_f32_16x16x32_bf16 v[148:151], a[180:183], v[32:35], v[148:151]
  v_exp_f32 v30, v30
  v_mfma_f32_16x16x32_bf16 v[152:155], a[184:187], v[32:35], v[152:155]
  v_exp_f32 v31, v31
  v_mfma_f32_16x16x32_bf16 v[156:159], a[188:191], v[32:35], v[156:159]
  v_cvt_pk_bf16_f32 v38, v28, v29
  v_cvt_pk_bf16_f32 v39, v30, v31
  v_mfma_f32_16x16x32_bf16 v[24:27], a[96:99], a[80:83], 0
  ds_read_b64_tr_b16 a[208:209], v2 offset:49664
  v_fma_f32 v16, v16, s24, v12
  v_smfmac_f32_16x16x64_bf16 v[44:47], a[224:227], v[32:39], v7
  buffer_load_dwordx4 v4, s[12:15], s20 offen offset:1024 lds
  v_mfma_f32_16x16x32_bf16 v[24:27], a[100:103], a[84:87], v[24:27]
  v_exp_f32 v16, v16
  v_mfma_f32_16x16x32_bf16 v[24:27], a[104:107], a[88:91], v[24:27]
  ds_read_b64_tr_b16 a[210:211], v2 offset:57856
  v_fma_f32 v17, v17, s24, v12
  v_mfma_f32_16x16x32_bf16 v[24:27], a[108:111], a[92:95], v[24:27]
  v_exp_f32 v17, v17
  v_mfma_f32_16x16x32_bf16 v[28:31], a[124:127], a[92:95], 0
  ds_read_b64_tr_b16 a[212:213], v2 offset:49672
  v_fma_f32 v18, v18, s24, v12
  v_mfma_f32_16x16x32_bf16 v[28:31], a[120:123], a[88:91], v[28:31]
  v_exp_f32 v18, v18
  v_mfma_f32_16x16x32_bf16 v[28:31], a[116:119], a[84:87], v[28:31]
  ds_read_b64_tr_b16 a[214:215], v2 offset:57864
  v_fma_f32 v19, v19, s24, v12
  v_mfma_f32_16x16x32_bf16 v[28:31], a[112:115], a[80:83], v[28:31]
  v_exp_f32 v19, v19
  v_mfma_f32_16x16x32_bf16 v[160:163], a[160:163], v[36:39], v[160:163]
  v_fma_f32 v20, v20, s24, v12
  v_cvt_pk_bf16_f32 v32, v16, v17
  v_mfma_f32_16x16x32_bf16 v[164:167], a[164:167], v[36:39], v[164:167]
L_pad8:
  s_cbranch_execz L_padret
  v_exp_f32 v20, v20
  v_mfma_f32_16x16x32_bf16 v[168:171], a[168:171], v[36:39], v[168:171]
  v_fma_f32 v21, v21, s24, v12
  v_cvt_pk_bf16_f32 v33, v18, v19
  v_mfma_f32_16x16x32_bf16 v[172:175], a[172:175], v[36:39], v[172:175]
  v_exp_f32 v21, v21
  v_mfma_f32_16x16x32_bf16 v[176:179], a[176:179], v[36:39], v[176:179]
  v_fma_f32 v22, v22, s24, v12
  v_fma_f32 v23, v23, s24, v12
  v_mfma_f32_16x16x32_bf16 v[180:183], a[180:183], v[36:39], v[180:183]
  v_exp_f32 v22, v22
  v_mfma_f32_16x16x32_bf16 v[184:187], a[184:187], v[36:39], v[184:187]
  v_exp_f32 v23, v23
  v_mfma_f32_16x16x32_bf16 v[188:191], a[188:191], v[36:39], v[188:191]
  s_waitcnt lgkmcnt(12)
  v_cvt_pk_bf16_f32 v34, v20, v21
  v_cvt_pk_bf16_f32 v35, v22, v23
  v_mfma_f32_16x16x32_bf16 v[16:19], a[128:131], a[0:3], 0
  ds_read_b64_tr_b16 a[216:217], v2 offset:49920
  v_fma_f32 v24, v24, s24, v13
  v_mfma_f32_16x16x32_bf16 v[16:19], a[132:135], a[4:7], v[16:19]
  v_exp_f32 v24, v24
  v_mfma_f32_16x16x32_bf16 v[16:19], a[136:139], a[8:11], v[16:19]
  ds_read_b64_tr_b16 a[218:219], v2 offset:58112
  v_fma_f32 v25, v25, s24, v13
  v_mfma_f32_16x16x32_bf16 v[16:19], a[140:143], a[12:15], v[16:19]
  v_exp_f32 v25, v25
  v_mfma_f32_16x16x32_bf16 v[20:23], a[156:159], a[12:15], 0
  ds_read_b64_tr_b16 a[220:221], v2 offset:49928
  v_fma_f32 v26, v26, s24, v13
  v_mfma_f32_16x16x32_bf16 v[20:23], a[152:155], a[8:11], v[20:23]
  v_exp_f32 v26, v26
  v_mfma_f32_16x16x32_bf16 v[20:23], a[148:151], a[4:7], v[20:23]
  ds_read_b64_tr_b16 a[222:223], v2 offset:58120
  v_fma_f32 v27, v27, s24, v13
  v_mfma_f32_16x16x32_bf16 v[20:23], a[144:147], a[0:3], v[20:23]
  v_exp_f32 v27, v27
  v_mfma_f32_16x16x32_bf16 v[192:195], a[160:163], v[32:35], v[192:195]
  v_fma_f32 v28, v28, s24, v13
  v_cvt_pk_bf16_f32 v36, v24, v25
  v_mfma_f32_16x16x32_bf16 v[196:199], a[164:167], v[32:35], v[196:199]
  v_exp_f32 v28, v28
  v_mfma_f32_16x16x32_bf16 v[200:203], a[168:171], v[32:35], v[200:203]
  v_fma_f32 v29, v29, s24, v13
  v_cvt_pk_bf16_f32 v37, v26, v27
  v_mfma_f32_16x16x32_bf16 v[204:207], a[172:175], v[32:35], v[204:207]
  v_exp_f32 v29, v29
  v_mfma_f32_16x16x32_bf16 v[208:211], a[176:179], v[32:35], v[208:211]
  s_add_u32 s20, s20, 8192
  v_fma_f32 v30, v30, s24, v13
  v_fma_f32 v31, v31, s24, v13
  v_mfma_f32_16x16x32_bf16 v[212:215], a[180:183], v[32:35], v[212:215]
  v_exp_f32 v30, v30
  v_mfma_f32_16x16x32_bf16 v[216:219], a[184:187], v[32:35], v[216:219]
  s_add_u32 m0, s32, 49152
  v_exp_f32 v31, v31
  v_mfma_f32_16x16x32_bf16 v[220:223], a[188:191], v[32:35], v[220:223]
  s_waitcnt vmcnt(12) lgkmcnt(0)
  v_cvt_pk_bf16_f32 v38, v28, v29
  v_cvt_pk_bf16_f32 v39, v30, v31
  v_mfma_f32_16x16x32_bf16 v[24:27], a[128:131], a[16:19], 0
  s_barrier
  ds_read_b128 a[96:99], v1 offset:2048
  v_fma_f32 v16, v16, s24, v8
  v_smfmac_f32_16x16x64_bf16 v[48:51], a[224:227], v[32:39], v7
  buffer_load_dwordx4 v5, s[8:11], s20 offen offset:2048 lds
  v_mfma_f32_16x16x32_bf16 v[24:27], a[132:135], a[20:23], v[24:27]
  s_waitcnt vmcnt(51)
  v_exp_f32 v16, v16
  v_mfma_f32_16x16x32_bf16 v[24:27], a[136:139], a[24:27], v[24:27]
  ds_read_b128 a[100:103], v1 offset:2304
  v_fma_f32 v17, v17, s24, v8
  v_mfma_f32_16x16x32_bf16 v[24:27], a[140:143], a[28:31], v[24:27]
  ds_read_b128 a[0:3], v3 offset:0
  v_exp_f32 v17, v17
  v_mfma_f32_16x16x32_bf16 v[28:31], a[156:159], a[28:31], 0
  ds_read_b128 a[104:107], v1 offset:2560
  v_fma_f32 v18, v18, s24, v8
  v_mfma_f32_16x16x32_bf16 v[28:31], a[152:155], a[24:27], v[28:31]
  ds_read_b128 a[4:7], v3 offset:256
  v_exp_f32 v18, v18
  v_mfma_f32_16x16x32_bf16 v[28:31], a[148:151], a[20:23], v[28:31]
  ds_read_b128 a[108:111], v1 offset:2816
  v_fma_f32 v19, v19, s24, v8
  v_mfma_f32_16x16x32_bf16 v[28:31], a[144:147], a[16:19], v[28:31]
  ds_read_b128 a[8:11], v3 offset:512
  v_exp_f32 v19, v19
  v_mfma_f32_16x16x32_bf16 v[224:227], a[160:163], v[36:39], v[224:227]
  v_fma_f32 v20, v20, s24, v8
  v_cvt_pk_bf16_f32 v32, v16, v17
  v_mfma_f32_16x16x32_bf16 v[228:231], a[164:167], v[36:39], v[228:231]
  ds_read_b128 a[12:15], v3 offset:768
  v_exp_f32 v20, v20
  v_mfma_f32_16x16x32_bf16 v[232:235], a[168:171], v[36:39], v[232:235]
  v_fma_f32 v21, v21, s24, v8
  v_cvt_pk_bf16_f32 v33, v18, v19
  v_mfma_f32_16x16x32_bf16 v[236:239], a[172:175], v[36:39], v[236:239]
  v_exp_f32 v21, v21
  v_mfma_f32_16x16x32_bf16 v[240:243], a[176:179], v[36:39], v[240:243]
  v_fma_f32 v22, v22, s24, v8
  v_fma_f32 v23, v23, s24, v8
  v_mfma_f32_16x16x32_bf16 v[244:247], a[180:183], v[36:39], v[244:247]
  v_exp_f32 v22, v22
  v_mfma_f32_16x16x32_bf16 v[248:251], a[184:187], v[36:39], v[248:251]
  v_exp_f32 v23, v23
  v_mfma_f32_16x16x32_bf16 v[252:255], a[188:191], v[36:39], v[252:255]
  v_cvt_pk_bf16_f32 v34, v20, v21
  v_cvt_pk_bf16_f32 v35, v22, v23
  v_mfma_f32_16x16x32_bf16 v[16:19], a[128:131], a[32:35], 0
  ds_read_b128 a[112:115], v1 offset:10240
  v_fma_f32 v24, v24, s24, v9
  v_mfma_f32_16x16x32_bf16 v[16:19], a[132:135], a[36:39], v[16:19]
  s_waitcnt vmcnt(42)
  v_exp_f32 v24, v24
  v_mfma_f32_16x16x32_bf16 v[16:19], a[136:139], a[40:43], v[16:19]
  ds_read_b128 a[116:119], v1 offset:10496
  v_fma_f32 v25, v25, s24, v9
  v_mfma_f32_16x16x32_bf16 v[16:19], a[140:143], a[44:47], v[16:19]
  buffer_load_dwordx4 v5, s[8:11], s20 offen offset:3072 lds
  ds_read_b128 a[16:19], v3 offset:4096
  v_exp_f32 v25, v25
  v_mfma_f32_16x16x32_bf16 v[20:23], a[156:159], a[44:47], 0
  ds_read_b128 a[120:123], v1 offset:10752
  v_fma_f32 v26, v26, s24, v9
  v_mfma_f32_16x16x32_bf16 v[20:23], a[152:155], a[40:43], v[20:23]
  ds_read_b128 a[20:23], v3 offset:4352
  v_exp_f32 v26, v26
  v_mfma_f32_16x16x32_bf16 v[20:23], a[148:151], a[36:39], v[20:23]
  ds_read_b128 a[124:127], v1 offset:11008
  v_fma_f32 v27, v27, s24, v9
  v_mfma_f32_16x16x32_bf16 v[20:23], a[144:147], a[32:35], v[20:23]
  ds_read_b128 a[24:27], v3 offset:4608
  v_exp_f32 v27, v27
  v_mfma_f32_16x16x32_bf16 v[64:67], a[192:195], v[32:35], v[64:67]
  v_fma_f32 v28, v28, s24, v9
  v_cvt_pk_bf16_f32 v36, v24, v25
  v_mfma_f32_16x16x32_bf16 v[68:71], a[196:199], v[32:35], v[68:71]
  ds_read_b128 a[28:31], v3 offset:4864
  v_exp_f32 v28, v28
  v_mfma_f32_16x16x32_bf16 v[72:75], a[200:203], v[32:35], v[72:75]
  v_fma_f32 v29, v29, s24, v9
  v_cvt_pk_bf16_f32 v37, v26, v27
  v_mfma_f32_16x16x32_bf16 v[76:79], a[204:207], v[32:35], v[76:79]
  v_exp_f32 v29, v29
  v_mfma_f32_16x16x32_bf16 v[80:83], a[208:211], v[32:35], v[80:83]
  v_fma_f32 v30, v30, s24, v9
  v_fma_f32 v31, v31, s24, v9
  v_mfma_f32_16x16x32_bf16 v[84:87], a[212:215], v[32:35], v[84:87]
  v_exp_f32 v30, v30
  v_mfma_f32_16x16x32_bf16 v[88:91], a[216:219], v[32:35], v[88:91]
  v_exp_f32 v31, v31
  v_mfma_f32_16x16x32_bf16 v[92:95], a[220:223], v[32:35], v[92:95]
  v_cvt_pk_bf16_f32 v38, v28, v29
  v_cvt_pk_bf16_f32 v39, v30, v31
  v_mfma_f32_16x16x32_bf16 v[24:27], a[128:131], a[48:51], 0
  ds_read_b64_tr_b16 a[160:161], v2 offset:0
  v_fma_f32 v16, v16, s24, v10
  v_smfmac_f32_16x16x64_bf16 v[40:43], a[224:227], v[32:39], v7
  buffer_load_dwordx4 v4, s[12:15], s20 offen lds
  v_mfma_f32_16x16x32_bf16 v[24:27], a[132:135], a[52:55], v[24:27]
  s_waitcnt vmcnt(35)
  v_exp_f32 v16, v16
  v_mfma_f32_16x16x32_bf16 v[24:27], a[136:139], a[56:59], v[24:27]
  ds_read_b64_tr_b16 a[162:163], v2 offset:8192
  v_fma_f32 v17, v17, s24, v10
  v_mfma_f32_16x16x32_bf16 v[24:27], a[140:143], a[60:63], v[24:27]
  ds_read_b128 a[32:35], v3 offset:8192
  v_exp_f32 v17, v17
  v_add_f32 v53, v40, v41
  v_rcp_f32 v52, v53
  v_cmp_ngt_f32 vcc, s26, v53
  v_pk_mul_f32 v[64:65], v[64:65], v[52:53] op_sel_hi:[1,0]
  v_pk_mul_f32 v[66:67], v[66:67], v[52:53] op_sel_hi:[1,0]
  v_pk_mul_f32 v[68:69], v[68:69], v[52:53] op_sel_hi:[1,0]
  v_pk_mul_f32 v[70:71], v[70:71], v[52:53] op_sel_hi:[1,0]
  v_mfma_f32_16x16x32_bf16 v[28:31], a[156:159], a[60:63], 0
  ds_read_b64_tr_b16 a[164:165], v2 offset:8
  v_fma_f32 v18, v18, s24, v10
  v_mfma_f32_16x16x32_bf16 v[28:31], a[152:155], a[56:59], v[28:31]
  s_or_b64 s[30:31], s[30:31], vcc
  ds_read_b128 a[36:39], v3 offset:8448
  v_exp_f32 v18, v18
  v_cvt_pk_bf16_f32 v64, v64, v65
  v_cvt_pk_bf16_f32 v65, v66, v67
  v_cvt_pk_bf16_f32 v66, v68, v69
  v_cvt_pk_bf16_f32 v67, v70, v71
  v_pk_mul_f32 v[72:73], v[72:73], v[52:53] op_sel_hi:[1,0]
  v_pk_mul_f32 v[74:75], v[74:75], v[52:53] op_sel_hi:[1,0]
  v_pk_mul_f32 v[76:77], v[76:77], v[52:53] op_sel_hi:[1,0]
  v_pk_mul_f32 v[78:79], v[78:79], v[52:53] op_sel_hi:[1,0]
  v_mfma_f32_16x16x32_bf16 v[28:31], a[148:151], a[52:55], v[28:31]
  ds_read_b64_tr_b16 a[166:167], v2 offset:8200
  ds_write_b128 v62, v[64:67] offset:0
  v_fma_f32 v19, v19, s24, v10
  v_mfma_f32_16x16x32_bf16 v[28:31], a[144:147], a[48:51], v[28:31]
  ds_read_b128 a[40:43], v3 offset:8704
  v_exp_f32 v19, v19
  v_cvt_pk_bf16_f32 v72, v72, v73
  v_cvt_pk_bf16_f32 v73, v74, v75
  v_cvt_pk_bf16_f32 v74, v76, v77
  v_cvt_pk_bf16_f32 v75, v78, v79
  v_pk_mul_f32 v[80:81], v[80:81], v[52:53] op_sel_hi:[1,0]
  v_pk_mul_f32 v[82:83], v[82:83], v[52:53] op_sel_hi:[1,0]
  v_pk_mul_f32 v[84:85], v[84:85], v[52:53] op_sel_hi:[1,0]
  v_pk_mul_f32 v[86:87], v[86:87], v[52:53] op_sel_hi:[1,0]
  v_mfma_f32_16x16x32_bf16 v[96:99], a[192:195], v[36:39], v[96:99]
  ds_write_b128 v62, v[72:75] offset:1024
  v_fma_f32 v20, v20, s24, v10
  v_cvt_pk_bf16_f32 v32, v16, v17
  v_mfma_f32_16x16x32_bf16 v[100:103], a[196:199], v[36:39], v[100:103]
  ds_read_b128 a[44:47], v3 offset:8960
  v_exp_f32 v20, v20
  v_cvt_pk_bf16_f32 v80, v80, v81
  v_cvt_pk_bf16_f32 v81, v82, v83
  v_cvt_pk_bf16_f32 v82, v84, v85
  v_cvt_pk_bf16_f32 v83, v86, v87
  v_pk_mul_f32 v[88:89], v[88:89], v[52:53] op_sel_hi:[1,0]
  v_pk_mul_f32 v[90:91], v[90:91], v[52:53] op_sel_hi:[1,0]
  v_pk_mul_f32 v[92:93], v[92:93], v[52:53] op_sel_hi:[1,0]
  v_pk_mul_f32 v[94:95], v[94:95], v[52:53] op_sel_hi:[1,0]
  v_mfma_f32_16x16x32_bf16 v[104:107], a[200:203], v[36:39], v[104:107]
  ds_write_b128 v62, v[80:83] offset:2048
  v_fma_f32 v21, v21, s24, v10
  v_cvt_pk_bf16_f32 v33, v18, v19
  v_mfma_f32_16x16x32_bf16 v[108:111], a[204:207], v[36:39], v[108:111]
  v_exp_f32 v21, v21
  v_cvt_pk_bf16_f32 v88, v88, v89
  v_cvt_pk_bf16_f32 v89, v90, v91
  v_cvt_pk_bf16_f32 v90, v92, v93
  v_cvt_pk_bf16_f32 v91, v94, v95
  v_mfma_f32_16x16x32_bf16 v[112:115], a[208:211], v[36:39], v[112:115]
  ds_write_b128 v62, v[88:91] offset:3072
  v_fma_f32 v22, v22, s24, v10
  v_fma_f32 v23, v23, s24, v10
  v_mfma_f32_16x16x32_bf16 v[116:119], a[212:215], v[36:39], v[116:119]
  v_exp_f32 v22, v22
  v_mfma_f32_16x16x32_bf16 v[120:123], a[216:219], v[36:39], v[120:123]
  v_exp_f32 v23, v23
  v_mfma_f32_16x16x32_bf16 v[124:127], a[220:223], v[36:39], v[124:127]
  v_cvt_pk_bf16_f32 v34, v20, v21
  v_cvt_pk_bf16_f32 v35, v22, v23
  v_mfma_f32_16x16x32_bf16 v[16:19], a[128:131], a[64:67], 0
  ds_read_b64_tr_b16 a[168:169], v2 offset:256
  v_fma_f32 v24, v24, s24, v11
  v_mfma_f32_16x16x32_bf16 v[16:19], a[132:135], a[68:71], v[16:19]
  s_waitcnt vmcnt(27)
  v_exp_f32 v24, v24
  v_mfma_f32_16x16x32_bf16 v[16:19], a[136:139], a[72:75], v[16:19]
  ds_read_b64_tr_b16 a[170:171], v2 offset:8448
  v_fma_f32 v25, v25, s24, v11
  v_mfma_f32_16x16x32_bf16 v[16:19], a[140:143], a[76:79], v[16:19]
  ds_read_b128 a[48:51], v3 offset:12288
  v_exp_f32 v25, v25
  v_add_f32 v53, v42, v43
  v_rcp_f32 v52, v53
  v_cmp_ngt_f32 vcc, s26, v53
  v_pk_mul_f32 v[96:97], v[96:97], v[52:53] op_sel_hi:[1,0]
  v_pk_mul_f32 v[98:99], v[98:99], v[52:53] op_sel_hi:[1,0]
  v_pk_mul_f32 v[100:101], v[100:101], v[52:53] op_sel_hi:[1,0]
  v_pk_mul_f32 v[102:103], v[102:103], v[52:53] op_sel_hi:[1,0]
  v_mfma_f32_16x16x32_bf16 v[20:23], a[156:159], a[76:79], 0
  ds_read_b64_tr_b16 a[172:173], v2 offset:264
  v_fma_f32 v26, v26, s24, v11
  v_mov_b32 v40, 0
  v_mov_b32 v41, 0
  v_mov_b32 v42, 0
  v_mov_b32 v43, 0
  v_mfma_f32_16x16x32_bf16 v[20:23], a[152:155], a[72:75], v[20:23]
  s_or_b64 s[30:31], s[30:31], vcc
  ds_read_b128 a[228:231], v63 offset:0
  ds_read_b128 a[52:55], v3 offset:12544
  v_exp_f32 v26, v26
  v_cvt_pk_bf16_f32 v96, v96, v97
  v_cvt_pk_bf16_f32 v97, v98, v99
  v_cvt_pk_bf16_f32 v98, v100, v101
  v_cvt_pk_bf16_f32 v99, v102, v103
  v_pk_mul_f32 v[104:105], v[104:105], v[52:53] op_sel_hi:[1,0]
  v_pk_mul_f32 v[106:107], v[106:107], v[52:53] op_sel_hi:[1,0]
  v_pk_mul_f32 v[108:109], v[108:109], v[52:53] op_sel_hi:[1,0]
  v_pk_mul_f32 v[110:111], v[110:111], v[52:53] op_sel_hi:[1,0]
  v_mfma_f32_16x16x32_bf16 v[20:23], a[148:151], a[68:71], v[20:23]
  ds_read_b64_tr_b16 a[174:175], v2 offset:8456
  ds_write_b128 v62, v[96:99] offset:4096
  v_fma_f32 v27, v27, s24, v11
  v_mfma_f32_16x16x32_bf16 v[20:23], a[144:147], a[64:67], v[20:23]
  ds_read_b128 a[56:59], v3 offset:12800
  v_exp_f32 v27, v27
  v_cvt_pk_bf16_f32 v104, v104, v105
  v_cvt_pk_bf16_f32 v105, v106, v107
  v_cvt_pk_bf16_f32 v106, v108, v109
  v_cvt_pk_bf16_f32 v107, v110, v111
  v_pk_mul_f32 v[112:113], v[112:113], v[52:53] op_sel_hi:[1,0]
  v_pk_mul_f32 v[114:115], v[114:115], v[52:53] op_sel_hi:[1,0]
  v_pk_mul_f32 v[116:117], v[116:117], v[52:53] op_sel_hi:[1,0]
  v_pk_mul_f32 v[118:119], v[118:119], v[52:53] op_sel_hi:[1,0]
  v_mfma_f32_16x16x32_bf16 v[128:131], a[192:195], v[32:35], v[128:131]
  ds_write_b128 v62, v[104:107] offset:5120
  v_fma_f32 v28, v28, s24, v11
  v_cvt_pk_bf16_f32 v36, v24, v25
  v_mfma_f32_16x16x32_bf16 v[132:135], a[196:199], v[32:35], v[132:135]
  ds_read_b128 a[60:63], v3 offset:13056
  v_exp_f32 v28, v28
  v_cvt_pk_bf16_f32 v112, v112, v113
  v_cvt_pk_bf16_f32 v113, v114, v115
  v_cvt_pk_bf16_f32 v114, v116, v117
  v_cvt_pk_bf16_f32 v115, v118, v119
  v_pk_mul_f32 v[120:121], v[120:121], v[52:53] op_sel_hi:[1,0]
  v_pk_mul_f32 v[122:123], v[122:123], v[52:53] op_sel_hi:[1,0]
  v_pk_mul_f32 v[124:125], v[124:125], v[52:53] op_sel_hi:[1,0]
  v_pk_mul_f32 v[126:127], v[126:127], v[52:53] op_sel_hi:[1,0]
  v_mfma_f32_16x16x32_bf16 v[136:139], a[200:203], v[32:35], v[136:139]
  ds_write_b128 v62, v[112:115] offset:6144
  v_fma_f32 v29, v29, s24, v11
  v_cvt_pk_bf16_f32 v37, v26, v27
  v_mfma_f32_16x16x32_bf16 v[140:143], a[204:207], v[32:35], v[140:143]
  v_exp_f32 v29, v29
  v_cvt_pk_bf16_f32 v120, v120, v121
  v_cvt_pk_bf16_f32 v121, v122, v123
  v_cvt_pk_bf16_f32 v122, v124, v125
  v_cvt_pk_bf16_f32 v123, v126, v127
  v_mfma_f32_16x16x32_bf16 v[144:147], a[208:211], v[32:35], v[144:147]
  ds_write_b128 v62, v[120:123] offset:7168
  v_fma_f32 v30, v30, s24, v11
  v_fma_f32 v31, v31, s24, v11
  v_mfma_f32_16x16x32_bf16 v[148:151], a[212:215], v[32:35], v[148:151]
  v_exp_f32 v30, v30
  v_mfma_f32_16x16x32_bf16 v[152:155], a[216:219], v[32:35], v[152:155]
  v_exp_f32 v31, v31
  v_mfma_f32_16x16x32_bf16 v[156:159], a[220:223], v[32:35], v[156:159]
  v_cvt_pk_bf16_f32 v38, v28, v29
  v_cvt_pk_bf16_f32 v39, v30, v31
  v_mfma_f32_16x16x32_bf16 v[24:27], a[128:131], a[80:83], 0
  ds_read_b64_tr_b16 a[176:177], v2 offset:512
  v_fma_f32 v16, v16, s24, v12
  v_smfmac_f32_16x16x64_bf16 v[44:47], a[224:227], v[32:39], v7
  buffer_load_dwordx4 v4, s[12:15], s20 offen offset:1024 lds
  v_mfma_f32_16x16x32_bf16 v[24:27], a[132:135], a[84:87], v[24:27]
  s_waitcnt vmcnt(18)
  v_exp_f32 v16, v16
  v_mfma_f32_16x16x32_bf16 v[24:27], a[136:139], a[88:91], v[24:27]
  ds_read_b64_tr_b16 a[178:179], v2 offset:8704
  v_fma_f32 v17, v17, s24, v12
  v_mfma_f32_16x16x32_bf16 v[24:27], a[140:143], a[92:95], v[24:27]
  ds_read_b128 a[64:67], v3 offset:16384
  v_exp_f32 v17, v17
  v_add_f32 v53, v44, v45
  v_rcp_f32 v52, v53
  v_cmp_ngt_f32 vcc, s26, v53
  v_pk_mul_f32 v[128:129], v[128:129], v[52:53] op_sel_hi:[1,0]
  v_pk_mul_f32 v[130:131], v[130:131], v[52:53] op_sel_hi:[1,0]
  v_pk_mul_f32 v[132:133], v[132:133], v[52:53] op_sel_hi:[1,0]
  v_pk_mul_f32 v[134:135], v[134:135], v[52:53] op_sel_hi:[1,0]
  v_mfma_f32_16x16x32_bf16 v[28:31], a[156:159], a[92:95], 0
  ds_read_b64_tr_b16 a[180:181], v2 offset:520
  v_fma_f32 v18, v18, s24, v12
  v_mfma_f32_16x16x32_bf16 v[28:31], a[152:155], a[88:91], v[28:31]
  s_or_b64 s[30:31], s[30:31], vcc
  ds_read_b128 a[68:71], v3 offset:16640
  v_exp_f32 v18, v18
  v_cvt_pk_bf16_f32 v128, v128, v129
  v_cvt_pk_bf16_f32 v129, v130, v131
  v_cvt_pk_bf16_f32 v130, v132, v133
  v_cvt_pk_bf16_f32 v131, v134, v135
  v_pk_mul_f32 v[136:137], v[136:137], v[52:53] op_sel_hi:[1,0]
  v_pk_mul_f32 v[138:139], v[138:139], v[52:53] op_sel_hi:[1,0]
  v_pk_mul_f32 v[140:141], v[140:141], v[52:53] op_sel_hi:[1,0]
  v_pk_mul_f32 v[142:143], v[142:143], v[52:53] op_sel_hi:[1,0]
  v_mfma_f32_16x16x32_bf16 v[28:31], a[148:151], a[84:87], v[28:31]
  ds_read_b64_tr_b16 a[182:183], v2 offset:8712
  ds_write_b128 v62, v[128:131] offset:8192
  v_fma_f32 v19, v19, s24, v12
  v_mfma_f32_16x16x32_bf16 v[28:31], a[144:147], a[80:83], v[28:31]
  ds_read_b128 a[72:75], v3 offset:16896
  v_exp_f32 v19, v19
  v_cvt_pk_bf16_f32 v136, v136, v137
  v_cvt_pk_bf16_f32 v137, v138, v139
  v_cvt_pk_bf16_f32 v138, v140, v141
  v_cvt_pk_bf16_f32 v139, v142, v143
  v_pk_mul_f32 v[144:145], v[144:145], v[52:53] op_sel_hi:[1,0]
  v_pk_mul_f32 v[146:147], v[146:147], v[52:53] op_sel_hi:[1,0]
  v_pk_mul_f32 v[148:149], v[148:149], v[52:53] op_sel_hi:[1,0]
  v_pk_mul_f32 v[150:151], v[150:151], v[52:53] op_sel_hi:[1,0]
  v_mfma_f32_16x16x32_bf16 v[160:163], a[192:195], v[36:39], v[160:163]
  s_waitcnt lgkmcnt(15)
  ds_write_b128 v62, v[136:139] offset:9216
  v_fma_f32 v20, v20, s24, v12
  v_cvt_pk_bf16_f32 v32, v16, v17
  v_mfma_f32_16x16x32_bf16 v[164:167], a[196:199], v[36:39], v[164:167]
  buffer_store_dwordx4 a[228:231], v6, s[16:19], s22 offen sc1
  ds_read_b128 a[232:235], v63 offset:512
  ds_read_b128 a[76:79], v3 offset:17152
  v_exp_f32 v20, v20
  v_cvt_pk_bf16_f32 v144, v144, v145
  v_cvt_pk_bf16_f32 v145, v146, v147
  v_cvt_pk_bf16_f32 v146, v148, v149
  v_cvt_pk_bf16_f32 v147, v150, v151
  v_pk_mul_f32 v[152:153], v[152:153], v[52:53] op_sel_hi:[1,0]
  v_pk_mul_f32 v[154:155], v[154:155], v[52:53] op_sel_hi:[1,0]
  v_pk_mul_f32 v[156:157], v[156:157], v[52:53] op_sel_hi:[1,0]
  v_pk_mul_f32 v[158:159], v[158:159], v[52:53] op_sel_hi:[1,0]
  v_mfma_f32_16x16x32_bf16 v[168:171], a[200:203], v[36:39], v[168:171]
  ds_write_b128 v62, v[144:147] offset:10240
  v_fma_f32 v21, v21, s24, v12
  v_cvt_pk_bf16_f32 v33, v18, v19
  v_mfma_f32_16x16x32_bf16 v[172:175], a[204:207], v[36:39], v[172:175]
  v_exp_f32 v21, v21
  v_cvt_pk_bf16_f32 v152, v152, v153
  v_cvt_pk_bf16_f32 v153, v154, v155
  v_cvt_pk_bf16_f32 v154, v156, v157
  v_cvt_pk_bf16_f32 v155, v158, v159
  v_mfma_f32_16x16x32_bf16 v[176:179], a[208:211], v[36:39], v[176:179]
  ds_write_b128 v62, v[152:155] offset:11264
  v_fma_f32 v22, v22, s24, v12
  v_fma_f32 v23, v23, s24, v12
  v_mfma_f32_16x16x32_bf16 v[180:183], a[212:215], v[36:39], v[180:183]
  v_exp_f32 v22, v22
  v_mfma_f32_16x16x32_bf16 v[184:187], a[216:219], v[36:39], v[184:187]
  s_waitcnt lgkmcnt(15)
  v_exp_f32 v23, v23
  v_mfma_f32_16x16x32_bf16 v[188:191], a[220:223], v[36:39], v[188:191]
  s_waitcnt lgkmcnt(15)
  v_cvt_pk_bf16_f32 v34, v20, v21
  v_cvt_pk_bf16_f32 v35, v22, v23
  v_mfma_f32_16x16x32_bf16 v[16:19], a[96:99], a[0:3], 0
  ds_read_b64_tr_b16 a[184:185], v2 offset:768
  v_fma_f32 v24, v24, s24, v13
  v_mfma_f32_16x16x32_bf16 v[16:19], a[100:103], a[4:7], v[16:19]
  s_waitcnt vmcnt(9)
  v_exp_f32 v24, v24
  v_mfma_f32_16x16x32_bf16 v[16:19], a[104:107], a[8:11], v[16:19]
  ds_read_b64_tr_b16 a[186:187], v2 offset:8960
  v_fma_f32 v25, v25, s24, v13
  v_mfma_f32_16x16x32_bf16 v[16:19], a[108:111], a[12:15], v[16:19]
  ds_read_b128 a[80:83], v3 offset:20480
  v_exp_f32 v25, v25
  v_add_f32 v53, v46, v47
  v_rcp_f32 v52, v53
  v_cmp_ngt_f32 vcc, s26, v53
  v_pk_mul_f32 v[160:161], v[160:161], v[52:53] op_sel_hi:[1,0]
  v_pk_mul_f32 v[162:163], v[162:163], v[52:53] op_sel_hi:[1,0]
  v_pk_mul_f32 v[164:165], v[164:165], v[52:53] op_sel_hi:[1,0]
  v_pk_mul_f32 v[166:167], v[166:167], v[52:53] op_sel_hi:[1,0]
  v_mfma_f32_16x16x32_bf16 v[20:23], a[124:127], a[12:15], 0
  ds_read_b64_tr_b16 a[188:189], v2 offset:776
  v_fma_f32 v26, v26, s24, v13
  v_mov_b32 v44, 0
  v_mov_b32 v45, 0
  v_mov_b32 v46, 0
  v_mov_b32 v47, 0
  v_mfma_f32_16x16x32_bf16 v[20:23], a[120:123], a[8:11], v[20:23]
  s_or_b64 s[30:31], s[30:31], vcc
  ds_read_b128 a[84:87], v3 offset:20736
  v_exp_f32 v26, v26
  v_cvt_pk_bf16_f32 v160, v160, v161
  v_cvt_pk_bf16_f32 v161, v162, v163
  v_cvt_pk_bf16_f32 v162, v164, v165
  v_cvt_pk_bf16_f32 v163, v166, v167
  v_pk_mul_f32 v[168:169], v[168:169], v[52:53] op_sel_hi:[1,0]
  v_pk_mul_f32 v[170:171], v[170:171], v[52:53] op_sel_hi:[1,0]
  v_pk_mul_f32 v[172:173], v[172:173], v[52:53] op_sel_hi:[1,0]
  v_pk_mul_f32 v[174:175], v[174:175], v[52:53] op_sel_hi:[1,0]
  v_mfma_f32_16x16x32_bf16 v[20:23], a[116:119], a[4:7], v[20:23]
  ds_read_b64_tr_b16 a[190:191], v2 offset:8968
  ds_write_b128 v62, v[160:163] offset:12288
  v_fma_f32 v27, v27, s24, v13
  v_mfma_f32_16x16x32_bf16 v[20:23], a[112:115], a[0:3], v[20:23]
  ds_read_b128 a[88:91], v3 offset:20992
  v_exp_f32 v27, v27
  v_cvt_pk_bf16_f32 v168, v168, v169
  v_cvt_pk_bf16_f32 v169, v170, v171
  v_cvt_pk_bf16_f32 v170, v172, v173
  v_cvt_pk_bf16_f32 v171, v174, v175
  v_pk_mul_f32 v[176:177], v[176:177], v[52:53] op_sel_hi:[1,0]
  v_pk_mul_f32 v[178:179], v[178:179], v[52:53] op_sel_hi:[1,0]
  v_pk_mul_f32 v[180:181], v[180:181], v[52:53] op_sel_hi:[1,0]
  v_pk_mul_f32 v[182:183], v[182:183], v[52:53] op_sel_hi:[1,0]
  v_mfma_f32_16x16x32_bf16 v[192:195], a[192:195], v[32:35], v[192:195]
  s_waitcnt lgkmcnt(11)
  ds_write_b128 v62, v[168:171] offset:13312
  v_fma_f32 v28, v28, s24, v13
  v_cvt_pk_bf16_f32 v36, v24, v25
  v_mfma_f32_16x16x32_bf16 v[196:199], a[196:199], v[32:35], v[196:199]
  buffer_store_dwordx4 a[232:235], v6, s[16:19], s22 offen offset:2048 sc1
  ds_read_b128 a[228:231], v63 offset:2048
  ds_read_b128 a[92:95], v3 offset:21248
  v_exp_f32 v28, v28
  v_cvt_pk_bf16_f32 v176, v176, v177
  v_cvt_pk_bf16_f32 v177, v178, v179
  v_cvt_pk_bf16_f32 v178, v180, v181
  v_cvt_pk_bf16_f32 v179, v182, v183
  v_pk_mul_f32 v[184:185], v[184:185], v[52:53] op_sel_hi:[1,0]
  v_pk_mul_f32 v[186:187], v[186:187], v[52:53] op_sel_hi:[1,0]
  v_pk_mul_f32 v[188:189], v[188:189], v[52:53] op_sel_hi:[1,0]
  v_pk_mul_f32 v[190:191], v[190:191], v[52:53] op_sel_hi:[1,0]
  v_mfma_f32_16x16x32_bf16 v[200:203], a[200:203], v[32:35], v[200:203]
  ds_write_b128 v62, v[176:179] offset:14336
  v_fma_f32 v29, v29, s24, v13
  v_cvt_pk_bf16_f32 v37, v26, v27
  v_mfma_f32_16x16x32_bf16 v[204:207], a[204:207], v[32:35], v[204:207]
  v_exp_f32 v29, v29
  v_max3_f32 v14, v16, v17, v18
  v_max3_f32 v14, v14, v19, v20
  v_cvt_pk_bf16_f32 v184, v184, v185
  v_cvt_pk_bf16_f32 v185, v186, v187
  v_cvt_pk_bf16_f32 v186, v188, v189
  v_cvt_pk_bf16_f32 v187, v190, v191
  v_mfma_f32_16x16x32_bf16 v[208:211], a[208:211], v[32:35], v[208:211]
  s_add_u32 s20, s20, 8192
  ds_write_b128 v62, v[184:187] offset:15360
  v_fma_f32 v30, v30, s24, v13
  v_fma_f32 v31, v31, s24, v13
  v_max3_f32 v14, v14, v21, v22
  v_max_f32 v14, v14, v23
  v_mov_b32 v15, v14
  v_mfma_f32_16x16x32_bf16 v[212:215], a[212:215], v[32:35], v[212:215]
  s_mov_b32 m0, s32
  v_exp_f32 v30, v30
  v_permlane16_swap_b32 v14, v15
  v_max_f32 v14, v14, v15
  v_mov_b32 v15, v14
  v_mfma_f32_16x16x32_bf16 v[216:219], a[216:219], v[32:35], v[216:219]
  s_waitcnt lgkmcnt(15)
  v_exp_f32 v31, v31
  v_permlane32_swap_b32 v14, v15
  v_max_f32 v14, v14, v15
  v_mfma_f32_16x16x32_bf16 v[220:223], a[220:223], v[32:35], v[220:223]
  s_waitcnt vmcnt(11) lgkmcnt(0)
  v_cvt_pk_bf16_f32 v38, v28, v29
  v_cvt_pk_bf16_f32 v39, v30, v31
  v_mul_f32 v8, s25, v14
  s_branch L_loop
L_tail:
L_pad9:
  s_cbranch_execz L_pad10
  v_mfma_f32_16x16x32_bf16 v[24:27], a[128:131], a[16:19], 0
  s_barrier
  ds_read_b128 a[96:99], v1 offset:34816
  v_fma_f32 v16, v16, s24, v8
  v_smfmac_f32_16x16x64_bf16 v[48:51], a[224:227], v[32:39], v7
  v_mfma_f32_16x16x32_bf16 v[24:27], a[132:135], a[20:23], v[24:27]
  s_add_u32 s40, s22, 0
  ds_read_b128 a[100:103], v1 offset:35072
  v_exp_f32 v16, v16
  v_mfma_f32_16x16x32_bf16 v[24:27], a[136:139], a[24:27], v[24:27]
  ds_read_b128 a[104:107], v1 offset:35328
  v_fma_f32 v17, v17, s24, v8
  v_mfma_f32_16x16x32_bf16 v[24:27], a[140:143], a[28:31], v[24:27]
  s_add_u32 s41, s22, 4096
  ds_read_b128 a[108:111], v1 offset:35584
  v_exp_f32 v17, v17
  v_mfma_f32_16x16x32_bf16 v[28:31], a[156:159], a[28:31], 0
  ds_read_b128 a[112:115], v1 offset:43008
  v_fma_f32 v18, v18, s24, v8
  v_mfma_f32_16x16x32_bf16 v[28:31], a[152:155], a[24:27], v[28:31]
  s_add_u32 s42, s22, 8192
  ds_read_b128 a[116:119], v1 offset:43264
  v_exp_f32 v18, v18
  v_mfma_f32_16x16x32_bf16 v[28:31], a[148:151], a[20:23], v[28:31]
  ds_read_b128 a[120:123], v1 offset:43520
  v_fma_f32 v19, v19, s24, v8
  v_mfma_f32_16x16x32_bf16 v[28:31], a[144:147], a[16:19], v[28:31]
  s_add_u32 s43, s22, 12288
  ds_read_b128 a[124:127], v1 offset:43776
  v_exp_f32 v19, v19
  v_mfma_f32_16x16x32_bf16 v[224:227], a[160:163], v[36:39], v[224:227]
  v_fma_f32 v20, v20, s24, v8
  v_cvt_pk_bf16_f32 v32, v16, v17
  v_mfma_f32_16x16x32_bf16 v[228:231], a[164:167], v[36:39], v[228:231]
  s_add_u32 s44, s22, 16384
  v_exp_f32 v20, v20
  v_mfma_f32_16x16x32_bf16 v[232:235], a[168:171], v[36:39], v[232:235]
L_pad10:
  s_cbranch_execz L_pad11
  v_fma_f32 v21, v21, s24, v8
  v_cvt_pk_bf16_f32 v33, v18, v19
  v_mfma_f32_16x16x32_bf16 v[236:239], a[172:175], v[36:39], v[236:239]
  s_add_u32 s45, s22, 20480
  v_exp_f32 v21, v21
  v_mfma_f32_16x16x32_bf16 v[240:243], a[176:179], v[36:39], v[240:243]
  v_fma_f32 v22, v22, s24, v8
  v_fma_f32 v23, v23, s24, v8
  v_mfma_f32_16x16x32_bf16 v[244:247], a[180:183], v[36:39], v[244:247]
  v_exp_f32 v22, v22
  v_mfma_f32_16x16x32_bf16 v[248:251], a[184:187], v[36:39], v[248:251]
  v_exp_f32 v23, v23
  v_mfma_f32_16x16x32_bf16 v[252:255], a[188:191], v[36:39], v[252:255]
  s_waitcnt lgkmcnt(0)
  v_cvt_pk_bf16_f32 v34, v20, v21
  v_cvt_pk_bf16_f32 v35, v22, v23
  v_mfma_f32_16x16x32_bf16 v[16:19], a[96:99], a[0:3], 0
  ds_read_b64_tr_b16 a[160:161], v2 offset:32768
  v_fma_f32 v24, v24, s24, v9
  v_mfma_f32_16x16x32_bf16 v[16:19], a[100:103], a[4:7], v[16:19]
  ds_read_b64_tr_b16 a[162:163], v2 offset:40960
  v_exp_f32 v24, v24
  v_mfma_f32_16x16x32_bf16 v[16:19], a[104:107], a[8:11], v[16:19]
  ds_read_b64_tr_b16 a[164:165], v2 offset:32776
  v_fma_f32 v25, v25, s24, v9
  v_mfma_f32_16x16x32_bf16 v[16:19], a[108:111], a[12:15], v[16:19]
  ds_read_b64_tr_b16 a[166:167], v2 offset:40968
  v_exp_f32 v25, v25
  v_mfma_f32_16x16x32_bf16 v[20:23], a[124:127], a[12:15], 0
  ds_read_b64_tr_b16 a[168:169], v2 offset:33024
  v_fma_f32 v26, v26, s24, v9
  v_mfma_f32_16x16x32_bf16 v[20:23], a[120:123], a[8:11], v[20:23]
  ds_read_b64_tr_b16 a[170:171], v2 offset:41216
  v_exp_f32 v26, v26
  v_mfma_f32_16x16x32_bf16 v[20:23], a[116:119], a[4:7], v[20:23]
  ds_read_b64_tr_b16 a[172:173], v2 offset:33032
  v_fma_f32 v27, v27, s24, v9
  v_mfma_f32_16x16x32_bf16 v[20:23], a[112:115], a[0:3], v[20:23]
  ds_read_b64_tr_b16 a[174:175], v2 offset:41224
  v_exp_f32 v27, v27
  v_mfma_f32_16x16x32_bf16 v[64:67], a[192:195], v[32:35], v[64:67]
  ds_read_b64_tr_b16 a[176:177], v2 offset:33280
  v_fma_f32 v28, v28, s24, v9
  v_cvt_pk_bf16_f32 v36, v24, v25
  v_mfma_f32_16x16x32_bf16 v[68:71], a[196:199], v[32:35], v[68:71]
  ds_read_b64_tr_b16 a[178:179], v2 offset:41472
  v_exp_f32 v28, v28
  v_mfma_f32_16x16x32_bf16 v[72:75], a[200:203], v[32:35], v[72:75]
  v_fma_f32 v29, v29, s24, v9
  v_cvt_pk_bf16_f32 v37, v26, v27
  v_mfma_f32_16x16x32_bf16 v[76:79], a[204:207], v[32:35], v[76:79]
  v_exp_f32 v29, v29
  v_mfma_f32_16x16x32_bf16 v[80:83], a[208:211], v[32:35], v[80:83]
  v_fma_f32 v30, v30, s24, v9
  v_fma_f32 v31, v31, s24, v9
  v_mfma_f32_16x16x32_bf16 v[84:87], a[212:215], v[32:35], v[84:87]
  v_exp_f32 v30, v30
  v_mfma_f32_16x16x32_bf16 v[88:91], a[216:219], v[32:35], v[88:91]
  v_exp_f32 v31, v31
  v_mfma_f32_16x16x32_bf16 v[92:95], a[220:223], v[32:35], v[92:95]
  s_waitcnt vmcnt(8)
  v_cvt_pk_bf16_f32 v38, v28, v29
  v_cvt_pk_bf16_f32 v39, v30, v31
  v_mfma_f32_16x16x32_bf16 v[24:27], a[96:99], a[16:19], 0
  s_barrier
  ds_read_b128 a[128:131], v1 offset:51200
  v_fma_f32 v16, v16, s24, v8
  v_smfmac_f32_16x16x64_bf16 v[40:43], a[224:227], v[32:39], v7
  v_mfma_f32_16x16x32_bf16 v[24:27], a[100:103], a[20:23], v[24:27]
  ds_read_b128 a[132:135], v1 offset:51456
  v_exp_f32 v16, v16
  v_mfma_f32_16x16x32_bf16 v[24:27], a[104:107], a[24:27], v[24:27]
  ds_read_b128 a[136:139], v1 offset:51712
  v_fma_f32 v17, v17, s24, v8
  v_mfma_f32_16x16x32_bf16 v[24:27], a[108:111], a[28:31], v[24:27]
  ds_read_b128 a[140:143], v1 offset:51968
  v_exp_f32 v17, v17
  v_mfma_f32_16x16x32_bf16 v[28:31], a[124:127], a[28:31], 0
  ds_read_b128 a[144:147], v1 offset:59392
  v_fma_f32 v18, v18, s24, v8
  v_mfma_f32_16x16x32_bf16 v[28:31], a[120:123], a[24:27], v[28:31]
  ds_read_b128 a[148:151], v1 offset:59648
  v_exp_f32 v18, v18
  v_mfma_f32_16x16x32_bf16 v[28:31], a[116:119], a[20:23], v[28:31]
  ds_read_b128 a[152:155], v1 offset:59904
  v_fma_f32 v19, v19, s24, v8
  v_mfma_f32_16x16x32_bf16 v[28:31], a[112:115], a[16:19], v[28:31]
  ds_read_b128 a[156:159], v1 offset:60160
  v_exp_f32 v19, v19
  v_mfma_f32_16x16x32_bf16 v[96:99], a[192:195], v[36:39], v[96:99]
  ds_read_b64_tr_b16 a[180:181], v2 offset:33288
  v_fma_f32 v20, v20, s24, v8
  v_cvt_pk_bf16_f32 v32, v16, v17
  v_mfma_f32_16x16x32_bf16 v[100:103], a[196:199], v[36:39], v[100:103]
  ds_read_b64_tr_b16 a[182:183], v2 offset:41480
  v_exp_f32 v20, v20
  v_mfma_f32_16x16x32_bf16 v[104:107], a[200:203], v[36:39], v[104:107]
  ds_read_b64_tr_b16 a[184:185], v2 offset:33536
  v_fma_f32 v21, v21, s24, v8
  v_cvt_pk_bf16_f32 v33, v18, v19
  v_mfma_f32_16x16x32_bf16 v[108:111], a[204:207], v[36:39], v[108:111]
  ds_read_b64_tr_b16 a[186:187], v2 offset:41728
  v_exp_f32 v21, v21
  v_mfma_f32_16x16x32_bf16 v[112:115], a[208:211], v[36:39], v[112:115]
  ds_read_b64_tr_b16 a[188:189], v2 offset:33544
  v_fma_f32 v22, v22, s24, v8
  v_fma_f32 v23, v23, s24, v8
  v_mfma_f32_16x16x32_bf16 v[116:119], a[212:215], v[36:39], v[116:119]
  ds_read_b64_tr_b16 a[190:191], v2 offset:41736
  v_exp_f32 v22, v22
  v_mfma_f32_16x16x32_bf16 v[120:123], a[216:219], v[36:39], v[120:123]
  v_exp_f32 v23, v23
  v_mfma_f32_16x16x32_bf16 v[124:127], a[220:223], v[36:39], v[124:127]
  s_waitcnt lgkmcnt(6)
  v_cvt_pk_bf16_f32 v34, v20, v21
  v_cvt_pk_bf16_f32 v35, v22, v23
  v_mfma_f32_16x16x32_bf16 v[16:19], a[128:131], a[0:3], 0
  ds_read_b64_tr_b16 a[192:193], v2 offset:49152
  v_fma_f32 v24, v24, s24, v9
  v_mfma_f32_16x16x32_bf16 v[16:19], a[132:135], a[4:7], v[16:19]
  ds_read_b64_tr_b16 a[194:195], v2 offset:57344
  v_exp_f32 v24, v24
  v_mfma_f32_16x16x32_bf16 v[16:19], a[136:139], a[8:11], v[16:19]
  ds_read_b64_tr_b16 a[196:197], v2 offset:49160
  v_fma_f32 v25, v25, s24, v9
  v_mfma_f32_16x16x32_bf16 v[16:19], a[140:143], a[12:15], v[16:19]
  ds_read_b64_tr_b16 a[198:199], v2 offset:57352
  v_exp_f32 v25, v25
  v_mfma_f32_16x16x32_bf16 v[20:23], a[156:159], a[12:15], 0
  ds_read_b64_tr_b16 a[200:201], v2 offset:49408
  v_fma_f32 v26, v26, s24, v9
  v_mfma_f32_16x16x32_bf16 v[20:23], a[152:155], a[8:11], v[20:23]
  ds_read_b64_tr_b16 a[202:203], v2 offset:57600
  v_exp_f32 v26, v26
  v_mfma_f32_16x16x32_bf16 v[20:23], a[148:151], a[4:7], v[20:23]
  ds_read_b64_tr_b16 a[204:205], v2 offset:49416
  v_fma_f32 v27, v27, s24, v9
  v_mfma_f32_16x16x32_bf16 v[20:23], a[144:147], a[0:3], v[20:23]
  s_waitcnt lgkmcnt(7)
  ds_read_b64_tr_b16 a[206:207], v2 offset:57608
  v_exp_f32 v27, v27
  v_mfma_f32_16x16x32_bf16 v[64:67], a[160:163], v[32:35], v[64:67]
  v_fma_f32 v28, v28, s24, v9
  v_cvt_pk_bf16_f32 v36, v24, v25
  v_mfma_f32_16x16x32_bf16 v[68:71], a[164:167], v[32:35], v[68:71]
  v_exp_f32 v28, v28
  v_mfma_f32_16x16x32_bf16 v[72:75], a[168:171], v[32:35], v[72:75]
  v_fma_f32 v29, v29, s24, v9
  v_cvt_pk_bf16_f32 v37, v26, v27
  v_mfma_f32_16x16x32_bf16 v[76:79], a[172:175], v[32:35], v[76:79]
  v_exp_f32 v29, v29
  v_mfma_f32_16x16x32_bf16 v[80:83], a[176:179], v[32:35], v[80:83]
  v_fma_f32 v30, v30, s24, v9
  v_fma_f32 v31, v31, s24, v9
  v_mfma_f32_16x16x32_bf16 v[84:87], a[180:183], v[32:35], v[84:87]
  v_exp_f32 v30, v30
  v_mfma_f32_16x16x32_bf16 v[88:91], a[184:187], v[32:35], v[88:91]
  v_exp_f32 v31, v31
  v_mfma_f32_16x16x32_bf16 v[92:95], a[188:191], v[32:35], v[92:95]
  v_cvt_pk_bf16_f32 v38, v28, v29
  v_cvt_pk_bf16_f32 v39, v30, v31
  v_mfma_f32_16x16x32_bf16 v[24:27], a[128:131], a[16:19], 0
  ds_read_b64_tr_b16 a[208:209], v2 offset:49664
  v_fma_f32 v16, v16, s24, v8
  v_smfmac_f32_16x16x64_bf16 v[40:43], a[224:227], v[32:39], v7
  v_mfma_f32_16x16x32_bf16 v[24:27], a[132:135], a[20:23], v[24:27]
  ds_read_b64_tr_b16 a[210:211], v2 offset:57856
  v_exp_f32 v16, v16
  v_mfma_f32_16x16x32_bf16 v[24:27], a[136:139], a[24:27], v[24:27]
  ds_read_b64_tr_b16 a[212:213], v2 offset:49672
  v_fma_f32 v17, v17, s24, v8
  v_mfma_f32_16x16x32_bf16 v[24:27], a[140:143], a[28:31], v[24:27]
  ds_read_b64_tr_b16 a[214:215], v2 offset:57864
  v_exp_f32 v17, v17
  v_mfma_f32_16x16x32_bf16 v[28:31], a[156:159], a[28:31], 0
  ds_read_b64_tr_b16 a[216:217], v2 offset:49920
  v_fma_f32 v18, v18, s24, v8
  v_mfma_f32_16x16x32_bf16 v[28:31], a[152:155], a[24:27], v[28:31]
  ds_read_b64_tr_b16 a[218:219], v2 offset:58112
  v_exp_f32 v18, v18
  v_mfma_f32_16x16x32_bf16 v[28:31], a[148:151], a[20:23], v[28:31]
  ds_read_b64_tr_b16 a[220:221], v2 offset:49928
  v_fma_f32 v19, v19, s24, v8
  v_mfma_f32_16x16x32_bf16 v[28:31], a[144:147], a[16:19], v[28:31]
  ds_read_b64_tr_b16 a[222:223], v2 offset:58120
  v_exp_f32 v19, v19
  v_mfma_f32_16x16x32_bf16 v[96:99], a[160:163], v[36:39], v[96:99]
  v_fma_f32 v20, v20, s24, v8
  v_cvt_pk_bf16_f32 v32, v16, v17
  v_mfma_f32_16x16x32_bf16 v[100:103], a[164:167], v[36:39], v[100:103]
  v_exp_f32 v20, v20
  v_mfma_f32_16x16x32_bf16 v[104:107], a[168:171], v[36:39], v[104:107]
  v_fma_f32 v21, v21, s24, v8
  v_cvt_pk_bf16_f32 v33, v18, v19
  v_mfma_f32_16x16x32_bf16 v[108:111], a[172:175], v[36:39], v[108:111]
  v_exp_f32 v21, v21
  v_mfma_f32_16x16x32_bf16 v[112:115], a[176:179], v[36:39], v[112:115]
  v_fma_f32 v22, v22, s24, v8
  v_fma_f32 v23, v23, s24, v8
  v_mfma_f32_16x16x32_bf16 v[116:119], a[180:183], v[36:39], v[116:119]
  v_exp_f32 v22, v22
  v_mfma_f32_16x16x32_bf16 v[120:123], a[184:187], v[36:39], v[120:123]
  v_exp_f32 v23, v23
  v_mfma_f32_16x16x32_bf16 v[124:127], a[188:191], v[36:39], v[124:127]
  v_cvt_pk_bf16_f32 v34, v20, v21
  v_cvt_pk_bf16_f32 v35, v22, v23
  v_mfma_f32_16x16x32_bf16 v[16:19], a[128:131], a[32:35], 0
  v_fma_f32 v24, v24, s24, v9
  v_mfma_f32_16x16x32_bf16 v[16:19], a[132:135], a[36:39], v[16:19]
  v_exp_f32 v24, v24
  v_mfma_f32_16x16x32_bf16 v[16:19], a[136:139], a[40:43], v[16:19]
  v_fma_f32 v25, v25, s24, v9
  v_mfma_f32_16x16x32_bf16 v[16:19], a[140:143], a[44:47], v[16:19]
  v_exp_f32 v25, v25
  v_mfma_f32_16x16x32_bf16 v[20:23], a[156:159], a[44:47], 0
  v_fma_f32 v26, v26, s24, v9
  v_mfma_f32_16x16x32_bf16 v[20:23], a[152:155], a[40:43], v[20:23]
  v_exp_f32 v26, v26
  v_mfma_f32_16x16x32_bf16 v[20:23], a[148:151], a[36:39], v[20:23]
  v_fma_f32 v27, v27, s24, v9
  v_mfma_f32_16x16x32_bf16 v[20:23], a[144:147], a[32:35], v[20:23]
  s_waitcnt lgkmcnt(0)
  v_exp_f32 v27, v27
  v_mfma_f32_16x16x32_bf16 v[64:67], a[192:195], v[32:35], v[64:67]
  v_fma_f32 v28, v28, s24, v9
  v_cvt_pk_bf16_f32 v36, v24, v25
  v_mfma_f32_16x16x32_bf16 v[68:71], a[196:199], v[32:35], v[68:71]
  v_exp_f32 v28, v28
  v_mfma_f32_16x16x32_bf16 v[72:75], a[200:203], v[32:35], v[72:75]
  v_fma_f32 v29, v29, s24, v9
  v_cvt_pk_bf16_f32 v37, v26, v27
  v_mfma_f32_16x16x32_bf16 v[76:79], a[204:207], v[32:35], v[76:79]
  v_exp_f32 v29, v29
  v_mfma_f32_16x16x32_bf16 v[80:83], a[208:211], v[32:35], v[80:83]
  v_fma_f32 v30, v30, s24, v9
  v_fma_f32 v31, v31, s24, v9
  v_mfma_f32_16x16x32_bf16 v[84:87], a[212:215], v[32:35], v[84:87]
  v_exp_f32 v30, v30
  v_mfma_f32_16x16x32_bf16 v[88:91], a[216:219], v[32:35], v[88:91]
  s_waitcnt vmcnt(0)
  v_exp_f32 v31, v31
  v_mfma_f32_16x16x32_bf16 v[92:95], a[220:223], v[32:35], v[92:95]
  v_cvt_pk_bf16_f32 v38, v28, v29
  v_cvt_pk_bf16_f32 v39, v30, v31
  v_mfma_f32_16x16x32_bf16 v[24:27], a[128:131], a[48:51], 0
  v_fma_f32 v16, v16, s24, v10
  v_smfmac_f32_16x16x64_bf16 v[40:43], a[224:227], v[32:39], v7
  v_mfma_f32_16x16x32_bf16 v[24:27], a[132:135], a[52:55], v[24:27]
  v_exp_f32 v16, v16
  v_mfma_f32_16x16x32_bf16 v[24:27], a[136:139], a[56:59], v[24:27]
  v_fma_f32 v17, v17, s24, v10
  v_mfma_f32_16x16x32_bf16 v[24:27], a[140:143], a[60:63], v[24:27]
  v_exp_f32 v17, v17
  s_nop 1
  v_add_f32 v53, v40, v41
  v_rcp_f32 v52, v53
  v_cmp_ngt_f32 vcc, s26, v53
  v_pk_mul_f32 v[64:65], v[64:65], v[52:53] op_sel_hi:[1,0]
  v_pk_mul_f32 v[66:67], v[66:67], v[52:53] op_sel_hi:[1,0]
  v_pk_mul_f32 v[68:69], v[68:69], v[52:53] op_sel_hi:[1,0]
  v_pk_mul_f32 v[70:71], v[70:71], v[52:53] op_sel_hi:[1,0]
  v_mfma_f32_16x16x32_bf16 v[28:31], a[156:159], a[60:63], 0
  v_fma_f32 v18, v18, s24, v10
  v_mfma_f32_16x16x32_bf16 v[28:31], a[152:155], a[56:59], v[28:31]
  s_or_b64 s[30:31], s[30:31], vcc
  v_exp_f32 v18, v18
  v_cvt_pk_bf16_f32 v64, v64, v65
  v_cvt_pk_bf16_f32 v65, v66, v67
  v_cvt_pk_bf16_f32 v66, v68, v69
  v_cvt_pk_bf16_f32 v67, v70, v71
  v_pk_mul_f32 v[72:73], v[72:73], v[52:53] op_sel_hi:[1,0]
  v_pk_mul_f32 v[74:75], v[74:75], v[52:53] op_sel_hi:[1,0]
  v_pk_mul_f32 v[76:77], v[76:77], v[52:53] op_sel_hi:[1,0]
  v_pk_mul_f32 v[78:79], v[78:79], v[52:53] op_sel_hi:[1,0]
  v_mfma_f32_16x16x32_bf16 v[28:31], a[148:151], a[52:55], v[28:31]
  ds_write_b128 v62, v[64:67] offset:0
  v_fma_f32 v19, v19, s24, v10
  v_mfma_f32_16x16x32_bf16 v[28:31], a[144:147], a[48:51], v[28:31]
  v_exp_f32 v19, v19
  v_cvt_pk_bf16_f32 v72, v72, v73
  v_cvt_pk_bf16_f32 v73, v74, v75
  v_cvt_pk_bf16_f32 v74, v76, v77
  v_cvt_pk_bf16_f32 v75, v78, v79
  v_pk_mul_f32 v[80:81], v[80:81], v[52:53] op_sel_hi:[1,0]
  v_pk_mul_f32 v[82:83], v[82:83], v[52:53] op_sel_hi:[1,0]
  v_pk_mul_f32 v[84:85], v[84:85], v[52:53] op_sel_hi:[1,0]
  v_pk_mul_f32 v[86:87], v[86:87], v[52:53] op_sel_hi:[1,0]
  v_mfma_f32_16x16x32_bf16 v[96:99], a[192:195], v[36:39], v[96:99]
  ds_write_b128 v62, v[72:75] offset:1024
  v_fma_f32 v20, v20, s24, v10
  v_cvt_pk_bf16_f32 v32, v16, v17
  v_mfma_f32_16x16x32_bf16 v[100:103], a[196:199], v[36:39], v[100:103]
  v_exp_f32 v20, v20
  v_cvt_pk_bf16_f32 v80, v80, v81
  v_cvt_pk_bf16_f32 v81, v82, v83
  v_cvt_pk_bf16_f32 v82, v84, v85
  v_cvt_pk_bf16_f32 v83, v86, v87
  v_pk_mul_f32 v[88:89], v[88:89], v[52:53] op_sel_hi:[1,0]
  v_pk_mul_f32 v[90:91], v[90:91], v[52:53] op_sel_hi:[1,0]
  v_pk_mul_f32 v[92:93], v[92:93], v[52:53] op_sel_hi:[1,0]
  v_pk_mul_f32 v[94:95], v[94:95], v[52:53] op_sel_hi:[1,0]
  v_mfma_f32_16x16x32_bf16 v[104:107], a[200:203], v[36:39], v[104:107]
  ds_write_b128 v62, v[80:83] offset:2048
  v_fma_f32 v21, v21, s24, v10
  v_cvt_pk_bf16_f32 v33, v18, v19
  v_mfma_f32_16x16x32_bf16 v[108:111], a[204:207], v[36:39], v[108:111]
  v_exp_f32 v21, v21
  v_cvt_pk_bf16_f32 v88, v88, v89
  v_cvt_pk_bf16_f32 v89, v90, v91
  v_cvt_pk_bf16_f32 v90, v92, v93
  v_cvt_pk_bf16_f32 v91, v94, v95
  v_mfma_f32_16x16x32_bf16 v[112:115], a[208:211], v[36:39], v[112:115]
  ds_write_b128 v62, v[88:91] offset:3072
  v_fma_f32 v22, v22, s24, v10
  v_fma_f32 v23, v23, s24, v10
  v_mfma_f32_16x16x32_bf16 v[116:119], a[212:215], v[36:39], v[116:119]
  v_exp_f32 v22, v22
  v_mfma_f32_16x16x32_bf16 v[120:123], a[216:219], v[36:39], v[120:123]
  v_exp_f32 v23, v23
  v_mfma_f32_16x16x32_bf16 v[124:127], a[220:223], v[36:39], v[124:127]
  v_cvt_pk_bf16_f32 v34, v20, v21
  v_cvt_pk_bf16_f32 v35, v22, v23
  v_mfma_f32_16x16x32_bf16 v[16:19], a[96:99], a[32:35], 0
  ds_read_b128 a[128:131], v1 offset:18432
  v_fma_f32 v24, v24, s24, v11
  v_mfma_f32_16x16x32_bf16 v[16:19], a[100:103], a[36:39], v[16:19]
  v_exp_f32 v24, v24
  v_mfma_f32_16x16x32_bf16 v[16:19], a[104:107], a[40:43], v[16:19]
  ds_read_b128 a[132:135], v1 offset:18688
  v_fma_f32 v25, v25, s24, v11
  v_mfma_f32_16x16x32_bf16 v[16:19], a[108:111], a[44:47], v[16:19]
  ds_read_b128 a[228:231], v63 offset:0
  v_exp_f32 v25, v25
  v_add_f32 v53, v42, v43
  v_rcp_f32 v52, v53
  v_cmp_ngt_f32 vcc, s26, v53
  v_pk_mul_f32 v[96:97], v[96:97], v[52:53] op_sel_hi:[1,0]
  v_pk_mul_f32 v[98:99], v[98:99], v[52:53] op_sel_hi:[1,0]
  v_pk_mul_f32 v[100:101], v[100:101], v[52:53] op_sel_hi:[1,0]
  v_pk_mul_f32 v[102:103], v[102:103], v[52:53] op_sel_hi:[1,0]
  v_mfma_f32_16x16x32_bf16 v[20:23], a[124:127], a[44:47], 0
  ds_read_b128 a[136:139], v1 offset:18944
  v_fma_f32 v26, v26, s24, v11
  v_mfma_f32_16x16x32_bf16 v[20:23], a[120:123], a[40:43], v[20:23]
  s_or_b64 s[30:31], s[30:31], vcc
  v_exp_f32 v26, v26
  v_cvt_pk_bf16_f32 v96, v96, v97
  v_cvt_pk_bf16_f32 v97, v98, v99
  v_cvt_pk_bf16_f32 v98, v100, v101
  v_cvt_pk_bf16_f32 v99, v102, v103
  v_pk_mul_f32 v[104:105], v[104:105], v[52:53] op_sel_hi:[1,0]
  v_pk_mul_f32 v[106:107], v[106:107], v[52:53] op_sel_hi:[1,0]
  v_pk_mul_f32 v[108:109], v[108:109], v[52:53] op_sel_hi:[1,0]
  v_pk_mul_f32 v[110:111], v[110:111], v[52:53] op_sel_hi:[1,0]
  v_mfma_f32_16x16x32_bf16 v[20:23], a[116:119], a[36:39], v[20:23]
  ds_read_b128 a[140:143], v1 offset:19200
  ds_write_b128 v62, v[96:99] offset:4096
  v_fma_f32 v27, v27, s24, v11
  v_mfma_f32_16x16x32_bf16 v[20:23], a[112:115], a[32:35], v[20:23]
  v_exp_f32 v27, v27
  v_cvt_pk_bf16_f32 v104, v104, v105
  v_cvt_pk_bf16_f32 v105, v106, v107
  v_cvt_pk_bf16_f32 v106, v108, v109
  v_cvt_pk_bf16_f32 v107, v110, v111
  v_pk_mul_f32 v[112:113], v[112:113], v[52:53] op_sel_hi:[1,0]
  v_pk_mul_f32 v[114:115], v[114:115], v[52:53] op_sel_hi:[1,0]
  v_pk_mul_f32 v[116:117], v[116:117], v[52:53] op_sel_hi:[1,0]
  v_pk_mul_f32 v[118:119], v[118:119], v[52:53] op_sel_hi:[1,0]
  v_mfma_f32_16x16x32_bf16 v[128:131], a[192:195], v[32:35], v[128:131]
  s_waitcnt lgkmcnt(3)
  ds_write_b128 v62, v[104:107] offset:5120
  v_fma_f32 v28, v28, s24, v11
  v_cvt_pk_bf16_f32 v36, v24, v25
  v_mfma_f32_16x16x32_bf16 v[132:135], a[196:199], v[32:35], v[132:135]
  buffer_store_dwordx4 a[228:231], v6, s[16:19], s40 offen sc1
  ds_read_b128 a[232:235], v63 offset:512
  v_exp_f32 v28, v28
  v_cvt_pk_bf16_f32 v112, v112, v113
  v_cvt_pk_bf16_f32 v113, v114, v115
  v_cvt_pk_bf16_f32 v114, v116, v117
  v_cvt_pk_bf16_f32 v115, v118, v119
  v_pk_mul_f32 v[120:121], v[120:121], v[52:53] op_sel_hi:[1,0]
  v_pk_mul_f32 v[122:123], v[122:123], v[52:53] op_sel_hi:[1,0]
  v_pk_mul_f32 v[124:125], v[124:125], v[52:53] op_sel_hi:[1,0]
  v_pk_mul_f32 v[126:127], v[126:127], v[52:53] op_sel_hi:[1,0]
  v_mfma_f32_16x16x32_bf16 v[136:139], a[200:203], v[32:35], v[136:139]
  ds_write_b128 v62, v[112:115] offset:6144
  v_fma_f32 v29, v29, s24, v11
  v_cvt_pk_bf16_f32 v37, v26, v27
  v_mfma_f32_16x16x32_bf16 v[140:143], a[204:207], v[32:35], v[140:143]
  v_exp_f32 v29, v29
  v_cvt_pk_bf16_f32 v120, v120, v121
  v_cvt_pk_bf16_f32 v121, v122, v123
  v_cvt_pk_bf16_f32 v122, v124, v125
  v_cvt_pk_bf16_f32 v123, v126, v127
  v_mfma_f32_16x16x32_bf16 v[144:147], a[208:211], v[32:35], v[144:147]
  ds_write_b128 v62, v[120:123] offset:7168
  v_fma_f32 v30, v30, s24, v11
  v_fma_f32 v31, v31, s24, v11
  v_mfma_f32_16x16x32_bf16 v[148:151], a[212:215], v[32:35], v[148:151]
  v_exp_f32 v30, v30
  v_mfma_f32_16x16x32_bf16 v[152:155], a[216:219], v[32:35], v[152:155]
  v_exp_f32 v31, v31
  v_mfma_f32_16x16x32_bf16 v[156:159], a[220:223], v[32:35], v[156:159]
  v_cvt_pk_bf16_f32 v38, v28, v29
  v_cvt_pk_bf16_f32 v39, v30, v31
  v_mfma_f32_16x16x32_bf16 v[24:27], a[96:99], a[48:51], 0
  s_waitcnt lgkmcnt(2)
  ds_read_b128 a[144:147], v1 offset:26624
  v_fma_f32 v16, v16, s24, v10
  v_smfmac_f32_16x16x64_bf16 v[44:47], a[224:227], v[32:39], v7
  v_mfma_f32_16x16x32_bf16 v[24:27], a[100:103], a[52:55], v[24:27]
  buffer_store_dwordx4 a[232:235], v6, s[16:19], s40 offen offset:2048 sc1
  ds_read_b128 a[236:239], v63 offset:2048
  v_exp_f32 v16, v16
  v_mfma_f32_16x16x32_bf16 v[24:27], a[104:107], a[56:59], v[24:27]
  ds_read_b128 a[148:151], v1 offset:26880
  v_fma_f32 v17, v17, s24, v10
  v_mfma_f32_16x16x32_bf16 v[24:27], a[108:111], a[60:63], v[24:27]
  v_exp_f32 v17, v17
  v_mfma_f32_16x16x32_bf16 v[28:31], a[124:127], a[60:63], 0
  ds_read_b128 a[152:155], v1 offset:27136
  v_fma_f32 v18, v18, s24, v10
  v_mfma_f32_16x16x32_bf16 v[28:31], a[120:123], a[56:59], v[28:31]
  v_exp_f32 v18, v18
  v_mfma_f32_16x16x32_bf16 v[28:31], a[116:119], a[52:55], v[28:31]
  ds_read_b128 a[156:159], v1 offset:27392
  v_fma_f32 v19, v19, s24, v10
  v_mfma_f32_16x16x32_bf16 v[28:31], a[112:115], a[48:51], v[28:31]
  v_exp_f32 v19, v19
  v_mfma_f32_16x16x32_bf16 v[160:163], a[192:195], v[36:39], v[160:163]
  v_fma_f32 v20, v20, s24, v10
  v_cvt_pk_bf16_f32 v32, v16, v17
  v_mfma_f32_16x16x32_bf16 v[164:167], a[196:199], v[36:39], v[164:167]
  v_exp_f32 v20, v20
  v_mfma_f32_16x16x32_bf16 v[168:171], a[200:203], v[36:39], v[168:171]
  v_fma_f32 v21, v21, s24, v10
  v_cvt_pk_bf16_f32 v33, v18, v19
  v_mfma_f32_16x16x32_bf16 v[172:175], a[204:207], v[36:39], v[172:175]
  v_exp_f32 v21, v21
  v_mfma_f32_16x16x32_bf16 v[176:179], a[208:211], v[36:39], v[176:179]
  s_waitcnt lgkmcnt(3)
  v_fma_f32 v22, v22, s24, v10
  v_fma_f32 v23, v23, s24, v10
  v_mfma_f32_16x16x32_bf16 v[180:183], a[212:215], v[36:39], v[180:183]
  buffer_store_dwordx4 a[236:239], v6, s[16:19], s40 offen offset:128 sc1
  ds_read_b128 a[240:243], v63 offset:2560
  v_exp_f32 v22, v22
  v_mfma_f32_16x16x32_bf16 v[184:187], a[216:219], v[36:39], v[184:187]
  v_exp_f32 v23, v23
  v_mfma_f32_16x16x32_bf16 v[188:191], a[220:223], v[36:39], v[188:191]
  s_waitcnt lgkmcnt(1)
  v_cvt_pk_bf16_f32 v34, v20, v21
  v_cvt_pk_bf16_f32 v35, v22, v23
  v_mfma_f32_16x16x32_bf16 v[16:19], a[128:131], a[32:35], 0
  ds_read_b64_tr_b16 a[192:193], v2 offset:16384
  v_fma_f32 v24, v24, s24, v11
  v_mfma_f32_16x16x32_bf16 v[16:19], a[132:135], a[36:39], v[16:19]
  ds_read_b64_tr_b16 a[194:195], v2 offset:24576
  v_exp_f32 v24, v24
  v_mfma_f32_16x16x32_bf16 v[16:19], a[136:139], a[40:43], v[16:19]
  ds_read_b64_tr_b16 a[196:197], v2 offset:16392
  v_fma_f32 v25, v25, s24, v11
  v_mfma_f32_16x16x32_bf16 v[16:19], a[140:143], a[44:47], v[16:19]
  ds_read_b64_tr_b16 a[198:199], v2 offset:24584
  v_exp_f32 v25, v25
  v_mfma_f32_16x16x32_bf16 v[20:23], a[156:159], a[44:47], 0
  ds_read_b64_tr_b16 a[200:201], v2 offset:16640
  v_fma_f32 v26, v26, s24, v11
  v_mfma_f32_16x16x32_bf16 v[20:23], a[152:155], a[40:43], v[20:23]
  ds_read_b64_tr_b16 a[202:203], v2 offset:24832
  v_exp_f32 v26, v26
  v_mfma_f32_16x16x32_bf16 v[20:23], a[148:151], a[36:39], v[20:23]
  ds_read_b64_tr_b16 a[204:205], v2 offset:16648
  v_fma_f32 v27, v27, s24, v11
  v_mfma_f32_16x16x32_bf16 v[20:23], a[144:147], a[32:35], v[20:23]
  ds_read_b64_tr_b16 a[206:207], v2 offset:24840
  v_exp_f32 v27, v27
  v_mfma_f32_16x16x32_bf16 v[128:131], a[160:163], v[32:35], v[128:131]
  s_waitcnt lgkmcnt(8)
  v_fma_f32 v28, v28, s24, v11
  v_cvt_pk_bf16_f32 v36, v24, v25
  v_mfma_f32_16x16x32_bf16 v[132:135], a[164:167], v[32:35], v[132:135]
  buffer_store_dwordx4 a[240:243], v6, s[16:19], s40 offen offset:2176 sc1
  ds_read_b128 a[244:247], v63 offset:4096
  v_exp_f32 v28, v28
  v_mfma_f32_16x16x32_bf16 v[136:139], a[168:171], v[32:35], v[136:139]
  v_fma_f32 v29, v29, s24, v11
  v_cvt_pk_bf16_f32 v37, v26, v27
  v_mfma_f32_16x16x32_bf16 v[140:143], a[172:175], v[32:35], v[140:143]
  v_exp_f32 v29, v29
  v_mfma_f32_16x16x32_bf16 v[144:147], a[176:179], v[32:35], v[144:147]
  v_fma_f32 v30, v30, s24, v11
  v_fma_f32 v31, v31, s24, v11
  v_mfma_f32_16x16x32_bf16 v[148:151], a[180:183], v[32:35], v[148:151]
  v_exp_f32 v30, v30
  v_mfma_f32_16x16x32_bf16 v[152:155], a[184:187], v[32:35], v[152:155]
  v_exp_f32 v31, v31
  v_mfma_f32_16x16x32_bf16 v[156:159], a[188:191], v[32:35], v[156:159]
  v_cvt_pk_bf16_f32 v38, v28, v29
  v_cvt_pk_bf16_f32 v39, v30, v31
  v_mfma_f32_16x16x32_bf16 v[24:27], a[128:131], a[48:51], 0
  ds_read_b64_tr_b16 a[208:209], v2 offset:16896
  v_fma_f32 v16, v16, s24, v10
  v_smfmac_f32_16x16x64_bf16 v[44:47], a[224:227], v[32:39], v7
  v_mfma_f32_16x16x32_bf16 v[24:27], a[132:135], a[52:55], v[24:27]
  ds_read_b64_tr_b16 a[210:211], v2 offset:25088
  v_exp_f32 v16, v16
  v_mfma_f32_16x16x32_bf16 v[24:27], a[136:139], a[56:59], v[24:27]
  ds_read_b64_tr_b16 a[212:213], v2 offset:16904
  v_fma_f32 v17, v17, s24, v10
  v_mfma_f32_16x16x32_bf16 v[24:27], a[140:143], a[60:63], v[24:27]
  ds_read_b64_tr_b16 a[214:215], v2 offset:25096
  v_exp_f32 v17, v17
  v_mfma_f32_16x16x32_bf16 v[28:31], a[156:159], a[60:63], 0
  s_waitcnt lgkmcnt(4)
  ds_read_b64_tr_b16 a[216:217], v2 offset:17152
  v_fma_f32 v18, v18, s24, v10
  v_mfma_f32_16x16x32_bf16 v[28:31], a[152:155], a[56:59], v[28:31]
  buffer_store_dwordx4 a[244:247], v6, s[16:19], s41 offen sc1
  ds_read_b64_tr_b16 a[218:219], v2 offset:25344
  ds_read_b128 a[248:251], v63 offset:4608
  v_exp_f32 v18, v18
  v_mfma_f32_16x16x32_bf16 v[28:31], a[148:151], a[52:55], v[28:31]
  ds_read_b64_tr_b16 a[220:221], v2 offset:17160
  v_fma_f32 v19, v19, s24, v10
  v_mfma_f32_16x16x32_bf16 v[28:31], a[144:147], a[48:51], v[28:31]
  ds_read_b64_tr_b16 a[222:223], v2 offset:25352
  v_exp_f32 v19, v19
  v_mfma_f32_16x16x32_bf16 v[160:163], a[160:163], v[36:39], v[160:163]
  v_fma_f32 v20, v20, s24, v10
  v_cvt_pk_bf16_f32 v32, v16, v17
  v_mfma_f32_16x16x32_bf16 v[164:167], a[164:167], v[36:39], v[164:167]
  v_exp_f32 v20, v20
  v_mfma_f32_16x16x32_bf16 v[168:171], a[168:171], v[36:39], v[168:171]
  v_fma_f32 v21, v21, s24, v10
  v_cvt_pk_bf16_f32 v33, v18, v19
  v_mfma_f32_16x16x32_bf16 v[172:175], a[172:175], v[36:39], v[172:175]
  v_exp_f32 v21, v21
  v_mfma_f32_16x16x32_bf16 v[176:179], a[176:179], v[36:39], v[176:179]
  v_fma_f32 v22, v22, s24, v10
  v_fma_f32 v23, v23, s24, v10
  v_mfma_f32_16x16x32_bf16 v[180:183], a[180:183], v[36:39], v[180:183]
  v_exp_f32 v22, v22
  v_mfma_f32_16x16x32_bf16 v[184:187], a[184:187], v[36:39], v[184:187]
  v_exp_f32 v23, v23
  v_mfma_f32_16x16x32_bf16 v[188:191], a[188:191], v[36:39], v[188:191]
  v_cvt_pk_bf16_f32 v34, v20, v21
  v_cvt_pk_bf16_f32 v35, v22, v23
  v_mfma_f32_16x16x32_bf16 v[16:19], a[128:131], a[64:67], 0
  s_waitcnt lgkmcnt(2)
  v_fma_f32 v24, v24, s24, v11
  v_mfma_f32_16x16x32_bf16 v[16:19], a[132:135], a[68:71], v[16:19]
  buffer_store_dwordx4 a[248:251], v6, s[16:19], s41 offen offset:2048 sc1
  ds_read_b128 a[228:231], v63 offset:6144
  v_exp_f32 v24, v24
  v_mfma_f32_16x16x32_bf16 v[16:19], a[136:139], a[72:75], v[16:19]
  v_fma_f32 v25, v25, s24, v11
  v_mfma_f32_16x16x32_bf16 v[16:19], a[140:143], a[76:79], v[16:19]
  v_exp_f32 v25, v25
  v_mfma_f32_16x16x32_bf16 v[20:23], a[156:159], a[76:79], 0
  v_fma_f32 v26, v26, s24, v11
  v_mfma_f32_16x16x32_bf16 v[20:23], a[152:155], a[72:75], v[20:23]
  v_exp_f32 v26, v26
  v_mfma_f32_16x16x32_bf16 v[20:23], a[148:151], a[68:71], v[20:23]
L_pad11:
  s_cbranch_execz L_padret
  v_fma_f32 v27, v27, s24, v11
  v_mfma_f32_16x16x32_bf16 v[20:23], a[144:147], a[64:67], v[20:23]
  s_waitcnt lgkmcnt(1)
  v_exp_f32 v27, v27
  v_mfma_f32_16x16x32_bf16 v[128:131], a[192:195], v[32:35], v[128:131]
  v_fma_f32 v28, v28, s24, v11
  v_cvt_pk_bf16_f32 v36, v24, v25
  v_mfma_f32_16x16x32_bf16 v[132:135], a[196:199], v[32:35], v[132:135]
  v_exp_f32 v28, v28
  v_mfma_f32_16x16x32_bf16 v[136:139], a[200:203], v[32:35], v[136:139]
  v_fma_f32 v29, v29, s24, v11
  v_cvt_pk_bf16_f32 v37, v26, v27
  v_mfma_f32_16x16x32_bf16 v[140:143], a[204:207], v[32:35], v[140:143]
  v_exp_f32 v29, v29
  v_mfma_f32_16x16x32_bf16 v[144:147], a[208:211], v[32:35], v[144:147]
  s_waitcnt lgkmcnt(0)
  v_fma_f32 v30, v30, s24, v11
  v_fma_f32 v31, v31, s24, v11
  v_mfma_f32_16x16x32_bf16 v[148:151], a[212:215], v[32:35], v[148:151]
  buffer_store_dwordx4 a[228:231], v6, s[16:19], s41 offen offset:128 sc1
  ds_read_b128 a[232:235], v63 offset:6656
  v_exp_f32 v30, v30
  v_mfma_f32_16x16x32_bf16 v[152:155], a[216:219], v[32:35], v[152:155]
  v_exp_f32 v31, v31
  v_mfma_f32_16x16x32_bf16 v[156:159], a[220:223], v[32:35], v[156:159]
  v_cvt_pk_bf16_f32 v38, v28, v29
  v_cvt_pk_bf16_f32 v39, v30, v31
  v_mfma_f32_16x16x32_bf16 v[24:27], a[128:131], a[80:83], 0
  v_fma_f32 v16, v16, s24, v12
  v_smfmac_f32_16x16x64_bf16 v[44:47], a[224:227], v[32:39], v7
  v_mfma_f32_16x16x32_bf16 v[24:27], a[132:135], a[84:87], v[24:27]
  v_exp_f32 v16, v16
  v_mfma_f32_16x16x32_bf16 v[24:27], a[136:139], a[88:91], v[24:27]
  v_fma_f32 v17, v17, s24, v12
  v_mfma_f32_16x16x32_bf16 v[24:27], a[140:143], a[92:95], v[24:27]
  v_exp_f32 v17, v17
  s_nop 1
  v_add_f32 v53, v44, v45
  v_rcp_f32 v52, v53
  v_cmp_ngt_f32 vcc, s26, v53
  v_pk_mul_f32 v[128:129], v[128:129], v[52:53] op_sel_hi:[1,0]
  v_pk_mul_f32 v[130:131], v[130:131], v[52:53] op_sel_hi:[1,0]
  v_pk_mul_f32 v[132:133], v[132:133], v[52:53] op_sel_hi:[1,0]
  v_pk_mul_f32 v[134:135], v[134:135], v[52:53] op_sel_hi:[1,0]
  v_mfma_f32_16x16x32_bf16 v[28:31], a[156:159], a[92:95], 0
  v_fma_f32 v18, v18, s24, v12
  v_mfma_f32_16x16x32_bf16 v[28:31], a[152:155], a[88:91], v[28:31]
  s_or_b64 s[30:31], s[30:31], vcc
  v_exp_f32 v18, v18
  v_cvt_pk_bf16_f32 v128, v128, v129
  v_cvt_pk_bf16_f32 v129, v130, v131
  v_cvt_pk_bf16_f32 v130, v132, v133
  v_cvt_pk_bf16_f32 v131, v134, v135
  v_pk_mul_f32 v[136:137], v[136:137], v[52:53] op_sel_hi:[1,0]
  v_pk_mul_f32 v[138:139], v[138:139], v[52:53] op_sel_hi:[1,0]
  v_pk_mul_f32 v[140:141], v[140:141], v[52:53] op_sel_hi:[1,0]
  v_pk_mul_f32 v[142:143], v[142:143], v[52:53] op_sel_hi:[1,0]
  v_mfma_f32_16x16x32_bf16 v[28:31], a[148:151], a[84:87], v[28:31]
  ds_write_b128 v62, v[128:131] offset:8192
  v_fma_f32 v19, v19, s24, v12
  v_mfma_f32_16x16x32_bf16 v[28:31], a[144:147], a[80:83], v[28:31]
  v_exp_f32 v19, v19
  v_cvt_pk_bf16_f32 v136, v136, v137
  v_cvt_pk_bf16_f32 v137, v138, v139
  v_cvt_pk_bf16_f32 v138, v140, v141
  v_cvt_pk_bf16_f32 v139, v142, v143
  v_pk_mul_f32 v[144:145], v[144:145], v[52:53] op_sel_hi:[1,0]
  v_pk_mul_f32 v[146:147], v[146:147], v[52:53] op_sel_hi:[1,0]
  v_pk_mul_f32 v[148:149], v[148:149], v[52:53] op_sel_hi:[1,0]
  v_pk_mul_f32 v[150:151], v[150:151], v[52:53] op_sel_hi:[1,0]
  v_mfma_f32_16x16x32_bf16 v[160:163], a[192:195], v[36:39], v[160:163]
  s_waitcnt lgkmcnt(1)
  ds_write_b128 v62, v[136:139] offset:9216
  v_fma_f32 v20, v20, s24, v12
  v_cvt_pk_bf16_f32 v32, v16, v17
  v_mfma_f32_16x16x32_bf16 v[164:167], a[196:199], v[36:39], v[164:167]
  buffer_store_dwordx4 a[232:235], v6, s[16:19], s41 offen offset:2176 sc1
  v_exp_f32 v20, v20
  v_cvt_pk_bf16_f32 v144, v144, v145
  v_cvt_pk_bf16_f32 v145, v146, v147
  v_cvt_pk_bf16_f32 v146, v148, v149
  v_cvt_pk_bf16_f32 v147, v150, v151
  v_pk_mul_f32 v[152:153], v[152:153], v[52:53] op_sel_hi:[1,0]
  v_pk_mul_f32 v[154:155], v[154:155], v[52:53] op_sel_hi:[1,0]
  v_pk_mul_f32 v[156:157], v[156:157], v[52:53] op_sel_hi:[1,0]
  v_pk_mul_f32 v[158:159], v[158:159], v[52:53] op_sel_hi:[1,0]
  v_mfma_f32_16x16x32_bf16 v[168:171], a[200:203], v[36:39], v[168:171]
  ds_write_b128 v62, v[144:147] offset:10240
  v_fma_f32 v21, v21, s24, v12
  v_cvt_pk_bf16_f32 v33, v18, v19
  v_mfma_f32_16x16x32_bf16 v[172:175], a[204:207], v[36:39], v[172:175]
  v_exp_f32 v21, v21
  v_cvt_pk_bf16_f32 v152, v152, v153
  v_cvt_pk_bf16_f32 v153, v154, v155
  v_cvt_pk_bf16_f32 v154, v156, v157
  v_cvt_pk_bf16_f32 v155, v158, v159
  v_mfma_f32_16x16x32_bf16 v[176:179], a[208:211], v[36:39], v[176:179]
  ds_write_b128 v62, v[152:155] offset:11264
  v_fma_f32 v22, v22, s24, v12
  v_fma_f32 v23, v23, s24, v12
  v_mfma_f32_16x16x32_bf16 v[180:183], a[212:215], v[36:39], v[180:183]
  v_exp_f32 v22, v22
  v_mfma_f32_16x16x32_bf16 v[184:187], a[216:219], v[36:39], v[184:187]
  ds_read_b128 a[236:239], v63 offset:8192
  v_exp_f32 v23, v23
  v_mfma_f32_16x16x32_bf16 v[188:191], a[220:223], v[36:39], v[188:191]
  v_cvt_pk_bf16_f32 v34, v20, v21
  v_cvt_pk_bf16_f32 v35, v22, v23
  v_mfma_f32_16x16x32_bf16 v[16:19], a[96:99], a[64:67], 0
  ds_read_b128 a[128:131], v1 offset:51200
  v_fma_f32 v24, v24, s24, v13
  v_mfma_f32_16x16x32_bf16 v[16:19], a[100:103], a[68:71], v[16:19]
  v_exp_f32 v24, v24
  v_mfma_f32_16x16x32_bf16 v[16:19], a[104:107], a[72:75], v[16:19]
  ds_read_b128 a[132:135], v1 offset:51456
  v_fma_f32 v25, v25, s24, v13
  v_mfma_f32_16x16x32_bf16 v[16:19], a[108:111], a[76:79], v[16:19]
  v_exp_f32 v25, v25
  v_add_f32 v53, v46, v47
  v_rcp_f32 v52, v53
  v_cmp_ngt_f32 vcc, s26, v53
  v_pk_mul_f32 v[160:161], v[160:161], v[52:53] op_sel_hi:[1,0]
  v_pk_mul_f32 v[162:163], v[162:163], v[52:53] op_sel_hi:[1,0]
  v_pk_mul_f32 v[164:165], v[164:165], v[52:53] op_sel_hi:[1,0]
  v_pk_mul_f32 v[166:167], v[166:167], v[52:53] op_sel_hi:[1,0]
  v_mfma_f32_16x16x32_bf16 v[20:23], a[124:127], a[76:79], 0
  ds_read_b128 a[136:139], v1 offset:51712
  v_fma_f32 v26, v26, s24, v13
  v_mfma_f32_16x16x32_bf16 v[20:23], a[120:123], a[72:75], v[20:23]
  s_or_b64 s[30:31], s[30:31], vcc
  v_exp_f32 v26, v26
  v_cvt_pk_bf16_f32 v160, v160, v161
  v_cvt_pk_bf16_f32 v161, v162, v163
  v_cvt_pk_bf16_f32 v162, v164, v165
  v_cvt_pk_bf16_f32 v163, v166, v167
  v_pk_mul_f32 v[168:169], v[168:169], v[52:53] op_sel_hi:[1,0]
  v_pk_mul_f32 v[170:171], v[170:171], v[52:53] op_sel_hi:[1,0]
  v_pk_mul_f32 v[172:173], v[172:173], v[52:53] op_sel_hi:[1,0]
  v_pk_mul_f32 v[174:175], v[174:175], v[52:53] op_sel_hi:[1,0]
  v_mfma_f32_16x16x32_bf16 v[20:23], a[116:119], a[68:71], v[20:23]
  ds_read_b128 a[140:143], v1 offset:51968
  ds_write_b128 v62, v[160:163] offset:12288
  v_fma_f32 v27, v27, s24, v13
  v_mfma_f32_16x16x32_bf16 v[20:23], a[112:115], a[64:67], v[20:23]
  v_exp_f32 v27, v27
  v_cvt_pk_bf16_f32 v168, v168, v169
  v_cvt_pk_bf16_f32 v169, v170, v171
  v_cvt_pk_bf16_f32 v170, v172, v173
  v_cvt_pk_bf16_f32 v171, v174, v175
  v_pk_mul_f32 v[176:177], v[176:177], v[52:53] op_sel_hi:[1,0]
  v_pk_mul_f32 v[178:179], v[178:179], v[52:53] op_sel_hi:[1,0]
  v_pk_mul_f32 v[180:181], v[180:181], v[52:53] op_sel_hi:[1,0]
  v_pk_mul_f32 v[182:183], v[182:183], v[52:53] op_sel_hi:[1,0]
  v_mfma_f32_16x16x32_bf16 v[192:195], a[192:195], v[32:35], v[192:195]
  s_waitcnt lgkmcnt(5)
  ds_write_b128 v62, v[168:171] offset:13312
  v_fma_f32 v28, v28, s24, v13
  v_cvt_pk_bf16_f32 v36, v24, v25
  v_mfma_f32_16x16x32_bf16 v[196:199], a[196:199], v[32:35], v[196:199]
  buffer_store_dwordx4 a[236:239], v6, s[16:19], s42 offen sc1
  ds_read_b128 a[240:243], v63 offset:8704
  v_exp_f32 v28, v28
  v_cvt_pk_bf16_f32 v176, v176, v177
  v_cvt_pk_bf16_f32 v177, v178, v179
  v_cvt_pk_bf16_f32 v178, v180, v181
  v_cvt_pk_bf16_f32 v179, v182, v183
  v_pk_mul_f32 v[184:185], v[184:185], v[52:53] op_sel_hi:[1,0]
  v_pk_mul_f32 v[186:187], v[186:187], v[52:53] op_sel_hi:[1,0]
  v_pk_mul_f32 v[188:189], v[188:189], v[52:53] op_sel_hi:[1,0]
  v_pk_mul_f32 v[190:191], v[190:191], v[52:53] op_sel_hi:[1,0]
  v_mfma_f32_16x16x32_bf16 v[200:203], a[200:203], v[32:35], v[200:203]
  ds_write_b128 v62, v[176:179] offset:14336
  v_fma_f32 v29, v29, s24, v13
  v_cvt_pk_bf16_f32 v37, v26, v27
  v_mfma_f32_16x16x32_bf16 v[204:207], a[204:207], v[32:35], v[204:207]
  v_exp_f32 v29, v29
  v_cvt_pk_bf16_f32 v184, v184, v185
  v_cvt_pk_bf16_f32 v185, v186, v187
  v_cvt_pk_bf16_f32 v186, v188, v189
  v_cvt_pk_bf16_f32 v187, v190, v191
  v_mfma_f32_16x16x32_bf16 v[208:211], a[208:211], v[32:35], v[208:211]
  ds_write_b128 v62, v[184:187] offset:15360
  v_fma_f32 v30, v30, s24, v13
  v_fma_f32 v31, v31, s24, v13
  v_mfma_f32_16x16x32_bf16 v[212:215], a[212:215], v[32:35], v[212:215]
  v_exp_f32 v30, v30
  v_mfma_f32_16x16x32_bf16 v[216:219], a[216:219], v[32:35], v[216:219]
  v_exp_f32 v31, v31
  v_mfma_f32_16x16x32_bf16 v[220:223], a[220:223], v[32:35], v[220:223]
  v_cvt_pk_bf16_f32 v38, v28, v29
  v_cvt_pk_bf16_f32 v39, v30, v31
  v_mfma_f32_16x16x32_bf16 v[24:27], a[96:99], a[80:83], 0
  s_waitcnt lgkmcnt(2)
  ds_read_b128 a[144:147], v1 offset:59392
  v_fma_f32 v16, v16, s24, v12
  v_smfmac_f32_16x16x64_bf16 v[48:51], a[224:227], v[32:39], v7
  v_mfma_f32_16x16x32_bf16 v[24:27], a[100:103], a[84:87], v[24:27]
  buffer_store_dwordx4 a[240:243], v6, s[16:19], s42 offen offset:2048 sc1
  ds_read_b128 a[244:247], v63 offset:10240
  v_exp_f32 v16, v16
  v_mfma_f32_16x16x32_bf16 v[24:27], a[104:107], a[88:91], v[24:27]
  ds_read_b128 a[148:151], v1 offset:59648
  v_fma_f32 v17, v17, s24, v12
  v_mfma_f32_16x16x32_bf16 v[24:27], a[108:111], a[92:95], v[24:27]
  v_exp_f32 v17, v17
  v_mfma_f32_16x16x32_bf16 v[28:31], a[124:127], a[92:95], 0
  ds_read_b128 a[152:155], v1 offset:59904
  v_fma_f32 v18, v18, s24, v12
  v_mfma_f32_16x16x32_bf16 v[28:31], a[120:123], a[88:91], v[28:31]
  v_exp_f32 v18, v18
  v_mfma_f32_16x16x32_bf16 v[28:31], a[116:119], a[84:87], v[28:31]
  ds_read_b128 a[156:159], v1 offset:60160
  v_fma_f32 v19, v19, s24, v12
  v_mfma_f32_16x16x32_bf16 v[28:31], a[112:115], a[80:83], v[28:31]
  v_exp_f32 v19, v19
  v_mfma_f32_16x16x32_bf16 v[224:227], a[192:195], v[36:39], v[224:227]
  v_fma_f32 v20, v20, s24, v12
  v_cvt_pk_bf16_f32 v32, v16, v17
  v_mfma_f32_16x16x32_bf16 v[228:231], a[196:199], v[36:39], v[228:231]
  v_exp_f32 v20, v20
  v_mfma_f32_16x16x32_bf16 v[232:235], a[200:203], v[36:39], v[232:235]
  v_fma_f32 v21, v21, s24, v12
  v_cvt_pk_bf16_f32 v33, v18, v19
  v_mfma_f32_16x16x32_bf16 v[236:239], a[204:207], v[36:39], v[236:239]
  v_exp_f32 v21, v21
  v_mfma_f32_16x16x32_bf16 v[240:243], a[208:211], v[36:39], v[240:243]
  s_waitcnt lgkmcnt(3)
  v_fma_f32 v22, v22, s24, v12
  v_fma_f32 v23, v23, s24, v12
  v_mfma_f32_16x16x32_bf16 v[244:247], a[212:215], v[36:39], v[244:247]
  buffer_store_dwordx4 a[244:247], v6, s[16:19], s42 offen offset:128 sc1
  ds_read_b128 a[248:251], v63 offset:10752
  v_exp_f32 v22, v22
  v_mfma_f32_16x16x32_bf16 v[248:251], a[216:219], v[36:39], v[248:251]
  v_exp_f32 v23, v23
  v_mfma_f32_16x16x32_bf16 v[252:255], a[220:223], v[36:39], v[252:255]
  s_waitcnt lgkmcnt(1)
  v_cvt_pk_bf16_f32 v34, v20, v21
  v_cvt_pk_bf16_f32 v35, v22, v23
  v_mfma_f32_16x16x32_bf16 v[16:19], a[128:131], a[64:67], 0
  ds_read_b64_tr_b16 a[192:193], v2 offset:49152
  v_fma_f32 v24, v24, s24, v13
  v_mfma_f32_16x16x32_bf16 v[16:19], a[132:135], a[68:71], v[16:19]
  ds_read_b64_tr_b16 a[194:195], v2 offset:57344
  v_exp_f32 v24, v24
  v_mfma_f32_16x16x32_bf16 v[16:19], a[136:139], a[72:75], v[16:19]
  ds_read_b64_tr_b16 a[196:197], v2 offset:49160
  v_fma_f32 v25, v25, s24, v13
  v_mfma_f32_16x16x32_bf16 v[16:19], a[140:143], a[76:79], v[16:19]
  ds_read_b64_tr_b16 a[198:199], v2 offset:57352
  v_exp_f32 v25, v25
  v_mfma_f32_16x16x32_bf16 v[20:23], a[156:159], a[76:79], 0
  ds_read_b64_tr_b16 a[200:201], v2 offset:49408
  v_fma_f32 v26, v26, s24, v13
  v_mfma_f32_16x16x32_bf16 v[20:23], a[152:155], a[72:75], v[20:23]
  ds_read_b64_tr_b16 a[202:203], v2 offset:57600
  v_exp_f32 v26, v26
  v_mfma_f32_16x16x32_bf16 v[20:23], a[148:151], a[68:71], v[20:23]
  ds_read_b64_tr_b16 a[204:205], v2 offset:49416
  v_fma_f32 v27, v27, s24, v13
  v_mfma_f32_16x16x32_bf16 v[20:23], a[144:147], a[64:67], v[20:23]
  ds_read_b64_tr_b16 a[206:207], v2 offset:57608
  v_exp_f32 v27, v27
  v_mfma_f32_16x16x32_bf16 v[192:195], a[160:163], v[32:35], v[192:195]
  s_waitcnt lgkmcnt(8)
  v_fma_f32 v28, v28, s24, v13
  v_cvt_pk_bf16_f32 v36, v24, v25
  v_mfma_f32_16x16x32_bf16 v[196:199], a[164:167], v[32:35], v[196:199]
  buffer_store_dwordx4 a[248:251], v6, s[16:19], s42 offen offset:2176 sc1
  ds_read_b128 a[228:231], v63 offset:12288
  v_exp_f32 v28, v28
  v_mfma_f32_16x16x32_bf16 v[200:203], a[168:171], v[32:35], v[200:203]
  v_fma_f32 v29, v29, s24, v13
  v_cvt_pk_bf16_f32 v37, v26, v27
  v_mfma_f32_16x16x32_bf16 v[204:207], a[172:175], v[32:35], v[204:207]
  v_exp_f32 v29, v29
  v_mfma_f32_16x16x32_bf16 v[208:211], a[176:179], v[32:35], v[208:211]
  v_fma_f32 v30, v30, s24, v13
  v_fma_f32 v31, v31, s24, v13
  v_mfma_f32_16x16x32_bf16 v[212:215], a[180:183], v[32:35], v[212:215]
  v_exp_f32 v30, v30
  v_mfma_f32_16x16x32_bf16 v[216:219], a[184:187], v[32:35], v[216:219]
  v_exp_f32 v31, v31
  v_mfma_f32_16x16x32_bf16 v[220:223], a[188:191], v[32:35], v[220:223]
  v_cvt_pk_bf16_f32 v38, v28, v29
  v_cvt_pk_bf16_f32 v39, v30, v31
  v_mfma_f32_16x16x32_bf16 v[24:27], a[128:131], a[80:83], 0
  ds_read_b64_tr_b16 a[208:209], v2 offset:49664
  v_fma_f32 v16, v16, s24, v12
  v_smfmac_f32_16x16x64_bf16 v[48:51], a[224:227], v[32:39], v7
  v_mfma_f32_16x16x32_bf16 v[24:27], a[132:135], a[84:87], v[24:27]
  ds_read_b64_tr_b16 a[210:211], v2 offset:57856
  v_exp_f32 v16, v16
  v_mfma_f32_16x16x32_bf16 v[24:27], a[136:139], a[88:91], v[24:27]
  ds_read_b64_tr_b16 a[212:213], v2 offset:49672
  v_fma_f32 v17, v17, s24, v12
  v_mfma_f32_16x16x32_bf16 v[24:27], a[140:143], a[92:95], v[24:27]
  ds_read_b64_tr_b16 a[214:215], v2 offset:57864
  v_exp_f32 v17, v17
  v_mfma_f32_16x16x32_bf16 v[28:31], a[156:159], a[92:95], 0
  s_waitcnt lgkmcnt(4)
  ds_read_b64_tr_b16 a[216:217], v2 offset:49920
  v_fma_f32 v18, v18, s24, v12
  v_mfma_f32_16x16x32_bf16 v[28:31], a[152:155], a[88:91], v[28:31]
  buffer_store_dwordx4 a[228:231], v6, s[16:19], s43 offen sc1
  ds_read_b64_tr_b16 a[218:219], v2 offset:58112
  ds_read_b128 a[232:235], v63 offset:12800
  v_exp_f32 v18, v18
  v_mfma_f32_16x16x32_bf16 v[28:31], a[148:151], a[84:87], v[28:31]
  ds_read_b64_tr_b16 a[220:221], v2 offset:49928
  v_fma_f32 v19, v19, s24, v12
  v_mfma_f32_16x16x32_bf16 v[28:31], a[144:147], a[80:83], v[28:31]
  ds_read_b64_tr_b16 a[222:223], v2 offset:58120
  v_exp_f32 v19, v19
  v_mfma_f32_16x16x32_bf16 v[224:227], a[160:163], v[36:39], v[224:227]
  v_fma_f32 v20, v20, s24, v12
  v_cvt_pk_bf16_f32 v32, v16, v17
  v_mfma_f32_16x16x32_bf16 v[228:231], a[164:167], v[36:39], v[228:231]
  v_exp_f32 v20, v20
  v_mfma_f32_16x16x32_bf16 v[232:235], a[168:171], v[36:39], v[232:235]
  v_fma_f32 v21, v21, s24, v12
  v_cvt_pk_bf16_f32 v33, v18, v19
  v_mfma_f32_16x16x32_bf16 v[236:239], a[172:175], v[36:39], v[236:239]
  v_exp_f32 v21, v21
  v_mfma_f32_16x16x32_bf16 v[240:243], a[176:179], v[36:39], v[240:243]
  v_fma_f32 v22, v22, s24, v12
  v_fma_f32 v23, v23, s24, v12
  v_mfma_f32_16x16x32_bf16 v[244:247], a[180:183], v[36:39], v[244:247]
  v_exp_f32 v22, v22
  v_mfma_f32_16x16x32_bf16 v[248:251], a[184:187], v[36:39], v[248:251]
  v_exp_f32 v23, v23
  v_mfma_f32_16x16x32_bf16 v[252:255], a[188:191], v[36:39], v[252:255]
  v_cvt_pk_bf16_f32 v34, v20, v21
  v_cvt_pk_bf16_f32 v35, v22, v23
  s_waitcnt lgkmcnt(2)
  v_fma_f32 v24, v24, s24, v13
  buffer_store_dwordx4 a[232:235], v6, s[16:19], s43 offen offset:2048 sc1
  ds_read_b128 a[236:239], v63 offset:14336
  v_exp_f32 v24, v24
  v_fma_f32 v25, v25, s24, v13
  v_exp_f32 v25, v25
  v_fma_f32 v26, v26, s24, v13
  v_exp_f32 v26, v26
  v_fma_f32 v27, v27, s24, v13
  s_waitcnt lgkmcnt(1)
  v_exp_f32 v27, v27
  v_mfma_f32_16x16x32_bf16 v[192:195], a[192:195], v[32:35], v[192:195]
  v_fma_f32 v28, v28, s24, v13
  v_cvt_pk_bf16_f32 v36, v24, v25
  v_mfma_f32_16x16x32_bf16 v[196:199], a[196:199], v[32:35], v[196:199]
  v_exp_f32 v28, v28
  v_mfma_f32_16x16x32_bf16 v[200:203], a[200:203], v[32:35], v[200:203]
  v_fma_f32 v29, v29, s24, v13
  v_cvt_pk_bf16_f32 v37, v26, v27
  v_mfma_f32_16x16x32_bf16 v[204:207], a[204:207], v[32:35], v[204:207]
  v_exp_f32 v29, v29
  v_mfma_f32_16x16x32_bf16 v[208:211], a[208:211], v[32:35], v[208:211]
  s_waitcnt lgkmcnt(0)
  v_fma_f32 v30, v30, s24, v13
  v_fma_f32 v31, v31, s24, v13
  v_mfma_f32_16x16x32_bf16 v[212:215], a[212:215], v[32:35], v[212:215]
  buffer_store_dwordx4 a[236:239], v6, s[16:19], s43 offen offset:128 sc1
  ds_read_b128 a[240:243], v63 offset:14848
  v_exp_f32 v30, v30
  v_mfma_f32_16x16x32_bf16 v[216:219], a[216:219], v[32:35], v[216:219]
  v_exp_f32 v31, v31
  v_mfma_f32_16x16x32_bf16 v[220:223], a[220:223], v[32:35], v[220:223]
  v_cvt_pk_bf16_f32 v38, v28, v29
  v_cvt_pk_bf16_f32 v39, v30, v31
  s_nop 1
  v_smfmac_f32_16x16x64_bf16 v[48:51], a[224:227], v[32:39], v7
  s_nop 7
  v_add_f32 v53, v48, v49
  v_rcp_f32 v52, v53
  v_cmp_ngt_f32 vcc, s26, v53
  v_pk_mul_f32 v[192:193], v[192:193], v[52:53] op_sel_hi:[1,0]
  v_pk_mul_f32 v[194:195], v[194:195], v[52:53] op_sel_hi:[1,0]
  v_pk_mul_f32 v[196:197], v[196:197], v[52:53] op_sel_hi:[1,0]
  v_pk_mul_f32 v[198:199], v[198:199], v[52:53] op_sel_hi:[1,0]
  s_or_b64 s[30:31], s[30:31], vcc
  v_cvt_pk_bf16_f32 v192, v192, v193
  v_cvt_pk_bf16_f32 v193, v194, v195
  v_cvt_pk_bf16_f32 v194, v196, v197
  v_cvt_pk_bf16_f32 v195, v198, v199
  v_pk_mul_f32 v[200:201], v[200:201], v[52:53] op_sel_hi:[1,0]
  v_pk_mul_f32 v[202:203], v[202:203], v[52:53] op_sel_hi:[1,0]
  v_pk_mul_f32 v[204:205], v[204:205], v[52:53] op_sel_hi:[1,0]
  v_pk_mul_f32 v[206:207], v[206:207], v[52:53] op_sel_hi:[1,0]
  ds_write_b128 v62, v[192:195] offset:16384
  v_cvt_pk_bf16_f32 v200, v200, v201
  v_cvt_pk_bf16_f32 v201, v202, v203
  v_cvt_pk_bf16_f32 v202, v204, v205
  v_cvt_pk_bf16_f32 v203, v206, v207
  v_pk_mul_f32 v[208:209], v[208:209], v[52:53] op_sel_hi:[1,0]
  v_pk_mul_f32 v[210:211], v[210:211], v[52:53] op_sel_hi:[1,0]
  v_pk_mul_f32 v[212:213], v[212:213], v[52:53] op_sel_hi:[1,0]
  v_pk_mul_f32 v[214:215], v[214:215], v[52:53] op_sel_hi:[1,0]
  v_mfma_f32_16x16x32_bf16 v[224:227], a[192:195], v[36:39], v[224:227]
  s_waitcnt lgkmcnt(1)
  ds_write_b128 v62, v[200:203] offset:17408
  v_mfma_f32_16x16x32_bf16 v[228:231], a[196:199], v[36:39], v[228:231]
  buffer_store_dwordx4 a[240:243], v6, s[16:19], s43 offen offset:2176 sc1
  v_cvt_pk_bf16_f32 v208, v208, v209
  v_cvt_pk_bf16_f32 v209, v210, v211
  v_cvt_pk_bf16_f32 v210, v212, v213
  v_cvt_pk_bf16_f32 v211, v214, v215
  v_pk_mul_f32 v[216:217], v[216:217], v[52:53] op_sel_hi:[1,0]
  v_pk_mul_f32 v[218:219], v[218:219], v[52:53] op_sel_hi:[1,0]
  v_pk_mul_f32 v[220:221], v[220:221], v[52:53] op_sel_hi:[1,0]
  v_pk_mul_f32 v[222:223], v[222:223], v[52:53] op_sel_hi:[1,0]
  v_mfma_f32_16x16x32_bf16 v[232:235], a[200:203], v[36:39], v[232:235]
  ds_write_b128 v62, v[208:211] offset:18432
  v_mfma_f32_16x16x32_bf16 v[236:239], a[204:207], v[36:39], v[236:239]
  v_cvt_pk_bf16_f32 v216, v216, v217
  v_cvt_pk_bf16_f32 v217, v218, v219
  v_cvt_pk_bf16_f32 v218, v220, v221
  v_cvt_pk_bf16_f32 v219, v222, v223
  v_mfma_f32_16x16x32_bf16 v[240:243], a[208:211], v[36:39], v[240:243]
  ds_write_b128 v62, v[216:219] offset:19456
  v_mfma_f32_16x16x32_bf16 v[244:247], a[212:215], v[36:39], v[244:247]
  v_mfma_f32_16x16x32_bf16 v[248:251], a[216:219], v[36:39], v[248:251]
  ds_read_b128 a[244:247], v63 offset:16384
  v_mfma_f32_16x16x32_bf16 v[252:255], a[220:223], v[36:39], v[252:255]
  ds_read_b128 a[248:251], v63 offset:16896
  s_waitcnt lgkmcnt(1)
  buffer_store_dwordx4 a[244:247], v6, s[16:19], s44 offen sc1
  v_add_f32 v53, v50, v51
  v_rcp_f32 v52, v53
  v_cmp_ngt_f32 vcc, s26, v53
  v_pk_mul_f32 v[224:225], v[224:225], v[52:53] op_sel_hi:[1,0]
  v_pk_mul_f32 v[226:227], v[226:227], v[52:53] op_sel_hi:[1,0]
  v_pk_mul_f32 v[228:229], v[228:229], v[52:53] op_sel_hi:[1,0]
  v_pk_mul_f32 v[230:231], v[230:231], v[52:53] op_sel_hi:[1,0]
  s_or_b64 s[30:31], s[30:31], vcc
  ds_read_b128 a[228:231], v63 offset:18432
  v_cvt_pk_bf16_f32 v224, v224, v225
  v_cvt_pk_bf16_f32 v225, v226, v227
  v_cvt_pk_bf16_f32 v226, v228, v229
  v_cvt_pk_bf16_f32 v227, v230, v231
  v_pk_mul_f32 v[232:233], v[232:233], v[52:53] op_sel_hi:[1,0]
  v_pk_mul_f32 v[234:235], v[234:235], v[52:53] op_sel_hi:[1,0]
  v_pk_mul_f32 v[236:237], v[236:237], v[52:53] op_sel_hi:[1,0]
  v_pk_mul_f32 v[238:239], v[238:239], v[52:53] op_sel_hi:[1,0]
  s_waitcnt lgkmcnt(1)
  ds_write_b128 v62, v[224:227] offset:20480
  buffer_store_dwordx4 a[248:251], v6, s[16:19], s44 offen offset:2048 sc1
  v_cvt_pk_bf16_f32 v232, v232, v233
  v_cvt_pk_bf16_f32 v233, v234, v235
  v_cvt_pk_bf16_f32 v234, v236, v237
  v_cvt_pk_bf16_f32 v235, v238, v239
  v_pk_mul_f32 v[240:241], v[240:241], v[52:53] op_sel_hi:[1,0]
  v_pk_mul_f32 v[242:243], v[242:243], v[52:53] op_sel_hi:[1,0]
  v_pk_mul_f32 v[244:245], v[244:245], v[52:53] op_sel_hi:[1,0]
  v_pk_mul_f32 v[246:247], v[246:247], v[52:53] op_sel_hi:[1,0]
  ds_write_b128 v62, v[232:235] offset:21504
  ds_read_b128 a[232:235], v63 offset:18944
  v_cvt_pk_bf16_f32 v240, v240, v241
  v_cvt_pk_bf16_f32 v241, v242, v243
  v_cvt_pk_bf16_f32 v242, v244, v245
  v_cvt_pk_bf16_f32 v243, v246, v247
  v_pk_mul_f32 v[248:249], v[248:249], v[52:53] op_sel_hi:[1,0]
  v_pk_mul_f32 v[250:251], v[250:251], v[52:53] op_sel_hi:[1,0]
  v_pk_mul_f32 v[252:253], v[252:253], v[52:53] op_sel_hi:[1,0]
  v_pk_mul_f32 v[254:255], v[254:255], v[52:53] op_sel_hi:[1,0]
  s_waitcnt lgkmcnt(3)
  ds_write_b128 v62, v[240:243] offset:22528
  buffer_store_dwordx4 a[228:231], v6, s[16:19], s44 offen offset:128 sc1
  v_cvt_pk_bf16_f32 v248, v248, v249
  v_cvt_pk_bf16_f32 v249, v250, v251
  v_cvt_pk_bf16_f32 v250, v252, v253
  v_cvt_pk_bf16_f32 v251, v254, v255
  ds_write_b128 v62, v[248:251] offset:23552
  s_waitcnt lgkmcnt(2)
  buffer_store_dwordx4 a[232:235], v6, s[16:19], s44 offen offset:2176 sc1
  ds_read_b128 a[236:239], v63 offset:20480
  ds_read_b128 a[240:243], v63 offset:20992
  ds_read_b128 a[244:247], v63 offset:22528
  ds_read_b128 a[248:251], v63 offset:23040
  s_waitcnt lgkmcnt(3)
  buffer_store_dwordx4 a[236:239], v6, s[16:19], s45 offen sc1
  s_waitcnt lgkmcnt(2)
  buffer_store_dwordx4 a[240:243], v6, s[16:19], s45 offen offset:2048 sc1
  s_waitcnt lgkmcnt(1)
  buffer_store_dwordx4 a[244:247], v6, s[16:19], s45 offen offset:128 sc1
  s_waitcnt lgkmcnt(0)
  buffer_store_dwordx4 a[248:251], v6, s[16:19], s45 offen offset:2176 sc1
  s_cmp_lg_u64 s[30:31], 0
  s_cselect_b32 s35, 1, 0
  s_lshl_b32 s35, s35, s27
  s_or_b32 s28, s28, s35
  s_cmp_eq_u32 s28, 0
  s_cbranch_scc1 L_end
  s_waitcnt vmcnt(0) lgkmcnt(0)
  v_lshrrev_b32 v58, 4, v0
  v_and_b32 v59, 15, v0
  v_lshlrev_b32 v6, 8, v59
  v_lshl_add_u32 v6, v58, 4, v6
  v_lshlrev_b32 v60, 10, v58
  v_lshl_add_u32 v60, v59, 4, v60
  v_add_u32 v60, s33, v60
  s_mov_b32 s40, s37
  s_mov_b32 s41, s36
L_sb:
  s_and_b32 s42, s28, 1
  s_cmp_eq_u32 s42, 0
  s_cbranch_scc1 L_sb_next
  s_mov_b32 s43, s40
  s_mov_b32 s44, 6
L_sq:
  buffer_load_dwordx4 v[64:67], v6, s[4:7], s43 offen offset:0
  buffer_load_dwordx4 v[68:71], v6, s[4:7], s43 offen offset:64
  buffer_load_dwordx4 v[72:75], v6, s[4:7], s43 offen offset:128
  buffer_load_dwordx4 v[76:79], v6, s[4:7], s43 offen offset:192
  v_mov_b32 v14, 0xff800000
  s_mov_b32 s45, s41
  s_mov_b32 s46, 32
L_s1:
  buffer_load_dwordx4 v[80:83], v6, s[8:11], s45 offen offset:2048
  buffer_load_dwordx4 v[84:87], v6, s[8:11], s45 offen offset:2112
  buffer_load_dwordx4 v[88:91], v6, s[8:11], s45 offen offset:2176
  buffer_load_dwordx4 v[92:95], v6, s[8:11], s45 offen offset:2240
  s_waitcnt vmcnt(0)
  v_mfma_f32_16x16x32_bf16 v[16:19], v[80:83], v[64:67], 0
  v_mfma_f32_16x16x32_bf16 v[16:19], v[84:87], v[68:71], v[16:19]
  v_mfma_f32_16x16x32_bf16 v[16:19], v[88:91], v[72:75], v[16:19]
  v_mfma_f32_16x16x32_bf16 v[16:19], v[92:95], v[76:79], v[16:19]
  s_nop 15
  v_max3_f32 v14, v14, v16, v17
  v_max3_f32 v14, v14, v18, v19
  s_add_u32 s45, s45, 4096
  s_sub_u32 s46, s46, 1
  s_cmp_lg_u32 s46, 0
  s_cbranch_scc1 L_s1
  v_mov_b32 v15, v14
  s_nop 1
  v_permlane16_swap_b32 v14, v15
  s_nop 1
  v_max_f32 v14, v14, v15
  v_mov_b32 v15, v14
  s_nop 1
  v_permlane32_swap_b32 v14, v15
  s_nop 1
  v_max_f32 v14, v14, v15
  v_mul_f32 v14, s25, v14
  v_mov_b32 v52, 0
  v_mov_b32 v128, 0
  v_mov_b32 v129, 0
  v_mov_b32 v130, 0
  v_mov_b32 v131, 0
  v_mov_b32 v132, 0
  v_mov_b32 v133, 0
  v_mov_b32 v134, 0
  v_mov_b32 v135, 0
  v_mov_b32 v136, 0
  v_mov_b32 v137, 0
  v_mov_b32 v138, 0
  v_mov_b32 v139, 0
  v_mov_b32 v140, 0
  v_mov_b32 v141, 0
  v_mov_b32 v142, 0
  v_mov_b32 v143, 0
  v_mov_b32 v144, 0
  v_mov_b32 v145, 0
  v_mov_b32 v146, 0
  v_mov_b32 v147, 0
  v_mov_b32 v148, 0
  v_mov_b32 v149, 0
  v_mov_b32 v150, 0
  v_mov_b32 v151, 0
  v_mov_b32 v152, 0
  v_mov_b32 v153, 0
  v_mov_b32 v154, 0
  v_mov_b32 v155, 0
  v_mov_b32 v156, 0
  v_mov_b32 v157, 0
  v_mov_b32 v158, 0
  v_mov_b32 v159, 0
  s_mov_b32 s45, s41
  s_mov_b32 s46, 16
L_s2:
  s_add_u32 s47, s45, 4096
  buffer_load_dwordx4 v[80:83], v6, s[8:11], s45 offen offset:2048
  buffer_load_dwordx4 v[84:87], v6, s[8:11], s45 offen offset:2112
  buffer_load_dwordx4 v[88:91], v6, s[8:11], s45 offen offset:2176
  buffer_load_dwordx4 v[92:95], v6, s[8:11], s45 offen offset:2240
  buffer_load_dwordx4 v[96:99], v6, s[8:11], s47 offen offset:2048
  buffer_load_dwordx4 v[100:103], v6, s[8:11], s47 offen offset:2112
  buffer_load_dwordx4 v[104:107], v6, s[8:11], s47 offen offset:2176
  buffer_load_dwordx4 v[108:111], v6, s[8:11], s47 offen offset:2240
  s_add_u32 m0, s33, 0
  s_nop 0
  buffer_load_dwordx4 v4, s[12:15], s45 offen offset:0 lds
  buffer_load_dwordx4 v4, s[12:15], s45 offen offset:1024 lds
  buffer_load_dwordx4 v4, s[12:15], s45 offen offset:2048 lds
  buffer_load_dwordx4 v4, s[12:15], s45 offen offset:3072 lds
  s_add_u32 m0, s33, 4096
  s_nop 0
  buffer_load_dwordx4 v4, s[12:15], s47 offen offset:0 lds
  buffer_load_dwordx4 v4, s[12:15], s47 offen offset:1024 lds
  buffer_load_dwordx4 v4, s[12:15], s47 offen offset:2048 lds
  buffer_load_dwordx4 v4, s[12:15], s47 offen offset:3072 lds
  s_waitcnt vmcnt(0)
  ds_read_b64_tr_b16 v[160:161], v60 offset:0
  ds_read_b64_tr_b16 v[162:163], v60 offset:4096
  ds_read_b64_tr_b16 v[164:165], v60 offset:8
  ds_read_b64_tr_b16 v[166:167], v60 offset:4104
  ds_read_b64_tr_b16 v[168:169], v60 offset:256
  ds_read_b64_tr_b16 v[170:171], v60 offset:4352
  ds_read_b64_tr_b16 v[172:173], v60 offset:264
  ds_read_b64_tr_b16 v[174:175], v60 offset:4360
  ds_read_b64_tr_b16 v[176:177], v60 offset:512
  ds_read_b64_tr_b16 v[178:179], v60 offset:4608
  ds_read_b64_tr_b16 v[180:181], v60 offset:520
  ds_read_b64_tr_b16 v[182:183], v60 offset:4616
  ds_read_b64_tr_b16 v[184:185], v60 offset:768
  ds_read_b64_tr_b16 v[186:187], v60 offset:4864
  ds_read_b64_tr_b16 v[188:189], v60 offset:776
  ds_read_b64_tr_b16 v[190:191], v60 offset:4872
  v_mfma_f32_16x16x32_bf16 v[16:19], v[80:83], v[64:67], 0
  v_mfma_f32_16x16x32_bf16 v[16:19], v[84:87], v[68:71], v[16:19]
  v_mfma_f32_16x16x32_bf16 v[16:19], v[88:91], v[72:75], v[16:19]
  v_mfma_f32_16x16x32_bf16 v[16:19], v[92:95], v[76:79], v[16:19]
  v_mfma_f32_16x16x32_bf16 v[20:23], v[96:99], v[64:67], 0
  v_mfma_f32_16x16x32_bf16 v[20:23], v[100:103], v[68:71], v[20:23]
  v_mfma_f32_16x16x32_bf16 v[20:23], v[104:107], v[72:75], v[20:23]
  v_mfma_f32_16x16x32_bf16 v[20:23], v[108:111], v[76:79], v[20:23]
  s_nop 15
  v_fma_f32 v16, v16, s24, v14
  v_fma_f32 v17, v17, s24, v14
  v_fma_f32 v18, v18, s24, v14
  v_fma_f32 v19, v19, s24, v14
  v_fma_f32 v20, v20, s24, v14
  v_fma_f32 v21, v21, s24, v14
  v_fma_f32 v22, v22, s24, v14
  v_fma_f32 v23, v23, s24, v14
  v_exp_f32 v16, v16
  v_exp_f32 v17, v17
  v_exp_f32 v18, v18
  v_exp_f32 v19, v19
  v_exp_f32 v20, v20
  v_exp_f32 v21, v21
  v_exp_f32 v22, v22
  v_exp_f32 v23, v23
  s_nop 0
  v_add_f32 v52, v52, v16
  v_add_f32 v52, v52, v17
  v_add_f32 v52, v52, v18
  v_add_f32 v52, v52, v19
  v_add_f32 v52, v52, v20
  v_add_f32 v52, v52, v21
  v_add_f32 v52, v52, v22
  v_add_f32 v52, v52, v23
  v_cvt_pk_bf16_f32 v32, v16, v17
  v_cvt_pk_bf16_f32 v33, v18, v19
  v_cvt_pk_bf16_f32 v34, v20, v21
  v_cvt_pk_bf16_f32 v35, v22, v23
  s_waitcnt lgkmcnt(0)
  s_nop 1
  v_mfma_f32_16x16x32_bf16 v[128:131], v[160:163], v[32:35], v[128:131]
  v_mfma_f32_16x16x32_bf16 v[132:135], v[164:167], v[32:35], v[132:135]
  v_mfma_f32_16x16x32_bf16 v[136:139], v[168:171], v[32:35], v[136:139]
  v_mfma_f32_16x16x32_bf16 v[140:143], v[172:175], v[32:35], v[140:143]
  v_mfma_f32_16x16x32_bf16 v[144:147], v[176:179], v[32:35], v[144:147]
  v_mfma_f32_16x16x32_bf16 v[148:151], v[180:183], v[32:35], v[148:151]
  v_mfma_f32_16x16x32_bf16 v[152:155], v[184:187], v[32:35], v[152:155]
  v_mfma_f32_16x16x32_bf16 v[156:159], v[188:191], v[32:35], v[156:159]
  s_add_u32 s45, s45, 8192
  s_sub_u32 s46, s46, 1
  s_cmp_lg_u32 s46, 0
  s_cbranch_scc1 L_s2
  v_mov_b32 v15, v52
  s_nop 1
  v_permlane16_swap_b32 v52, v15
  s_nop 1
  v_add_f32 v52, v52, v15
  v_mov_b32 v15, v52
  s_nop 1
  v_permlane32_swap_b32 v52, v15
  s_nop 1
  v_add_f32 v52, v52, v15
  v_rcp_f32 v53, v52
  s_nop 15
  v_mul_f32 v128, v128, v53
  v_mul_f32 v129, v129, v53
  v_mul_f32 v130, v130, v53
  v_mul_f32 v131, v131, v53
  v_mul_f32 v132, v132, v53
  v_mul_f32 v133, v133, v53
  v_mul_f32 v134, v134, v53
  v_mul_f32 v135, v135, v53
  v_mul_f32 v136, v136, v53
  v_mul_f32 v137, v137, v53
  v_mul_f32 v138, v138, v53
  v_mul_f32 v139, v139, v53
  v_mul_f32 v140, v140, v53
  v_mul_f32 v141, v141, v53
  v_mul_f32 v142, v142, v53
  v_mul_f32 v143, v143, v53
  v_mul_f32 v144, v144, v53
  v_mul_f32 v145, v145, v53
  v_mul_f32 v146, v146, v53
  v_mul_f32 v147, v147, v53
  v_mul_f32 v148, v148, v53
  v_mul_f32 v149, v149, v53
  v_mul_f32 v150, v150, v53
  v_mul_f32 v151, v151, v53
  v_mul_f32 v152, v152, v53
  v_mul_f32 v153, v153, v53
  v_mul_f32 v154, v154, v53
  v_mul_f32 v155, v155, v53
  v_mul_f32 v156, v156, v53
  v_mul_f32 v157, v157, v53
  v_mul_f32 v158, v158, v53
  v_mul_f32 v159, v159, v53
  v_cvt_pk_bf16_f32 v128, v128, v129
  v_cvt_pk_bf16_f32 v129, v130, v131
  v_cvt_pk_bf16_f32 v130, v132, v133
  v_cvt_pk_bf16_f32 v131, v134, v135
  buffer_store_dwordx4 v[128:131], v6, s[16:19], s43 offen offset:0
  v_cvt_pk_bf16_f32 v136, v136, v137
  v_cvt_pk_bf16_f32 v137, v138, v139
  v_cvt_pk_bf16_f32 v138, v140, v141
  v_cvt_pk_bf16_f32 v139, v142, v143
  buffer_store_dwordx4 v[136:139], v6, s[16:19], s43 offen offset:64
  v_cvt_pk_bf16_f32 v144, v144, v145
  v_cvt_pk_bf16_f32 v145, v146, v147
  v_cvt_pk_bf16_f32 v146, v148, v149
  v_cvt_pk_bf16_f32 v147, v150, v151
  buffer_store_dwordx4 v[144:147], v6, s[16:19], s43 offen offset:128
  v_cvt_pk_bf16_f32 v152, v152, v153
  v_cvt_pk_bf16_f32 v153, v154, v155
  v_cvt_pk_bf16_f32 v154, v156, v157
  v_cvt_pk_bf16_f32 v155, v158, v159
  buffer_store_dwordx4 v[152:155], v6, s[16:19], s43 offen offset:192
  s_waitcnt vmcnt(0)
  s_add_u32 s43, s43, 4096
  s_sub_u32 s44, s44, 1
  s_cmp_lg_u32 s44, 0
  s_cbranch_scc1 L_sq
L_sb_next:
  s_add_u32 s40, s40, 25165824
  s_add_u32 s41, s41, 16777216
  s_lshr_b32 s28, s28, 1
  s_cmp_lg_u32 s28, 0
  s_cbranch_scc1 L_sb
L_end:
  s_endpgm
.section .rodata,"a"
.p2align 6
.amdhsa_kernel standalone__gqa_softmax__near_ridge_kernel
  .amdhsa_next_free_vgpr 512
  .amdhsa_next_free_sgpr 64
  .amdhsa_accum_offset 256
  .amdhsa_group_segment_fixed_size 0
  .amdhsa_kernarg_size 48
  .amdhsa_user_sgpr_count 2
  .amdhsa_user_sgpr_kernarg_segment_ptr 1
  .amdhsa_system_sgpr_workgroup_id_x 1
.end_amdhsa_kernel
```
